```python
import torch

def _softmax(x, axis=-1):
    return torch.softmax(x, dim=axis)
def _gelu(x):
    return torch.nn.functional.gelu(x, approximate="tanh")
def _silu(x):
    return torch.nn.functional.silu(x)
def _sigmoid(x):
    return torch.sigmoid(x)
def _layernorm(x, axis=-1, eps=1e-5):
    m = x.mean(dim=axis, keepdim=True)
    v = x.var(dim=axis, keepdim=True, unbiased=False)
    return (x - m) / torch.sqrt(v + eps)
def _scatter_add(tgt, idx, src, axis=0):
    return tgt.clone().index_add_(axis, idx, src)
def _segment_sum(src, seg, n):
    out = torch.zeros((n,) + src.shape[1:], dtype=src.dtype)
    return out.index_add_(0, seg, src)
def _pad(x, pw):
    flat = tuple(v for pair in reversed(pw) for v in pair)
    return torch.nn.functional.pad(x, flat)

kernel_name = 'parallel_sum__ssm_conv_s4d__swiglu_ffn__prompt'

def setup_inputs():

    _w = (lambda a: (lambda t: t.to(torch.bfloat16) if t.is_floating_point() else t)(torch.as_tensor(a)))
    def _A_setup():
        Bsz, L, D, N = 1, 2048, 576, 128
        return {
            "u": _w((lambda *s: torch.randn(*s, dtype=torch.bfloat16) * 0.05)(Bsz, L, D)),
            "log_A_real": _w((lambda *s: torch.randn(*s, dtype=torch.bfloat16) * 3.2)(D, N) * 0.5),
            "A_imag": _w((lambda *s: torch.randn(*s, dtype=torch.bfloat16) * 0.2)(D, N) * 3.14),
            "C_real": _w((lambda *s: torch.randn(*s, dtype=torch.bfloat16) * 3.2)(D, N) / N ** 0.5),
            "C_imag": _w((lambda *s: torch.randn(*s, dtype=torch.bfloat16) * 3.2)(D, N) / N ** 0.5),
            "log_dt": _w((lambda *s: torch.randn(*s, dtype=torch.bfloat16) * 0.2)(D) * 0.5 - 4.0),
            "D_skip": _w((lambda *s: torch.randn(*s, dtype=torch.bfloat16) * 0.2)(D)),
        }
    _A_in = _A_setup()

    def _B_setup():
        B, S, D, F = 1, 2048, 576, 4608
        return {
            "x": _w((lambda *s: torch.randn(*s, dtype=torch.bfloat16) * 0.05)(B, S, D)),
            "w_gate": _w((lambda *s: torch.randn(*s, dtype=torch.bfloat16) * 0.05)(D, F)),
            "w_up": _w((lambda *s: torch.randn(*s, dtype=torch.bfloat16) * 0.05)(D, F)),
            "w_down": _w((lambda *s: torch.randn(*s, dtype=torch.bfloat16) * 0.05)(F, D)),
        }
    _B_in = _B_setup()

    return {
        "A_u": _A_in["u"],
        "A_log_A_real": _A_in["log_A_real"],
        "A_A_imag": _A_in["A_imag"],
        "A_C_real": _A_in["C_real"],
        "A_C_imag": _A_in["C_imag"],
        "A_log_dt": _A_in["log_dt"],
        "A_D_skip": _A_in["D_skip"],
        "B_x": _B_in["x"],
        "B_w_gate": _B_in["w_gate"],
        "B_w_up": _B_in["w_up"],
        "B_w_down": _B_in["w_down"],
    }

def reference(A_u, A_log_A_real, A_A_imag, A_C_real, A_C_imag, A_log_dt, A_D_skip, B_x, B_w_gate, B_w_up, B_w_down):
    def _A_ref(u, log_A_real, A_imag, C_real, C_imag, log_dt, D_skip):
        L = u.shape[1]
        dt = torch.exp(log_dt)
        A = -torch.exp(log_A_real) + 1j * A_imag
        C = (C_real + 1j * C_imag) * dt[:, None]
        pos = (lambda x, dt: x.to(dt))(torch.arange(L), log_dt.dtype)
        P = torch.exp((A * dt[:, None])[:, :, None] * pos[None, None, :])
        K = 2.0 * torch.einsum("dn,dnl->dl", C, P).real
        L2 = 2 * L
        u_t = (lambda x, *d: x.permute(*d))(u, 0, 2, 1)
        Kf = (lambda x, *a, **k: torch.fft.rfft(x.float(), *a, **k))(K, L2)
        Uf = (lambda x, *a, **k: torch.fft.rfft(x.float(), *a, **k))(u_t, L2)
        y = (lambda x, *a, **k: torch.fft.irfft(x, *a, **k).to(torch.bfloat16))(Uf * Kf[None, :, :], L2)[:, :, :L]
        y = (lambda x, *d: x.permute(*d))(y, 0, 2, 1)
        return y + u * D_skip[None, None, :]

    def _B_ref(x, w_gate, w_up, w_down):
        g = _silu(x @ w_gate)
        u = x @ w_up
        return (g * u) @ w_down

    x = A_u
    xn = _layernorm(x, axis=-1)
    return x + _A_ref(xn, A_log_A_real, A_A_imag, A_C_real, A_C_imag, A_log_dt, A_D_skip) + _B_ref(xn, B_w_gate, B_w_up, B_w_down)
```

```asm
; @launch grid=(256,1,1) block=(256,1,1) lds=163840
.amdgcn_target "amdgcn-amd-amdhsa--gfx950"
.text
.globl parallel_sum__ssm_conv_s4d__swiglu_ffn__prompt_kernel
.p2align 8
.type parallel_sum__ssm_conv_s4d__swiglu_ffn__prompt_kernel,@function
parallel_sum__ssm_conv_s4d__swiglu_ffn__prompt_kernel:
    s_cmp_ge_u32 s2, 256
    s_cbranch_scc1 M_end
    s_load_dwordx2 s[4:5], s[0:1], 104
    s_load_dwordx2 s[6:7], s[0:1], 64
    s_load_dwordx2 s[8:9], s[0:1], 72
    s_load_dwordx2 s[10:11], s[0:1], 80
    s_getpc_b64 s[12:13]
M_pc:
    s_lshr_b32 s14, s2, 3
    s_lshl_b32 s14, s14, 11
    v_and_b32 v250, 15, v0
    v_lshlrev_b32 v250, 7, v250
    v_add_u32 v250, s14, v250
    v_min_u32 v250, M_codeend-M_pc-4, v250
    global_load_dword v251, v250, s[12:13]
    v_lshrrev_b32 v11, 6, v0
    v_and_b32 v0, 63, v0
    s_cmp_lt_u32 s2, 64
    v_readfirstlane_b32 s3, v11
    v_lshlrev_b32 v1, 4, v0
    s_cbranch_scc0 M_k
    s_load_dwordx2 s[16:17], s[0:1], 0
    s_load_dwordx2 s[24:25], s[0:1], 96
    s_mov_b32 s18, 2359296
    s_mov_b32 s19, 0x00020000
    s_and_b32 s65, s2, 7
    s_lshl_b32 s65, s65, 3
    s_lshr_b32 s66, s2, 3
    s_add_u32 s50, s65, s66
    v_lshrrev_b32 v48, 3, v0
    v_and_b32 v49, 7, v0
    v_mul_u32_u24 v50, 1152, v48
    v_lshl_add_u32 v50, v49, 4, v50
    s_mul_i32 s51, s50, 36864
    s_mul_i32 s65, s3, 9216
    s_add_u32 s65, s65, s51
    s_waitcnt lgkmcnt(0)
    buffer_load_dwordx4 v[140:143], v50, s[16:19], s65 offen offset:0
    buffer_load_dwordx4 v[144:147], v50, s[16:19], s65 offen offset:128
    buffer_load_dwordx4 v[148:151], v50, s[16:19], s65 offen offset:256
    buffer_load_dwordx4 v[152:155], v50, s[16:19], s65 offen offset:384
    buffer_load_dwordx4 v[156:159], v50, s[16:19], s65 offen offset:512
    buffer_load_dwordx4 v[160:163], v50, s[16:19], s65 offen offset:640
    buffer_load_dwordx4 v[164:167], v50, s[16:19], s65 offen offset:768
    buffer_load_dwordx4 v[168:171], v50, s[16:19], s65 offen offset:896
    buffer_load_dwordx4 v[172:175], v50, s[16:19], s65 offen offset:1024
    s_and_b32 s60, s2, 3
    s_lshr_b32 s65, s2, 3
    s_and_b32 s64, s65, 3
    s_bfe_u32 s66, s65, 0x10002
    s_lshr_b32 s63, s65, 3
    s_and_b32 s67, s2, 4
    s_add_u32 s63, s63, s67
    s_lshl_b32 s62, s60, 1
    s_add_u32 s62, s62, s66
    s_lshl_b32 s58, s63, 1
    s_add_u32 s58, s58, s66
    v_lshrrev_b32 v11, 2, v0
    v_mul_u32_u24 v6, 9216, v11
    v_lshrrev_b32 v11, 4, v0
    v_and_b32 v11, 2, v11
    v_and_b32 v12, 3, v0
    v_xor_b32 v11, v11, v12
    v_lshl_add_u32 v6, v11, 4, v6
    v_lshrrev_b32 v11, 1, v0
    v_lshrrev_b32 v12, 1, v11
    v_and_b32 v12, 4, v12
    v_xor_b32 v11, v11, v12
    v_mul_u32_u24 v7, 9216, v11
    v_and_b32 v11, 1, v0
    v_lshl_add_u32 v7, v11, 4, v7
    s_and_b32 s65, s3, 1
    s_lshr_b32 s66, s3, 1
    s_lshl_b32 s40, s66, 12
    s_lshl_b32 s67, s65, 11
    s_add_u32 s40, s40, s67
    s_lshl_b32 s41, s66, 11
    s_lshl_b32 s67, s65, 10
    s_add_u32 s41, s41, s67
    s_mul_i32 s42, s62, 1152
    s_mul_i32 s67, s64, 288
    s_add_u32 s42, s42, s67
    s_mul_i32 s67, s66, 294912
    s_add_u32 s42, s42, s67
    s_and_b32 s68, s64, 1
    s_xor_b32 s67, s68, 1
    s_lshl_b32 s67, s67, 8
    s_add_u32 s43, s42, s67
    s_lshl_b32 s67, s68, 5
    s_add_u32 s42, s42, s67
    s_and_b32 s65, s3, 1
    s_cmp_eq_u32 s65, 0
    s_cselect_b32 s12, s6, s8
    s_cselect_b32 s13, s7, s9
    s_mov_b32 s14, 5308416
    s_mov_b32 s15, 0x00020000
    s_mov_b32 s20, s4
    s_mov_b32 s21, s5
    s_mov_b32 s22, 2359296
    s_mov_b32 s23, 0x00020000
    s_add_u32 s28, s4, 7151616
    s_addc_u32 s29, s5, 0
    s_mov_b32 s30, 2359296
    s_mov_b32 s31, 0x00020000
    s_add_u32 s36, s4, 40181760
    s_addc_u32 s37, s5, 0
    s_mov_b32 s38, 13312
    s_mov_b32 s39, 0x00020000
    v_mov_b32 v53, 0x3f803f80
    v_mov_b32 v56, 0
    v_mov_b32 v57, 0
    v_mov_b32 v58, 0
    v_mov_b32 v59, 0
    v_mov_b32 v60, 0
    v_mov_b32 v61, 0
    v_mov_b32 v62, 0
    v_mov_b32 v63, 0
    v_lshrrev_b32 v55, 2, v49
    v_lshlrev_b32 v55, 10, v55
    v_and_b32 v51, 3, v49
    v_lshl_add_u32 v55, v51, 8, v55
    v_lshl_add_u32 v55, v48, 4, v55
    s_mul_i32 s67, s3, 10496
    s_add_u32 s67, s67, 50176
    v_mul_u32_u24 v52, 1312, v48
    v_lshl_add_u32 v52, v49, 4, v52
    v_add_u32 v52, s67, v52
    s_waitcnt vmcnt(0)
    v_dot2c_f32_bf16 v56, v140, v53
    v_dot2c_f32_bf16 v60, v140, v140
    v_dot2c_f32_bf16 v57, v141, v53
    v_dot2c_f32_bf16 v61, v141, v141
    v_dot2c_f32_bf16 v58, v142, v53
    v_dot2c_f32_bf16 v62, v142, v142
    v_dot2c_f32_bf16 v59, v143, v53
    v_dot2c_f32_bf16 v63, v143, v143
    v_dot2c_f32_bf16 v56, v144, v53
    v_dot2c_f32_bf16 v60, v144, v144
    v_dot2c_f32_bf16 v57, v145, v53
    v_dot2c_f32_bf16 v61, v145, v145
    v_dot2c_f32_bf16 v58, v146, v53
    v_dot2c_f32_bf16 v62, v146, v146
    v_dot2c_f32_bf16 v59, v147, v53
    v_dot2c_f32_bf16 v63, v147, v147
    v_dot2c_f32_bf16 v56, v148, v53
    v_dot2c_f32_bf16 v60, v148, v148
    v_dot2c_f32_bf16 v57, v149, v53
    v_dot2c_f32_bf16 v61, v149, v149
    v_dot2c_f32_bf16 v58, v150, v53
    v_dot2c_f32_bf16 v62, v150, v150
    v_dot2c_f32_bf16 v59, v151, v53
    v_dot2c_f32_bf16 v63, v151, v151
    v_dot2c_f32_bf16 v56, v152, v53
    v_dot2c_f32_bf16 v60, v152, v152
    v_dot2c_f32_bf16 v57, v153, v53
    v_dot2c_f32_bf16 v61, v153, v153
    v_dot2c_f32_bf16 v58, v154, v53
    v_dot2c_f32_bf16 v62, v154, v154
    v_dot2c_f32_bf16 v59, v155, v53
    v_dot2c_f32_bf16 v63, v155, v155
    v_dot2c_f32_bf16 v56, v156, v53
    v_dot2c_f32_bf16 v60, v156, v156
    v_dot2c_f32_bf16 v57, v157, v53
    v_dot2c_f32_bf16 v61, v157, v157
    v_dot2c_f32_bf16 v58, v158, v53
    v_dot2c_f32_bf16 v62, v158, v158
    v_dot2c_f32_bf16 v59, v159, v53
    v_dot2c_f32_bf16 v63, v159, v159
    v_dot2c_f32_bf16 v56, v160, v53
    v_dot2c_f32_bf16 v60, v160, v160
    v_dot2c_f32_bf16 v57, v161, v53
    v_dot2c_f32_bf16 v61, v161, v161
    v_dot2c_f32_bf16 v58, v162, v53
    v_dot2c_f32_bf16 v62, v162, v162
    v_dot2c_f32_bf16 v59, v163, v53
    v_dot2c_f32_bf16 v63, v163, v163
    v_dot2c_f32_bf16 v56, v164, v53
    v_dot2c_f32_bf16 v60, v164, v164
    v_dot2c_f32_bf16 v57, v165, v53
    v_dot2c_f32_bf16 v61, v165, v165
    v_dot2c_f32_bf16 v58, v166, v53
    v_dot2c_f32_bf16 v62, v166, v166
    v_dot2c_f32_bf16 v59, v167, v53
    v_dot2c_f32_bf16 v63, v167, v167
    v_dot2c_f32_bf16 v56, v168, v53
    v_dot2c_f32_bf16 v60, v168, v168
    v_dot2c_f32_bf16 v57, v169, v53
    v_dot2c_f32_bf16 v61, v169, v169
    v_dot2c_f32_bf16 v58, v170, v53
    v_dot2c_f32_bf16 v62, v170, v170
    v_dot2c_f32_bf16 v59, v171, v53
    v_dot2c_f32_bf16 v63, v171, v171
    v_dot2c_f32_bf16 v56, v172, v53
    v_dot2c_f32_bf16 v60, v172, v172
    v_dot2c_f32_bf16 v57, v173, v53
    v_dot2c_f32_bf16 v61, v173, v173
    v_dot2c_f32_bf16 v58, v174, v53
    v_dot2c_f32_bf16 v62, v174, v174
    v_dot2c_f32_bf16 v59, v175, v53
    v_dot2c_f32_bf16 v63, v175, v175
    s_nop 2
    v_add_f32 v56, v56, v57
    v_add_f32 v58, v58, v59
    v_add_f32 v60, v60, v61
    v_add_f32 v62, v62, v63
    v_add_f32 v56, v56, v58
    v_add_f32 v57, v60, v62
    s_nop 1
    v_add_f32_dpp v56, v56, v56 quad_perm:[1,0,3,2] row_mask:0xf bank_mask:0xf
    v_add_f32_dpp v57, v57, v57 quad_perm:[1,0,3,2] row_mask:0xf bank_mask:0xf
    s_nop 1
    v_add_f32_dpp v56, v56, v56 quad_perm:[2,3,0,1] row_mask:0xf bank_mask:0xf
    v_add_f32_dpp v57, v57, v57 quad_perm:[2,3,0,1] row_mask:0xf bank_mask:0xf
    s_nop 1
    v_add_f32_dpp v56, v56, v56 row_half_mirror row_mask:0xf bank_mask:0xf
    v_add_f32_dpp v57, v57, v57 row_half_mirror row_mask:0xf bank_mask:0xf
    v_mul_f32 v56, 0x3ae38e39, v56
    v_mul_f32 v57, 0x3ae38e39, v57
    v_lshlrev_b32 v64, 16, v140
    v_fma_f32 v57, -v56, v56, v57
    v_and_b32 v65, 0xffff0000, v140
    v_max_f32 v57, 0, v57
    v_lshlrev_b32 v66, 16, v141
    v_add_f32 v57, 0x3727c5ac, v57
    v_and_b32 v67, 0xffff0000, v141
    v_rsq_f32 v54, v57
    v_lshlrev_b32 v68, 16, v142
    v_and_b32 v69, 0xffff0000, v142
    v_lshlrev_b32 v70, 16, v143
    v_and_b32 v71, 0xffff0000, v143
    v_lshlrev_b32 v72, 16, v144
    v_and_b32 v73, 0xffff0000, v144
    v_lshlrev_b32 v74, 16, v145
    v_and_b32 v75, 0xffff0000, v145
    v_lshlrev_b32 v76, 16, v146
    v_and_b32 v77, 0xffff0000, v146
    v_lshlrev_b32 v78, 16, v147
    v_and_b32 v79, 0xffff0000, v147
    v_lshlrev_b32 v80, 16, v148
    v_and_b32 v81, 0xffff0000, v148
    v_lshlrev_b32 v82, 16, v149
    v_and_b32 v83, 0xffff0000, v149
    v_lshlrev_b32 v84, 16, v150
    v_and_b32 v85, 0xffff0000, v150
    v_lshlrev_b32 v86, 16, v151
    v_and_b32 v87, 0xffff0000, v151
    v_lshlrev_b32 v88, 16, v152
    v_and_b32 v89, 0xffff0000, v152
    v_lshlrev_b32 v90, 16, v153
    v_and_b32 v91, 0xffff0000, v153
    v_lshlrev_b32 v92, 16, v154
    v_and_b32 v93, 0xffff0000, v154
    v_lshlrev_b32 v94, 16, v155
    v_and_b32 v95, 0xffff0000, v155
    v_lshlrev_b32 v96, 16, v156
    v_and_b32 v97, 0xffff0000, v156
    v_lshlrev_b32 v98, 16, v157
    v_and_b32 v99, 0xffff0000, v157
    v_lshlrev_b32 v100, 16, v158
    v_and_b32 v101, 0xffff0000, v158
    v_lshlrev_b32 v102, 16, v159
    v_and_b32 v103, 0xffff0000, v159
    v_lshlrev_b32 v104, 16, v160
    v_and_b32 v105, 0xffff0000, v160
    v_lshlrev_b32 v106, 16, v161
    v_and_b32 v107, 0xffff0000, v161
    v_lshlrev_b32 v108, 16, v162
    v_and_b32 v109, 0xffff0000, v162
    v_lshlrev_b32 v110, 16, v163
    v_and_b32 v111, 0xffff0000, v163
    v_lshlrev_b32 v112, 16, v164
    v_and_b32 v113, 0xffff0000, v164
    v_lshlrev_b32 v114, 16, v165
    v_and_b32 v115, 0xffff0000, v165
    v_lshlrev_b32 v116, 16, v166
    v_and_b32 v117, 0xffff0000, v166
    v_lshlrev_b32 v118, 16, v167
    v_and_b32 v119, 0xffff0000, v167
    v_lshlrev_b32 v120, 16, v168
    v_and_b32 v121, 0xffff0000, v168
    v_lshlrev_b32 v122, 16, v169
    v_and_b32 v123, 0xffff0000, v169
    v_lshlrev_b32 v124, 16, v170
    v_and_b32 v125, 0xffff0000, v170
    v_lshlrev_b32 v126, 16, v171
    v_and_b32 v127, 0xffff0000, v171
    v_lshlrev_b32 v128, 16, v172
    v_and_b32 v129, 0xffff0000, v172
    v_lshlrev_b32 v130, 16, v173
    v_and_b32 v131, 0xffff0000, v173
    v_lshlrev_b32 v132, 16, v174
    v_and_b32 v133, 0xffff0000, v174
    v_lshlrev_b32 v134, 16, v175
    v_and_b32 v135, 0xffff0000, v175
    v_mul_f32 v53, v56, v54
    s_lshr_b32 s65, s3, 1
    s_mul_i32 s65, s65, 18432
    s_and_b32 s66, s3, 1
    s_lshl_b32 s66, s66, 7
    s_add_u32 s65, s65, s66
    s_add_u32 s65, s65, s51
    v_fma_f32 v64, v64, v54, -v53
    v_fma_f32 v65, v65, v54, -v53
    v_fma_f32 v66, v66, v54, -v53
    v_fma_f32 v67, v67, v54, -v53
    v_fma_f32 v68, v68, v54, -v53
    v_fma_f32 v69, v69, v54, -v53
    v_fma_f32 v70, v70, v54, -v53
    v_fma_f32 v71, v71, v54, -v53
    v_cvt_pk_bf16_f32 v140, v64, v65
    v_cvt_pk_bf16_f32 v141, v66, v67
    v_cvt_pk_bf16_f32 v142, v68, v69
    v_cvt_pk_bf16_f32 v143, v70, v71
    buffer_store_dwordx4 v[140:143], v55, s[20:23], s65 offen offset:0 sc1
    ds_write_b128 v52, v[140:143] offset:0
    v_fma_f32 v72, v72, v54, -v53
    v_fma_f32 v73, v73, v54, -v53
    v_fma_f32 v74, v74, v54, -v53
    v_fma_f32 v75, v75, v54, -v53
    v_fma_f32 v76, v76, v54, -v53
    v_fma_f32 v77, v77, v54, -v53
    v_fma_f32 v78, v78, v54, -v53
    v_fma_f32 v79, v79, v54, -v53
    v_cvt_pk_bf16_f32 v144, v72, v73
    v_cvt_pk_bf16_f32 v145, v74, v75
    v_cvt_pk_bf16_f32 v146, v76, v77
    v_cvt_pk_bf16_f32 v147, v78, v79
    buffer_store_dwordx4 v[144:147], v55, s[20:23], s65 offen offset:2048 sc1
    ds_write_b128 v52, v[144:147] offset:128
    v_fma_f32 v80, v80, v54, -v53
    v_fma_f32 v81, v81, v54, -v53
    v_fma_f32 v82, v82, v54, -v53
    v_fma_f32 v83, v83, v54, -v53
    v_fma_f32 v84, v84, v54, -v53
    v_fma_f32 v85, v85, v54, -v53
    v_fma_f32 v86, v86, v54, -v53
    v_fma_f32 v87, v87, v54, -v53
    v_cvt_pk_bf16_f32 v148, v80, v81
    v_cvt_pk_bf16_f32 v149, v82, v83
    v_cvt_pk_bf16_f32 v150, v84, v85
    v_cvt_pk_bf16_f32 v151, v86, v87
    s_add_u32 s65, s65, 4096
    buffer_store_dwordx4 v[148:151], v55, s[20:23], s65 offen offset:0 sc1
    ds_write_b128 v52, v[148:151] offset:256
    v_fma_f32 v88, v88, v54, -v53
    v_fma_f32 v89, v89, v54, -v53
    v_fma_f32 v90, v90, v54, -v53
    v_fma_f32 v91, v91, v54, -v53
    v_fma_f32 v92, v92, v54, -v53
    v_fma_f32 v93, v93, v54, -v53
    v_fma_f32 v94, v94, v54, -v53
    v_fma_f32 v95, v95, v54, -v53
    v_cvt_pk_bf16_f32 v152, v88, v89
    v_cvt_pk_bf16_f32 v153, v90, v91
    v_cvt_pk_bf16_f32 v154, v92, v93
    v_cvt_pk_bf16_f32 v155, v94, v95
    buffer_store_dwordx4 v[152:155], v55, s[20:23], s65 offen offset:2048 sc1
    ds_write_b128 v52, v[152:155] offset:384
    v_fma_f32 v96, v96, v54, -v53
    v_fma_f32 v97, v97, v54, -v53
    v_fma_f32 v98, v98, v54, -v53
    v_fma_f32 v99, v99, v54, -v53
    v_fma_f32 v100, v100, v54, -v53
    v_fma_f32 v101, v101, v54, -v53
    v_fma_f32 v102, v102, v54, -v53
    v_fma_f32 v103, v103, v54, -v53
    v_cvt_pk_bf16_f32 v156, v96, v97
    v_cvt_pk_bf16_f32 v157, v98, v99
    v_cvt_pk_bf16_f32 v158, v100, v101
    v_cvt_pk_bf16_f32 v159, v102, v103
    s_add_u32 s65, s65, 4096
    buffer_store_dwordx4 v[156:159], v55, s[20:23], s65 offen offset:0 sc1
    ds_write_b128 v52, v[156:159] offset:512
    v_fma_f32 v104, v104, v54, -v53
    v_fma_f32 v105, v105, v54, -v53
    v_fma_f32 v106, v106, v54, -v53
    v_fma_f32 v107, v107, v54, -v53
    v_fma_f32 v108, v108, v54, -v53
    v_fma_f32 v109, v109, v54, -v53
    v_fma_f32 v110, v110, v54, -v53
    v_fma_f32 v111, v111, v54, -v53
    v_cvt_pk_bf16_f32 v160, v104, v105
    v_cvt_pk_bf16_f32 v161, v106, v107
    v_cvt_pk_bf16_f32 v162, v108, v109
    v_cvt_pk_bf16_f32 v163, v110, v111
    buffer_store_dwordx4 v[160:163], v55, s[20:23], s65 offen offset:2048 sc1
    ds_write_b128 v52, v[160:163] offset:640
    v_fma_f32 v112, v112, v54, -v53
    v_fma_f32 v113, v113, v54, -v53
    v_fma_f32 v114, v114, v54, -v53
    v_fma_f32 v115, v115, v54, -v53
    v_fma_f32 v116, v116, v54, -v53
    v_fma_f32 v117, v117, v54, -v53
    v_fma_f32 v118, v118, v54, -v53
    v_fma_f32 v119, v119, v54, -v53
    v_cvt_pk_bf16_f32 v164, v112, v113
    v_cvt_pk_bf16_f32 v165, v114, v115
    v_cvt_pk_bf16_f32 v166, v116, v117
    v_cvt_pk_bf16_f32 v167, v118, v119
    s_add_u32 s65, s65, 4096
    buffer_store_dwordx4 v[164:167], v55, s[20:23], s65 offen offset:0 sc1
    ds_write_b128 v52, v[164:167] offset:768
    v_fma_f32 v120, v120, v54, -v53
    v_fma_f32 v121, v121, v54, -v53
    v_fma_f32 v122, v122, v54, -v53
    v_fma_f32 v123, v123, v54, -v53
    v_fma_f32 v124, v124, v54, -v53
    v_fma_f32 v125, v125, v54, -v53
    v_fma_f32 v126, v126, v54, -v53
    v_fma_f32 v127, v127, v54, -v53
    v_cvt_pk_bf16_f32 v168, v120, v121
    v_cvt_pk_bf16_f32 v169, v122, v123
    v_cvt_pk_bf16_f32 v170, v124, v125
    v_cvt_pk_bf16_f32 v171, v126, v127
    buffer_store_dwordx4 v[168:171], v55, s[20:23], s65 offen offset:2048 sc1
    ds_write_b128 v52, v[168:171] offset:896
    v_fma_f32 v128, v128, v54, -v53
    v_fma_f32 v129, v129, v54, -v53
    v_fma_f32 v130, v130, v54, -v53
    v_fma_f32 v131, v131, v54, -v53
    v_fma_f32 v132, v132, v54, -v53
    v_fma_f32 v133, v133, v54, -v53
    v_fma_f32 v134, v134, v54, -v53
    v_fma_f32 v135, v135, v54, -v53
    v_cvt_pk_bf16_f32 v172, v128, v129
    v_cvt_pk_bf16_f32 v173, v130, v131
    v_cvt_pk_bf16_f32 v174, v132, v133
    v_cvt_pk_bf16_f32 v175, v134, v135
    s_add_u32 s65, s65, 4096
    buffer_store_dwordx4 v[172:175], v55, s[20:23], s65 offen offset:0 sc1
    ds_write_b128 v52, v[172:175] offset:1024
    s_mul_i32 s67, s3, 288
    s_add_u32 s67, s67, 50176
    v_lshrrev_b32 v57, 4, v0
    v_bfe_u32 v58, v0, 2, 2
    v_lshl_add_u32 v58, v57, 3, v58
    v_mul_u32_u24 v58, 1312, v58
    v_and_b32 v59, 3, v0
    v_lshl_add_u32 v58, v59, 3, v58
    v_add_u32 v58, s67, v58
    v_add_u32 v59, 5248, v58
    v_and_b32 v60, 15, v0
    v_lshlrev_b32 v60, 6, v60
    v_lshl_add_u32 v60, v57, 4, v60
    s_mul_i32 s65, s3, 9216
    s_add_u32 s65, s65, s51
    s_waitcnt lgkmcnt(0)
    s_barrier
    ds_read_b64_tr_b16 v[64:65], v58 offset:0
    ds_read_b64_tr_b16 v[66:67], v59 offset:0
    ds_read_b64_tr_b16 v[68:69], v58 offset:32
    ds_read_b64_tr_b16 v[70:71], v59 offset:32
    ds_read_b64_tr_b16 v[72:73], v58 offset:64
    ds_read_b64_tr_b16 v[74:75], v59 offset:64
    ds_read_b64_tr_b16 v[76:77], v58 offset:96
    ds_read_b64_tr_b16 v[78:79], v59 offset:96
    ds_read_b64_tr_b16 v[80:81], v58 offset:128
    ds_read_b64_tr_b16 v[82:83], v59 offset:128
    ds_read_b64_tr_b16 v[84:85], v58 offset:160
    ds_read_b64_tr_b16 v[86:87], v59 offset:160
    ds_read_b64_tr_b16 v[88:89], v58 offset:192
    ds_read_b64_tr_b16 v[90:91], v59 offset:192
    s_waitcnt lgkmcnt(8)
    ds_read_b64_tr_b16 v[92:93], v58 offset:224
    ds_read_b64_tr_b16 v[94:95], v59 offset:224
    ds_read_b64_tr_b16 v[96:97], v58 offset:256
    ds_read_b64_tr_b16 v[98:99], v59 offset:256
    s_waitcnt lgkmcnt(0)
    s_add_u32 s66, s65, 0
    buffer_store_dwordx4 v[64:67], v60, s[28:31], s66 offen offset:0 sc1
    buffer_store_dwordx4 v[68:71], v60, s[28:31], s66 offen offset:1024 sc1
    buffer_store_dwordx4 v[72:75], v60, s[28:31], s66 offen offset:2048 sc1
    buffer_store_dwordx4 v[76:79], v60, s[28:31], s66 offen offset:3072 sc1
    s_add_u32 s66, s65, 4096
    buffer_store_dwordx4 v[80:83], v60, s[28:31], s66 offen offset:0 sc1
    buffer_store_dwordx4 v[84:87], v60, s[28:31], s66 offen offset:1024 sc1
    buffer_store_dwordx4 v[88:91], v60, s[28:31], s66 offen offset:2048 sc1
    buffer_store_dwordx4 v[92:95], v60, s[28:31], s66 offen offset:3072 sc1
    s_add_u32 s66, s65, 8192
    buffer_store_dwordx4 v[96:99], v60, s[28:31], s66 offen offset:0 sc1
    s_cmp_lg_u32 s3, 0
    s_cbranch_scc1 M_ln_nz
    v_mov_b32 v60, 0
    v_mov_b32 v61, 0
    v_mov_b32 v62, 0
    v_mov_b32 v63, 0
    s_lshl_b32 s65, s50, 7
    s_add_u32 s66, s65, 8192
    s_mov_b64 exec, 0xff
    buffer_store_dwordx4 v[60:63], v1, s[36:39], s65 offen sc1
    buffer_store_dwordx4 v[60:63], v1, s[36:39], s66 offen sc1
    s_mov_b64 exec, -1
M_ln_nz:
    s_waitcnt vmcnt(0) lgkmcnt(0)
    s_barrier
    s_mov_b32 s68, 0
    s_mov_b32 s72, 0
    s_cmp_lg_u32 s3, 0
    s_cbranch_scc1 M_ln_nf
    s_mov_b32 s26, 256
    s_mov_b32 s27, 0x00020000
    s_lshl_b32 s65, s50, 2
    v_mov_b32 v15, 1
    s_mov_b64 exec, 1
    buffer_store_dword v15, off, s[24:27], s65 sc1
    s_mov_b64 exec, -1
M_ln_nf:
    s_add_u32 m0, s40, 0
    s_add_u32 s48, s42, 0
    buffer_load_dwordx4 v6, s[12:15], s48 offen lds
    s_add_u32 m0, s40, 1024
    s_add_u32 s48, s42, 147456
    buffer_load_dwordx4 v6, s[12:15], s48 offen lds
    s_add_u32 m0, s40, 8192
    s_add_u32 s48, s42, 589824
    buffer_load_dwordx4 v6, s[12:15], s48 offen lds
    s_add_u32 m0, s40, 9216
    s_add_u32 s48, s42, 737280
    buffer_load_dwordx4 v6, s[12:15], s48 offen lds
    s_add_u32 m0, s40, 16384
    s_add_u32 s48, s42, 1179648
    buffer_load_dwordx4 v6, s[12:15], s48 offen lds
    s_add_u32 m0, s40, 17408
    s_add_u32 s48, s42, 1327104
    buffer_load_dwordx4 v6, s[12:15], s48 offen lds
    s_add_u32 m0, s40, 24576
    s_add_u32 s48, s42, 1769472
    buffer_load_dwordx4 v6, s[12:15], s48 offen lds
    s_add_u32 m0, s40, 25600
    s_add_u32 s48, s42, 1916928
    buffer_load_dwordx4 v6, s[12:15], s48 offen lds
    s_add_u32 m0, s40, 32768
    s_add_u32 s48, s42, 2359296
    buffer_load_dwordx4 v6, s[12:15], s48 offen lds
    s_add_u32 m0, s40, 33792
    s_add_u32 s48, s42, 2506752
    buffer_load_dwordx4 v6, s[12:15], s48 offen lds
    s_add_u32 m0, s40, 40960
    s_add_u32 s48, s42, 2949120
    buffer_load_dwordx4 v6, s[12:15], s48 offen lds
    s_add_u32 m0, s40, 41984
    s_add_u32 s48, s42, 3096576
    buffer_load_dwordx4 v6, s[12:15], s48 offen lds
    v_lshrrev_b32 v11, 4, v0
    v_bfe_u32 v12, v0, 2, 2
    v_lshl_add_u32 v12, v11, 3, v12
    v_and_b32 v13, 3, v0
    v_lshlrev_b32 v13, 3, v13
    v_and_b32 v11, 1, v11
    v_lshl_add_u32 v2, v12, 6, v13
    v_lshl_add_u32 v2, v11, 5, v2
    v_xor_b32 v3, 32, v2
    v_lshl_add_u32 v4, v12, 5, v13
    v_lshl_add_u32 v4, v11, 7, v4
    v_lshlrev_b32 v11, 8, v11
    v_sub_u32 v5, v4, v11
    v_add_u32 v5, 128, v5
    s_and_b32 s68, s64, 1
    s_lshl_b32 s66, s63, 4
    s_lshl_b32 s67, s3, 2
    s_add_u32 s66, s66, s67
    s_mul_i32 s44, s66, 18432
    s_add_u32 s69, s44, 18432
    s_add_u32 s70, s44, 36864
    s_add_u32 s71, s44, 55296
    s_lshl_b32 s67, s62, 7
    s_add_u32 s66, s66, s67
    s_mul_i32 s66, s66, 18432
    s_lshl_b32 s67, s64, 11
    s_add_u32 s45, s66, s67
    s_lshl_b32 s67, s64, 10
    s_add_u32 s67, s67, s66
    s_add_u32 s79, s67, 8192
    s_lshr_b32 s67, s64, 1
    s_lshl_b32 s67, s67, 10
    s_add_u32 s66, s66, s67
    s_lshl_b32 s67, s68, 3
    s_add_u32 s66, s66, s67
    s_add_u32 s101, s66, 16384
    s_lshl_b32 s66, s60, 8
    s_lshl_b32 s67, s58, 3
    s_add_u32 s66, s66, s67
    s_lshl_b32 s67, s3, 1
    s_add_u32 s66, s66, s67
    s_mul_i32 s75, s66, 18432
    s_add_u32 s76, s75, 18432
    s_add_u32 s77, s75, 2359296
    s_add_u32 s78, s75, 2377728
    s_mov_b32 s47, 0xbfb8aa3b
    s_mov_b32 s100, 0
    s_lshl_b32 s52, s63, 2
    s_add_u32 s52, s52, s60
    s_lshl_b32 s52, s52, 7
    s_lshl_b32 s53, s58, 2
    s_add_u32 s53, s53, s64
    s_lshl_b32 s53, s53, 7
    s_add_u32 s53, s53, 4096
    s_min_u32 s65, s3, 2
    s_mul_i32 s51, s65, 21248
    s_add_u32 s51, s51, 99840
    v_and_b32 v11, 3, v0
    v_sub_u32 v11, 3, v11
    v_mul_u32_u24 v8, 4160, v11
    v_bfe_u32 v11, v0, 2, 2
    v_lshlrev_b32 v11, 3, v11
    v_sub_u32 v8, v8, v11
    v_bfe_u32 v11, v0, 4, 1
    v_lshlrev_b32 v11, 4, v11
    v_lshrrev_b32 v12, 5, v0
    v_lshlrev_b32 v12, 5, v12
    v_sub_u32 v11, v11, v12
    v_add_u32 v8, v8, v11
    v_add_u32 v8, 56, v8
    v_add_u32 v8, s51, v8
    v_and_b32 v12, 15, v0
    v_lshl_add_u32 v9, v12, 5, v11
    v_add_u32 v9, 16704, v9
    v_add_u32 v9, s51, v9
    v_lshlrev_b32 v10, 5, v12
    v_lshrrev_b32 v12, 4, v0
    v_lshl_add_u32 v10, v12, 3, v10
    s_mov_b32 s68, 0
    s_branch M_pre
M_k:
    s_load_dwordx2 s[16:17], s[0:1], 8
    s_load_dwordx2 s[20:21], s[0:1], 16
    s_load_dwordx2 s[24:25], s[0:1], 24
    s_load_dwordx2 s[28:29], s[0:1], 32
    s_load_dwordx2 s[32:33], s[0:1], 40
    s_load_dwordx2 s[36:37], s[0:1], 48
    s_mov_b32 s18, 147456
    s_mov_b32 s19, 0x00020000
    s_mov_b32 s22, 147456
    s_mov_b32 s23, 0x00020000
    s_mov_b32 s26, 147456
    s_mov_b32 s27, 0x00020000
    s_mov_b32 s30, 147456
    s_mov_b32 s31, 0x00020000
    s_mov_b32 s34, 1152
    s_mov_b32 s35, 0x00020000
    s_mov_b32 s38, 1152
    s_mov_b32 s39, 0x00020000
    s_and_b32 s65, s2, 7
    s_mul_i32 s65, s65, 24
    s_lshr_b32 s66, s2, 3
    s_add_u32 s65, s65, s66
    s_sub_u32 s65, s65, 8
    s_mul_i32 s50, s65, 3
    s_and_b32 s65, s3, 1
    s_lshl_b32 s65, s65, 6
    v_add_u32 v92, s65, v0
    s_lshl_b32 s66, s50, 8
    v_lshlrev_b32 v93, 1, v92
    v_add_u32 v93, s66, v93
    s_lshl_b32 s66, s50, 1
    v_mov_b32 v94, s66
    s_waitcnt lgkmcnt(0)
    buffer_load_ushort v52, v94, s[32:35], 0 offen offset:0
    buffer_load_ushort v48, v93, s[16:19], 0 offen offset:0
    buffer_load_ushort v49, v93, s[20:23], 0 offen offset:0
    buffer_load_ushort v50, v93, s[24:27], 0 offen offset:0
    buffer_load_ushort v51, v93, s[28:31], 0 offen offset:0
    buffer_load_ushort v53, v94, s[36:39], 0 offen offset:0
    buffer_load_ushort v60, v94, s[32:35], 0 offen offset:2
    buffer_load_ushort v56, v93, s[16:19], 0 offen offset:256
    buffer_load_ushort v57, v93, s[20:23], 0 offen offset:256
    buffer_load_ushort v58, v93, s[24:27], 0 offen offset:256
    buffer_load_ushort v59, v93, s[28:31], 0 offen offset:256
    buffer_load_ushort v61, v94, s[36:39], 0 offen offset:2
    buffer_load_ushort v68, v94, s[32:35], 0 offen offset:4
    buffer_load_ushort v64, v93, s[16:19], 0 offen offset:512
    buffer_load_ushort v65, v93, s[20:23], 0 offen offset:512
    buffer_load_ushort v66, v93, s[24:27], 0 offen offset:512
    buffer_load_ushort v67, v93, s[28:31], 0 offen offset:512
    buffer_load_ushort v69, v94, s[36:39], 0 offen offset:4
    s_and_b32 s60, s2, 3
    s_lshr_b32 s65, s2, 3
    s_and_b32 s64, s65, 3
    s_bfe_u32 s66, s65, 0x10002
    s_lshr_b32 s63, s65, 3
    s_and_b32 s67, s2, 4
    s_add_u32 s63, s63, s67
    s_lshl_b32 s62, s60, 1
    s_add_u32 s62, s62, s66
    s_lshl_b32 s58, s63, 1
    s_add_u32 s58, s58, s66
    v_lshrrev_b32 v11, 2, v0
    v_mul_u32_u24 v6, 9216, v11
    v_lshrrev_b32 v11, 4, v0
    v_and_b32 v11, 2, v11
    v_and_b32 v12, 3, v0
    v_xor_b32 v11, v11, v12
    v_lshl_add_u32 v6, v11, 4, v6
    v_lshrrev_b32 v11, 1, v0
    v_lshrrev_b32 v12, 1, v11
    v_and_b32 v12, 4, v12
    v_xor_b32 v11, v11, v12
    v_mul_u32_u24 v7, 9216, v11
    v_and_b32 v11, 1, v0
    v_lshl_add_u32 v7, v11, 4, v7
    s_and_b32 s65, s3, 1
    s_lshr_b32 s66, s3, 1
    s_lshl_b32 s40, s66, 12
    s_lshl_b32 s67, s65, 11
    s_add_u32 s40, s40, s67
    s_lshl_b32 s41, s66, 11
    s_lshl_b32 s67, s65, 10
    s_add_u32 s41, s41, s67
    s_mul_i32 s42, s62, 1152
    s_mul_i32 s67, s64, 288
    s_add_u32 s42, s42, s67
    s_mul_i32 s67, s66, 294912
    s_add_u32 s42, s42, s67
    s_and_b32 s68, s64, 1
    s_xor_b32 s67, s68, 1
    s_lshl_b32 s67, s67, 8
    s_add_u32 s43, s42, s67
    s_lshl_b32 s67, s68, 5
    s_add_u32 s42, s42, s67
    s_and_b32 s65, s3, 1
    s_cmp_eq_u32 s65, 0
    s_cselect_b32 s12, s6, s8
    s_cselect_b32 s13, s7, s9
    s_mov_b32 s14, 5308416
    s_mov_b32 s15, 0x00020000
    s_lshr_b32 s65, s2, 3
    s_sub_u32 s65, s65, 8
    s_lshl_b32 s65, s65, 1
    s_lshr_b32 s66, s3, 1
    s_add_u32 s65, s65, s66
    s_mul_i32 s65, s65, 48
    v_min_u32 v240, 47, v0
    v_add_u32 v240, s65, v240
    v_lshrrev_b32 v241, 3, v240
    v_mul_u32_u24 v241, 9216, v241
    v_bfe_u32 v242, v240, 2, 1
    v_mul_u32_u24 v242, 1152, v242
    v_add_u32 v241, v241, v242
    v_and_b32 v242, 3, v240
    v_lshlrev_b32 v243, 1, v242
    v_cmp_eq_u32 vcc, 3, v242
    s_bfe_u32 s66, s2, 0x10002
    s_mul_i32 s66, s66, 2654208
    v_addc_co_u32 v243, vcc, 0, v243, vcc
    v_lshl_add_u32 v241, v243, 7, v241
    s_mul_i32 s67, s60, 2304
    s_add_u32 s66, s66, s67
    v_add_u32 v241, s66, v241
    s_lshr_b32 s65, s3, 1
    s_cmp_eq_u32 s65, 0
    s_mov_b32 s21, 0x41800000
    s_cselect_b32 s20, 1.0, 4.0
    s_cselect_b32 s21, s21, 0x42800000
    s_cselect_b32 s22, 0, 0x44000000
    s_mov_b32 s23, 0x43800000
    s_cselect_b32 s23, s23, 0x44c00000
    s_mov_b32 s24, 0x3fb8aa3b
    s_mov_b32 s25, 0x326558db
    s_mov_b32 s26, 0x3f317218
    s_mul_i32 s66, s65, 8448
    s_add_u32 s66, s66, 49152
    s_mul_i32 s67, s65, 16896
    s_add_u32 s67, s67, 66048
    v_lshlrev_b32 v72, 2, v92
    v_add_u32 v73, s67, v72
    v_add_u32 v72, s66, v72
    s_waitcnt vmcnt(0)
    buffer_load_dword v249, v241, s[12:15], 0 offen
    v_lshlrev_b32 v48, 16, v48
    v_lshlrev_b32 v49, 16, v49
    v_lshlrev_b32 v50, 16, v50
    v_lshlrev_b32 v51, 16, v51
    v_lshlrev_b32 v52, 16, v52
    v_lshlrev_b32 v53, 16, v53
    v_mul_f32 v92, s24, v52
    v_fma_f32 v93, s24, v52, -v92
    v_exp_f32 v92, v92
    v_mul_f32 v93, s26, v93
    v_fmac_f32 v93, s25, v52
    v_fma_f32 v52, v92, v93, v92
    v_cvt_pk_bf16_f32 v52, v52, v52
    v_lshlrev_b32 v52, 16, v52
    v_mul_f32 v94, s24, v48
    v_fma_f32 v95, s24, v48, -v94
    v_exp_f32 v94, v94
    v_mul_f32 v95, s26, v95
    v_fmac_f32 v95, s25, v48
    v_fma_f32 v48, v94, v95, v94
    v_cvt_pk_bf16_f32 v48, v48, v48
    v_lshlrev_b32 v48, 16, v48
    v_mul_f32 v48, v48, v52
    v_mul_f32 v49, v49, v52
    v_mul_f32 v50, v50, v52
    v_mul_f32 v51, v51, v52
    v_mul_f32 v48, 0xbfb8aa3b, v48
    v_mul_f32 v49, 0.15915494, v49
    v_add_f32 v50, v50, v50
    v_add_f32 v51, v51, v51
    v_mul_f32 v92, s20, v48
    v_mul_f32 v93, s20, v49
    v_exp_f32 v92, v92
    v_fract_f32 v93, v93
    s_nop 0
    v_cos_f32 v100, v93
    v_sin_f32 v101, v93
    s_nop 0
    v_mul_f32 v100, v100, v92
    v_mul_f32 v101, v101, v92
    v_mul_f32 v94, s21, v48
    v_mul_f32 v95, s21, v49
    v_exp_f32 v94, v94
    v_fract_f32 v95, v95
    s_nop 0
    v_cos_f32 v102, v95
    v_sin_f32 v103, v95
    s_nop 0
    v_mul_f32 v102, v102, v94
    v_mul_f32 v103, v103, v94
    v_mul_f32 v92, s22, v48
    v_mul_f32 v93, s22, v49
    v_exp_f32 v92, v92
    v_fract_f32 v93, v93
    s_nop 0
    v_cos_f32 v104, v93
    v_sin_f32 v105, v93
    s_nop 0
    v_mul_f32 v104, v104, v92
    v_mul_f32 v105, v105, v92
    v_mul_f32 v106, v50, v104
    v_mul_f32 v107, v50, v105
    v_fma_f32 v106, -v51, v105, v106
    v_fmac_f32 v107, v51, v104
    v_mul_f32 v92, s23, v48
    v_mul_f32 v93, s23, v49
    v_exp_f32 v92, v92
    v_fract_f32 v93, v93
    s_nop 0
    v_cos_f32 v104, v93
    v_sin_f32 v105, v93
    s_nop 0
    v_mul_f32 v104, v104, v92
    v_mul_f32 v105, v105, v92
    v_mul_f32 v232, v50, v104
    v_mul_f32 v233, v50, v105
    v_fma_f32 v232, -v51, v105, v232
    v_fmac_f32 v233, v51, v104
    v_mov_b32 v110, 1.0
    v_mov_b32 v111, 0
    v_pk_mul_f32 v[108:109], v[106:107], v[102:103] op_sel_hi:[0,1]
    v_pk_mul_f32 v[112:113], v[110:111], v[100:101] op_sel_hi:[0,1]
    v_pk_mul_f32 v[234:235], v[232:233], v[102:103] op_sel_hi:[0,1]
    v_cvt_pk_bf16_f32 v220, v106, -v107
    v_cvt_pk_bf16_f32 v221, v110, v111
    v_cvt_pk_bf16_f32 v222, v232, -v233
    v_pk_fma_f32 v[108:109], v[106:107], v[102:103], v[108:109] op_sel:[1,1,0] op_sel_hi:[1,0,1] neg_lo:[0,1,0]
    v_pk_fma_f32 v[112:113], v[110:111], v[100:101], v[112:113] op_sel:[1,1,0] op_sel_hi:[1,0,1] neg_lo:[0,1,0]
    v_pk_fma_f32 v[234:235], v[232:233], v[102:103], v[234:235] op_sel:[1,1,0] op_sel_hi:[1,0,1] neg_lo:[0,1,0]
    ds_write_b32 v73, v220 offset:0
    ds_write_b32 v72, v221 offset:0
    ds_write_b32 v73, v222 offset:8448
    v_pk_mul_f32 v[106:107], v[108:109], v[102:103] op_sel_hi:[0,1]
    v_pk_mul_f32 v[110:111], v[112:113], v[100:101] op_sel_hi:[0,1]
    v_pk_mul_f32 v[232:233], v[234:235], v[102:103] op_sel_hi:[0,1]
    v_cvt_pk_bf16_f32 v224, v108, -v109
    v_cvt_pk_bf16_f32 v225, v112, v113
    v_cvt_pk_bf16_f32 v226, v234, -v235
    v_pk_fma_f32 v[106:107], v[108:109], v[102:103], v[106:107] op_sel:[1,1,0] op_sel_hi:[1,0,1] neg_lo:[0,1,0]
    v_pk_fma_f32 v[110:111], v[112:113], v[100:101], v[110:111] op_sel:[1,1,0] op_sel_hi:[1,0,1] neg_lo:[0,1,0]
    v_pk_fma_f32 v[232:233], v[234:235], v[102:103], v[232:233] op_sel:[1,1,0] op_sel_hi:[1,0,1] neg_lo:[0,1,0]
    ds_write_b32 v73, v224 offset:528
    ds_write_b32 v72, v225 offset:528
    ds_write_b32 v73, v226 offset:8976
    v_pk_mul_f32 v[108:109], v[106:107], v[102:103] op_sel_hi:[0,1]
    v_pk_mul_f32 v[112:113], v[110:111], v[100:101] op_sel_hi:[0,1]
    v_pk_mul_f32 v[234:235], v[232:233], v[102:103] op_sel_hi:[0,1]
    v_cvt_pk_bf16_f32 v220, v106, -v107
    v_cvt_pk_bf16_f32 v221, v110, v111
    v_cvt_pk_bf16_f32 v222, v232, -v233
    v_pk_fma_f32 v[108:109], v[106:107], v[102:103], v[108:109] op_sel:[1,1,0] op_sel_hi:[1,0,1] neg_lo:[0,1,0]
    v_pk_fma_f32 v[112:113], v[110:111], v[100:101], v[112:113] op_sel:[1,1,0] op_sel_hi:[1,0,1] neg_lo:[0,1,0]
    v_pk_fma_f32 v[234:235], v[232:233], v[102:103], v[234:235] op_sel:[1,1,0] op_sel_hi:[1,0,1] neg_lo:[0,1,0]
    ds_write_b32 v73, v220 offset:1056
    ds_write_b32 v72, v221 offset:1056
    ds_write_b32 v73, v222 offset:9504
    v_pk_mul_f32 v[106:107], v[108:109], v[102:103] op_sel_hi:[0,1]
    v_pk_mul_f32 v[110:111], v[112:113], v[100:101] op_sel_hi:[0,1]
    v_pk_mul_f32 v[232:233], v[234:235], v[102:103] op_sel_hi:[0,1]
    v_cvt_pk_bf16_f32 v224, v108, -v109
    v_cvt_pk_bf16_f32 v225, v112, v113
    v_cvt_pk_bf16_f32 v226, v234, -v235
    v_pk_fma_f32 v[106:107], v[108:109], v[102:103], v[106:107] op_sel:[1,1,0] op_sel_hi:[1,0,1] neg_lo:[0,1,0]
    v_pk_fma_f32 v[110:111], v[112:113], v[100:101], v[110:111] op_sel:[1,1,0] op_sel_hi:[1,0,1] neg_lo:[0,1,0]
    v_pk_fma_f32 v[232:233], v[234:235], v[102:103], v[232:233] op_sel:[1,1,0] op_sel_hi:[1,0,1] neg_lo:[0,1,0]
    ds_write_b32 v73, v224 offset:1584
    ds_write_b32 v72, v225 offset:1584
    ds_write_b32 v73, v226 offset:10032
    v_pk_mul_f32 v[108:109], v[106:107], v[102:103] op_sel_hi:[0,1]
    v_pk_mul_f32 v[112:113], v[110:111], v[100:101] op_sel_hi:[0,1]
    v_pk_mul_f32 v[234:235], v[232:233], v[102:103] op_sel_hi:[0,1]
    v_cvt_pk_bf16_f32 v220, v106, -v107
    v_cvt_pk_bf16_f32 v221, v110, v111
    v_cvt_pk_bf16_f32 v222, v232, -v233
    v_pk_fma_f32 v[108:109], v[106:107], v[102:103], v[108:109] op_sel:[1,1,0] op_sel_hi:[1,0,1] neg_lo:[0,1,0]
    v_pk_fma_f32 v[112:113], v[110:111], v[100:101], v[112:113] op_sel:[1,1,0] op_sel_hi:[1,0,1] neg_lo:[0,1,0]
    v_pk_fma_f32 v[234:235], v[232:233], v[102:103], v[234:235] op_sel:[1,1,0] op_sel_hi:[1,0,1] neg_lo:[0,1,0]
    ds_write_b32 v73, v220 offset:2112
    ds_write_b32 v72, v221 offset:2112
    ds_write_b32 v73, v222 offset:10560
    v_pk_mul_f32 v[106:107], v[108:109], v[102:103] op_sel_hi:[0,1]
    v_pk_mul_f32 v[110:111], v[112:113], v[100:101] op_sel_hi:[0,1]
    v_pk_mul_f32 v[232:233], v[234:235], v[102:103] op_sel_hi:[0,1]
    v_cvt_pk_bf16_f32 v224, v108, -v109
    v_cvt_pk_bf16_f32 v225, v112, v113
    v_cvt_pk_bf16_f32 v226, v234, -v235
    v_pk_fma_f32 v[106:107], v[108:109], v[102:103], v[106:107] op_sel:[1,1,0] op_sel_hi:[1,0,1] neg_lo:[0,1,0]
    v_pk_fma_f32 v[110:111], v[112:113], v[100:101], v[110:111] op_sel:[1,1,0] op_sel_hi:[1,0,1] neg_lo:[0,1,0]
    v_pk_fma_f32 v[232:233], v[234:235], v[102:103], v[232:233] op_sel:[1,1,0] op_sel_hi:[1,0,1] neg_lo:[0,1,0]
    ds_write_b32 v73, v224 offset:2640
    ds_write_b32 v72, v225 offset:2640
    ds_write_b32 v73, v226 offset:11088
    v_pk_mul_f32 v[108:109], v[106:107], v[102:103] op_sel_hi:[0,1]
    v_pk_mul_f32 v[112:113], v[110:111], v[100:101] op_sel_hi:[0,1]
    v_pk_mul_f32 v[234:235], v[232:233], v[102:103] op_sel_hi:[0,1]
    v_cvt_pk_bf16_f32 v220, v106, -v107
    v_cvt_pk_bf16_f32 v221, v110, v111
    v_cvt_pk_bf16_f32 v222, v232, -v233
    v_pk_fma_f32 v[108:109], v[106:107], v[102:103], v[108:109] op_sel:[1,1,0] op_sel_hi:[1,0,1] neg_lo:[0,1,0]
    v_pk_fma_f32 v[112:113], v[110:111], v[100:101], v[112:113] op_sel:[1,1,0] op_sel_hi:[1,0,1] neg_lo:[0,1,0]
    v_pk_fma_f32 v[234:235], v[232:233], v[102:103], v[234:235] op_sel:[1,1,0] op_sel_hi:[1,0,1] neg_lo:[0,1,0]
    ds_write_b32 v73, v220 offset:3168
    ds_write_b32 v72, v221 offset:3168
    ds_write_b32 v73, v222 offset:11616
    v_pk_mul_f32 v[106:107], v[108:109], v[102:103] op_sel_hi:[0,1]
    v_pk_mul_f32 v[110:111], v[112:113], v[100:101] op_sel_hi:[0,1]
    v_pk_mul_f32 v[232:233], v[234:235], v[102:103] op_sel_hi:[0,1]
    v_cvt_pk_bf16_f32 v224, v108, -v109
    v_cvt_pk_bf16_f32 v225, v112, v113
    v_cvt_pk_bf16_f32 v226, v234, -v235
    v_pk_fma_f32 v[106:107], v[108:109], v[102:103], v[106:107] op_sel:[1,1,0] op_sel_hi:[1,0,1] neg_lo:[0,1,0]
    v_pk_fma_f32 v[110:111], v[112:113], v[100:101], v[110:111] op_sel:[1,1,0] op_sel_hi:[1,0,1] neg_lo:[0,1,0]
    v_pk_fma_f32 v[232:233], v[234:235], v[102:103], v[232:233] op_sel:[1,1,0] op_sel_hi:[1,0,1] neg_lo:[0,1,0]
    ds_write_b32 v73, v224 offset:3696
    ds_write_b32 v72, v225 offset:3696
    ds_write_b32 v73, v226 offset:12144
    v_pk_mul_f32 v[108:109], v[106:107], v[102:103] op_sel_hi:[0,1]
    v_pk_mul_f32 v[112:113], v[110:111], v[100:101] op_sel_hi:[0,1]
    v_pk_mul_f32 v[234:235], v[232:233], v[102:103] op_sel_hi:[0,1]
    v_cvt_pk_bf16_f32 v220, v106, -v107
    v_cvt_pk_bf16_f32 v221, v110, v111
    v_cvt_pk_bf16_f32 v222, v232, -v233
    v_pk_fma_f32 v[108:109], v[106:107], v[102:103], v[108:109] op_sel:[1,1,0] op_sel_hi:[1,0,1] neg_lo:[0,1,0]
    v_pk_fma_f32 v[112:113], v[110:111], v[100:101], v[112:113] op_sel:[1,1,0] op_sel_hi:[1,0,1] neg_lo:[0,1,0]
    v_pk_fma_f32 v[234:235], v[232:233], v[102:103], v[234:235] op_sel:[1,1,0] op_sel_hi:[1,0,1] neg_lo:[0,1,0]
    ds_write_b32 v73, v220 offset:4224
    ds_write_b32 v72, v221 offset:4224
    ds_write_b32 v73, v222 offset:12672
    v_pk_mul_f32 v[106:107], v[108:109], v[102:103] op_sel_hi:[0,1]
    v_pk_mul_f32 v[110:111], v[112:113], v[100:101] op_sel_hi:[0,1]
    v_pk_mul_f32 v[232:233], v[234:235], v[102:103] op_sel_hi:[0,1]
    v_cvt_pk_bf16_f32 v224, v108, -v109
    v_cvt_pk_bf16_f32 v225, v112, v113
    v_cvt_pk_bf16_f32 v226, v234, -v235
    v_pk_fma_f32 v[106:107], v[108:109], v[102:103], v[106:107] op_sel:[1,1,0] op_sel_hi:[1,0,1] neg_lo:[0,1,0]
    v_pk_fma_f32 v[110:111], v[112:113], v[100:101], v[110:111] op_sel:[1,1,0] op_sel_hi:[1,0,1] neg_lo:[0,1,0]
    v_pk_fma_f32 v[232:233], v[234:235], v[102:103], v[232:233] op_sel:[1,1,0] op_sel_hi:[1,0,1] neg_lo:[0,1,0]
    ds_write_b32 v73, v224 offset:4752
    ds_write_b32 v72, v225 offset:4752
    ds_write_b32 v73, v226 offset:13200
    v_pk_mul_f32 v[108:109], v[106:107], v[102:103] op_sel_hi:[0,1]
    v_pk_mul_f32 v[112:113], v[110:111], v[100:101] op_sel_hi:[0,1]
    v_pk_mul_f32 v[234:235], v[232:233], v[102:103] op_sel_hi:[0,1]
    v_cvt_pk_bf16_f32 v220, v106, -v107
    v_cvt_pk_bf16_f32 v221, v110, v111
    v_cvt_pk_bf16_f32 v222, v232, -v233
    v_pk_fma_f32 v[108:109], v[106:107], v[102:103], v[108:109] op_sel:[1,1,0] op_sel_hi:[1,0,1] neg_lo:[0,1,0]
    v_pk_fma_f32 v[112:113], v[110:111], v[100:101], v[112:113] op_sel:[1,1,0] op_sel_hi:[1,0,1] neg_lo:[0,1,0]
    v_pk_fma_f32 v[234:235], v[232:233], v[102:103], v[234:235] op_sel:[1,1,0] op_sel_hi:[1,0,1] neg_lo:[0,1,0]
    ds_write_b32 v73, v220 offset:5280
    ds_write_b32 v72, v221 offset:5280
    ds_write_b32 v73, v222 offset:13728
    v_pk_mul_f32 v[106:107], v[108:109], v[102:103] op_sel_hi:[0,1]
    v_pk_mul_f32 v[110:111], v[112:113], v[100:101] op_sel_hi:[0,1]
    v_pk_mul_f32 v[232:233], v[234:235], v[102:103] op_sel_hi:[0,1]
    v_cvt_pk_bf16_f32 v224, v108, -v109
    v_cvt_pk_bf16_f32 v225, v112, v113
    v_cvt_pk_bf16_f32 v226, v234, -v235
    v_pk_fma_f32 v[106:107], v[108:109], v[102:103], v[106:107] op_sel:[1,1,0] op_sel_hi:[1,0,1] neg_lo:[0,1,0]
    v_pk_fma_f32 v[110:111], v[112:113], v[100:101], v[110:111] op_sel:[1,1,0] op_sel_hi:[1,0,1] neg_lo:[0,1,0]
    v_pk_fma_f32 v[232:233], v[234:235], v[102:103], v[232:233] op_sel:[1,1,0] op_sel_hi:[1,0,1] neg_lo:[0,1,0]
    ds_write_b32 v73, v224 offset:5808
    ds_write_b32 v72, v225 offset:5808
    ds_write_b32 v73, v226 offset:14256
    v_pk_mul_f32 v[108:109], v[106:107], v[102:103] op_sel_hi:[0,1]
    v_pk_mul_f32 v[112:113], v[110:111], v[100:101] op_sel_hi:[0,1]
    v_pk_mul_f32 v[234:235], v[232:233], v[102:103] op_sel_hi:[0,1]
    v_cvt_pk_bf16_f32 v220, v106, -v107
    v_cvt_pk_bf16_f32 v221, v110, v111
    v_cvt_pk_bf16_f32 v222, v232, -v233
    v_pk_fma_f32 v[108:109], v[106:107], v[102:103], v[108:109] op_sel:[1,1,0] op_sel_hi:[1,0,1] neg_lo:[0,1,0]
    v_pk_fma_f32 v[112:113], v[110:111], v[100:101], v[112:113] op_sel:[1,1,0] op_sel_hi:[1,0,1] neg_lo:[0,1,0]
    v_pk_fma_f32 v[234:235], v[232:233], v[102:103], v[234:235] op_sel:[1,1,0] op_sel_hi:[1,0,1] neg_lo:[0,1,0]
    ds_write_b32 v73, v220 offset:6336
    ds_write_b32 v72, v221 offset:6336
    ds_write_b32 v73, v222 offset:14784
    v_pk_mul_f32 v[106:107], v[108:109], v[102:103] op_sel_hi:[0,1]
    v_pk_mul_f32 v[110:111], v[112:113], v[100:101] op_sel_hi:[0,1]
    v_pk_mul_f32 v[232:233], v[234:235], v[102:103] op_sel_hi:[0,1]
    v_cvt_pk_bf16_f32 v224, v108, -v109
    v_cvt_pk_bf16_f32 v225, v112, v113
    v_cvt_pk_bf16_f32 v226, v234, -v235
    v_pk_fma_f32 v[106:107], v[108:109], v[102:103], v[106:107] op_sel:[1,1,0] op_sel_hi:[1,0,1] neg_lo:[0,1,0]
    v_pk_fma_f32 v[110:111], v[112:113], v[100:101], v[110:111] op_sel:[1,1,0] op_sel_hi:[1,0,1] neg_lo:[0,1,0]
    v_pk_fma_f32 v[232:233], v[234:235], v[102:103], v[232:233] op_sel:[1,1,0] op_sel_hi:[1,0,1] neg_lo:[0,1,0]
    ds_write_b32 v73, v224 offset:6864
    ds_write_b32 v72, v225 offset:6864
    ds_write_b32 v73, v226 offset:15312
    v_pk_mul_f32 v[108:109], v[106:107], v[102:103] op_sel_hi:[0,1]
    v_pk_mul_f32 v[112:113], v[110:111], v[100:101] op_sel_hi:[0,1]
    v_pk_mul_f32 v[234:235], v[232:233], v[102:103] op_sel_hi:[0,1]
    v_cvt_pk_bf16_f32 v220, v106, -v107
    v_cvt_pk_bf16_f32 v221, v110, v111
    v_cvt_pk_bf16_f32 v222, v232, -v233
    v_pk_fma_f32 v[108:109], v[106:107], v[102:103], v[108:109] op_sel:[1,1,0] op_sel_hi:[1,0,1] neg_lo:[0,1,0]
    v_pk_fma_f32 v[112:113], v[110:111], v[100:101], v[112:113] op_sel:[1,1,0] op_sel_hi:[1,0,1] neg_lo:[0,1,0]
    v_pk_fma_f32 v[234:235], v[232:233], v[102:103], v[234:235] op_sel:[1,1,0] op_sel_hi:[1,0,1] neg_lo:[0,1,0]
    ds_write_b32 v73, v220 offset:7392
    ds_write_b32 v72, v221 offset:7392
    ds_write_b32 v73, v222 offset:15840
    v_cvt_pk_bf16_f32 v224, v108, -v109
    v_cvt_pk_bf16_f32 v225, v112, v113
    v_cvt_pk_bf16_f32 v226, v234, -v235
    ds_write_b32 v73, v224 offset:7920
    ds_write_b32 v72, v225 offset:7920
    ds_write_b32 v73, v226 offset:16368
    s_lshr_b32 s65, s3, 1
    s_mul_i32 s66, s65, 8448
    s_add_u32 s66, s66, 49152
    v_and_b32 v92, 15, v0
    v_lshrrev_b32 v93, 4, v0
    v_mul_u32_u24 v74, 528, v92
    v_lshl_add_u32 v74, v93, 4, v74
    s_mul_i32 s67, s3, 8448
    s_add_u32 s67, s67, 66048
    v_add_u32 v75, s67, v74
    v_add_u32 v74, s66, v74
    s_lshl_b32 s67, s3, 10
    s_add_u32 s67, s67, 159488
    v_lshlrev_b32 v76, 6, v92
    v_lshl_add_u32 v76, v93, 4, v76
    v_add_u32 v76, s67, v76
    s_lshl_b32 s67, s3, 6
    v_add_u32 v94, s67, v0
    v_lshlrev_b32 v77, 4, v94
    v_add_u32 v77, 99840, v77
    v_lshlrev_b32 v94, 3, v94
    s_min_u32 s65, s3, 2
    s_mul_i32 s51, s65, 21248
    s_add_u32 s51, s51, 99840
    v_mov_b32 v200, 0
    v_mov_b32 v201, 0
    v_mov_b32 v202, 0
    v_mov_b32 v203, 0
    v_add_u32 v11, 16640, v1
    v_bfe_u32 v12, v0, 2, 2
    v_mul_u32_u24 v12, 4160, v12
    v_and_b32 v13, 3, v0
    v_lshl_add_u32 v12, v13, 4, v12
    v_add_u32 v12, 4096, v12
    v_cmp_gt_u32 vcc, 32, v0
    s_nop 1
    v_cndmask_b32 v11, v12, v11, vcc
    v_add_u32 v11, s51, v11
    ds_write_b128 v11, v[200:203]
    s_bfe_u32 s66, s2, 0x10002
    s_mul_i32 s66, s66, 2654208
    s_mul_i32 s67, s60, 2304
    s_add_u32 s66, s66, s67
    s_lshr_b32 s65, s2, 3
    s_sub_u32 s65, s65, 8
    s_lshl_b32 s65, s65, 1
    s_lshr_b32 s67, s3, 1
    s_add_u32 s65, s65, s67
    v_min_u32 v240, 23, v0
    s_mul_i32 s48, s65, 24
    v_add_u32 v240, s48, v240
    v_lshrrev_b32 v242, 2, v240
    v_mul_u32_u24 v244, 9216, v242
    v_bfe_u32 v242, v240, 1, 1
    v_mul_u32_u24 v242, 1152, v242
    v_add_u32 v244, v244, v242
    v_and_b32 v242, 1, v240
    v_mul_u32_u24 v242, 256, v242
    v_add_u32 v244, v244, v242
    s_add_u32 s48, s66, 384
    v_add_u32 v244, s48, v244
    v_min_u32 v240, 23, v0
    s_mul_i32 s48, s65, 24
    v_add_u32 v240, s48, v240
    v_lshrrev_b32 v242, 2, v240
    v_mul_u32_u24 v245, 9216, v242
    v_bfe_u32 v242, v240, 1, 1
    v_mul_u32_u24 v242, 1152, v242
    v_add_u32 v245, v245, v242
    v_and_b32 v242, 1, v240
    v_mul_u32_u24 v242, 896, v242
    v_add_u32 v245, v245, v242
    s_add_u32 s48, s66, 128
    v_add_u32 v245, s48, v245
    v_min_u32 v240, 23, v0
    s_mul_i32 s48, s65, 24
    v_add_u32 v240, s48, v240
    v_lshrrev_b32 v242, 2, v240
    v_mul_u32_u24 v246, 9216, v242
    v_bfe_u32 v242, v240, 1, 1
    v_mul_u32_u24 v242, 1152, v242
    v_add_u32 v246, v246, v242
    v_and_b32 v242, 1, v240
    v_mul_u32_u24 v242, 0, v242
    v_add_u32 v246, v246, v242
    s_add_u32 s48, s66, 768
    v_add_u32 v246, s48, v246
    s_lshr_b32 s65, s2, 3
    s_sub_u32 s65, s65, 8
    s_lshl_b32 s65, s65, 2
    s_add_u32 s65, s65, s3
    s_mul_i32 s65, s65, 54
    v_min_u32 v240, 53, v0
    v_add_u32 v240, s65, v240
    v_lshlrev_b32 v247, 7, v240
    s_bfe_u32 s66, s2, 0x10002
    s_mul_i32 s66, s66, 663552
    s_mul_i32 s67, s60, 1327104
    s_add_u32 s66, s66, s67
    v_add_u32 v247, s66, v247
    s_mov_b32 s16, s10
    s_mov_b32 s17, s11
    s_mov_b32 s18, 5308416
    s_mov_b32 s19, 0x00020000
    s_load_dwordx2 s[32:33], s[0:1], 96
    s_mov_b32 s34, 256
    s_mov_b32 s35, 0x00020000
    s_mov_b32 s72, 0
    s_add_u32 s36, s4, 7151616
    s_addc_u32 s37, s5, 0
    s_mov_b32 s38, 2359296
    s_mov_b32 s39, 0x00020000
    s_waitcnt lgkmcnt(0)
    s_barrier
    s_add_u32 m0, s40, 0
    s_add_u32 s48, s42, 0
    buffer_load_dwordx4 v6, s[12:15], s48 offen lds
    s_add_u32 m0, s40, 1024
    s_add_u32 s48, s42, 147456
    buffer_load_dwordx4 v6, s[12:15], s48 offen lds
    s_add_u32 m0, s40, 8192
    s_add_u32 s48, s42, 589824
    buffer_load_dwordx4 v6, s[12:15], s48 offen lds
    s_add_u32 m0, s40, 9216
    s_add_u32 s48, s42, 737280
    buffer_load_dwordx4 v6, s[12:15], s48 offen lds
    buffer_load_dword v249, v244, s[12:15], 0 offen
    buffer_load_dword v249, v247, s[16:19], 0 offen
    ds_read_b128 v[120:123], v74 offset:0
    ds_read_b128 v[152:155], v75 offset:0
    ds_read_b128 v[124:127], v74 offset:64
    ds_read_b128 v[156:159], v75 offset:64
    ds_read_b128 v[128:131], v74 offset:128
    ds_read_b128 v[160:163], v75 offset:128
    ds_read_b128 v[132:135], v74 offset:192
    ds_read_b128 v[164:167], v75 offset:192
    ds_read_b128 v[136:139], v74 offset:256
    ds_read_b128 v[168:171], v75 offset:256
    ds_read_b128 v[140:143], v74 offset:320
    ds_read_b128 v[172:175], v75 offset:320
    ds_read_b128 v[144:147], v74 offset:384
    ds_read_b128 v[176:179], v75 offset:384
    ds_read_b128 v[148:151], v74 offset:448
    ds_read_b128 v[180:183], v75 offset:448
    v_lshlrev_b32 v56, 16, v56
    v_lshlrev_b32 v57, 16, v57
    v_lshlrev_b32 v58, 16, v58
    v_lshlrev_b32 v59, 16, v59
    v_lshlrev_b32 v60, 16, v60
    v_lshlrev_b32 v61, 16, v61
    v_mul_f32 v92, s24, v60
    v_fma_f32 v93, s24, v60, -v92
    v_exp_f32 v92, v92
    v_mul_f32 v93, s26, v93
    v_fmac_f32 v93, s25, v60
    v_fma_f32 v60, v92, v93, v92
    v_cvt_pk_bf16_f32 v60, v60, v60
    v_lshlrev_b32 v60, 16, v60
    v_mul_f32 v94, s24, v56
    v_fma_f32 v95, s24, v56, -v94
    v_exp_f32 v94, v94
    v_mul_f32 v95, s26, v95
    v_fmac_f32 v95, s25, v56
    v_fma_f32 v56, v94, v95, v94
    v_cvt_pk_bf16_f32 v56, v56, v56
    v_lshlrev_b32 v56, 16, v56
    v_mul_f32 v56, v56, v60
    v_mul_f32 v57, v57, v60
    v_mul_f32 v58, v58, v60
    v_mul_f32 v59, v59, v60
    v_mul_f32 v56, 0xbfb8aa3b, v56
    v_mul_f32 v57, 0.15915494, v57
    v_add_f32 v58, v58, v58
    v_add_f32 v59, v59, v59
    v_mul_f32 v92, s20, v56
    v_mul_f32 v93, s20, v57
    v_exp_f32 v92, v92
    v_fract_f32 v93, v93
    s_nop 0
    v_cos_f32 v100, v93
    v_sin_f32 v101, v93
    s_nop 0
    v_mul_f32 v100, v100, v92
    v_mul_f32 v101, v101, v92
    v_mul_f32 v94, s21, v56
    v_mul_f32 v95, s21, v57
    v_exp_f32 v94, v94
    v_fract_f32 v95, v95
    s_nop 0
    v_cos_f32 v102, v95
    v_sin_f32 v103, v95
    s_nop 0
    v_mul_f32 v102, v102, v94
    v_mul_f32 v103, v103, v94
    v_mul_f32 v92, s22, v56
    v_mul_f32 v93, s22, v57
    v_exp_f32 v92, v92
    v_fract_f32 v93, v93
    s_nop 0
    v_cos_f32 v104, v93
    v_sin_f32 v105, v93
    s_nop 0
    v_mul_f32 v104, v104, v92
    v_mul_f32 v105, v105, v92
    v_mul_f32 v106, v58, v104
    v_mul_f32 v107, v58, v105
    v_fma_f32 v106, -v59, v105, v106
    v_fmac_f32 v107, v59, v104
    v_mul_f32 v92, s23, v56
    v_mul_f32 v93, s23, v57
    v_exp_f32 v92, v92
    v_fract_f32 v93, v93
    s_nop 0
    v_cos_f32 v104, v93
    v_sin_f32 v105, v93
    s_nop 0
    v_mul_f32 v104, v104, v92
    v_mul_f32 v105, v105, v92
    v_mul_f32 v232, v58, v104
    v_mul_f32 v233, v58, v105
    v_fma_f32 v232, -v59, v105, v232
    v_fmac_f32 v233, v59, v104
    v_mov_b32 v110, 1.0
    v_mov_b32 v111, 0
    s_waitcnt lgkmcnt(0)
    v_mfma_f32_16x16x32_bf16 v[184:187], v[120:123], v[152:155], 0
    v_mfma_f32_16x16x32_bf16 v[228:231], v[124:127], v[156:159], 0
    v_mfma_f32_16x16x32_bf16 v[184:187], v[128:131], v[160:163], v[184:187]
    v_mfma_f32_16x16x32_bf16 v[228:231], v[132:135], v[164:167], v[228:231]
    v_mfma_f32_16x16x32_bf16 v[184:187], v[136:139], v[168:171], v[184:187]
    v_mfma_f32_16x16x32_bf16 v[228:231], v[140:143], v[172:175], v[228:231]
    v_mfma_f32_16x16x32_bf16 v[184:187], v[144:147], v[176:179], v[184:187]
    v_mfma_f32_16x16x32_bf16 v[228:231], v[148:151], v[180:183], v[228:231]
    s_nop 7
    v_add_f32 v184, v184, v228
    v_add_f32 v185, v185, v229
    v_add_f32 v186, v186, v230
    v_add_f32 v187, v187, v231
    ds_write_b128 v76, v[184:187]
    s_lshl_b32 s67, s3, 6
    v_add_u32 v240, s67, v0
    v_lshlrev_b32 v240, 3, v240
    s_mov_b32 s66, 159488
    v_sub_u32 v80, 2047, v240
    v_sub_u32 v81, 2046, v240
    v_max_i32 v80, 0, v80
    v_max_i32 v81, 0, v81
    v_cvt_f32_u32 v80, v80
    v_cvt_f32_u32 v81, v81
    v_cvt_pk_bf16_f32 v241, v80, v81
    v_lshlrev_b32 v80, 16, v241
    v_and_b32 v81, 0xffff0000, v241
    v_cvt_u32_f32 v80, v80
    v_cvt_u32_f32 v81, v81
    v_add_u32 v241, 0x600, v80
    v_lshrrev_b32 v241, 2, v241
    v_min_u32 v80, v80, v241
    v_lshl_add_u32 v80, v80, 2, s66
    v_add_u32 v241, 0x600, v81
    v_lshrrev_b32 v241, 2, v241
    v_min_u32 v81, v81, v241
    v_lshl_add_u32 v81, v81, 2, s66
    v_sub_u32 v82, 2045, v240
    v_sub_u32 v83, 2044, v240
    v_max_i32 v82, 0, v82
    v_max_i32 v83, 0, v83
    v_cvt_f32_u32 v82, v82
    v_cvt_f32_u32 v83, v83
    v_cvt_pk_bf16_f32 v241, v82, v83
    v_lshlrev_b32 v82, 16, v241
    v_and_b32 v83, 0xffff0000, v241
    v_cvt_u32_f32 v82, v82
    v_cvt_u32_f32 v83, v83
    v_add_u32 v241, 0x600, v82
    v_lshrrev_b32 v241, 2, v241
    v_min_u32 v82, v82, v241
    v_lshl_add_u32 v82, v82, 2, s66
    v_add_u32 v241, 0x600, v83
    v_lshrrev_b32 v241, 2, v241
    v_min_u32 v83, v83, v241
    v_lshl_add_u32 v83, v83, 2, s66
    v_sub_u32 v84, 2043, v240
    v_sub_u32 v85, 2042, v240
    v_max_i32 v84, 0, v84
    v_max_i32 v85, 0, v85
    v_cvt_f32_u32 v84, v84
    v_cvt_f32_u32 v85, v85
    v_cvt_pk_bf16_f32 v241, v84, v85
    v_lshlrev_b32 v84, 16, v241
    v_and_b32 v85, 0xffff0000, v241
    v_cvt_u32_f32 v84, v84
    v_cvt_u32_f32 v85, v85
    v_add_u32 v241, 0x600, v84
    v_lshrrev_b32 v241, 2, v241
    v_min_u32 v84, v84, v241
    v_lshl_add_u32 v84, v84, 2, s66
    v_add_u32 v241, 0x600, v85
    v_lshrrev_b32 v241, 2, v241
    v_min_u32 v85, v85, v241
    v_lshl_add_u32 v85, v85, 2, s66
    v_sub_u32 v86, 2041, v240
    v_sub_u32 v87, 2040, v240
    v_max_i32 v86, 0, v86
    v_max_i32 v87, 0, v87
    v_cvt_f32_u32 v86, v86
    v_cvt_f32_u32 v87, v87
    v_cvt_pk_bf16_f32 v241, v86, v87
    v_lshlrev_b32 v86, 16, v241
    v_and_b32 v87, 0xffff0000, v241
    v_cvt_u32_f32 v86, v86
    v_cvt_u32_f32 v87, v87
    v_add_u32 v241, 0x600, v86
    v_lshrrev_b32 v241, 2, v241
    v_min_u32 v86, v86, v241
    v_lshl_add_u32 v86, v86, 2, s66
    v_add_u32 v241, 0x600, v87
    v_lshrrev_b32 v241, 2, v241
    v_min_u32 v87, v87, v241
    v_lshl_add_u32 v87, v87, 2, s66
    v_sub_u32 v88, 2039, v240
    v_sub_u32 v89, 2038, v240
    v_max_i32 v88, 0, v88
    v_max_i32 v89, 0, v89
    v_cvt_f32_u32 v88, v88
    v_cvt_f32_u32 v89, v89
    v_cvt_pk_bf16_f32 v241, v88, v89
    v_lshlrev_b32 v88, 16, v241
    v_and_b32 v89, 0xffff0000, v241
    v_cvt_u32_f32 v88, v88
    v_cvt_u32_f32 v89, v89
    v_add_u32 v241, 0x600, v88
    v_lshrrev_b32 v241, 2, v241
    v_min_u32 v88, v88, v241
    v_lshl_add_u32 v88, v88, 2, s66
    v_add_u32 v241, 0x600, v89
    v_lshrrev_b32 v241, 2, v241
    v_min_u32 v89, v89, v241
    v_lshl_add_u32 v89, v89, 2, s66
    v_sub_u32 v90, 2037, v240
    v_sub_u32 v91, 2036, v240
    v_max_i32 v90, 0, v90
    v_max_i32 v91, 0, v91
    v_cvt_f32_u32 v90, v90
    v_cvt_f32_u32 v91, v91
    v_cvt_pk_bf16_f32 v241, v90, v91
    v_lshlrev_b32 v90, 16, v241
    v_and_b32 v91, 0xffff0000, v241
    v_cvt_u32_f32 v90, v90
    v_cvt_u32_f32 v91, v91
    v_add_u32 v241, 0x600, v90
    v_lshrrev_b32 v241, 2, v241
    v_min_u32 v90, v90, v241
    v_lshl_add_u32 v90, v90, 2, s66
    v_add_u32 v241, 0x600, v91
    v_lshrrev_b32 v241, 2, v241
    v_min_u32 v91, v91, v241
    v_lshl_add_u32 v91, v91, 2, s66
    v_cmp_eq_u32 vcc, 0x7f8, v240
    s_nop 1
    s_mov_b64 s[28:29], vcc
    s_waitcnt lgkmcnt(0)
    s_barrier
    ds_read_b32 v188, v80
    ds_read_b32 v189, v81
    ds_read_b32 v190, v82
    ds_read_b32 v191, v83
    ds_read_b32 v192, v84
    ds_read_b32 v193, v85
    ds_read_b32 v194, v86
    ds_read_b32 v195, v87
    ds_read_b32 v196, v88
    ds_read_b32 v197, v89
    ds_read_b32 v198, v90
    v_cndmask_b32 v53, 0, v53, s[28:29]
    v_pk_mul_f32 v[108:109], v[106:107], v[102:103] op_sel_hi:[0,1]
    v_pk_mul_f32 v[112:113], v[110:111], v[100:101] op_sel_hi:[0,1]
    v_pk_mul_f32 v[234:235], v[232:233], v[102:103] op_sel_hi:[0,1]
    v_cvt_pk_bf16_f32 v220, v106, -v107
    v_cvt_pk_bf16_f32 v221, v110, v111
    v_cvt_pk_bf16_f32 v222, v232, -v233
    v_pk_fma_f32 v[108:109], v[106:107], v[102:103], v[108:109] op_sel:[1,1,0] op_sel_hi:[1,0,1] neg_lo:[0,1,0]
    v_pk_fma_f32 v[112:113], v[110:111], v[100:101], v[112:113] op_sel:[1,1,0] op_sel_hi:[1,0,1] neg_lo:[0,1,0]
    v_pk_fma_f32 v[234:235], v[232:233], v[102:103], v[234:235] op_sel:[1,1,0] op_sel_hi:[1,0,1] neg_lo:[0,1,0]
    ds_write_b32 v73, v220 offset:0
    ds_write_b32 v72, v221 offset:0
    ds_write_b32 v73, v222 offset:8448
    v_pk_mul_f32 v[106:107], v[108:109], v[102:103] op_sel_hi:[0,1]
    v_pk_mul_f32 v[110:111], v[112:113], v[100:101] op_sel_hi:[0,1]
    v_pk_mul_f32 v[232:233], v[234:235], v[102:103] op_sel_hi:[0,1]
    v_cvt_pk_bf16_f32 v224, v108, -v109
    v_cvt_pk_bf16_f32 v225, v112, v113
    v_cvt_pk_bf16_f32 v226, v234, -v235
    v_pk_fma_f32 v[106:107], v[108:109], v[102:103], v[106:107] op_sel:[1,1,0] op_sel_hi:[1,0,1] neg_lo:[0,1,0]
    v_pk_fma_f32 v[110:111], v[112:113], v[100:101], v[110:111] op_sel:[1,1,0] op_sel_hi:[1,0,1] neg_lo:[0,1,0]
    v_pk_fma_f32 v[232:233], v[234:235], v[102:103], v[232:233] op_sel:[1,1,0] op_sel_hi:[1,0,1] neg_lo:[0,1,0]
    ds_write_b32 v73, v224 offset:528
    ds_write_b32 v72, v225 offset:528
    ds_write_b32 v73, v226 offset:8976
    v_pk_mul_f32 v[108:109], v[106:107], v[102:103] op_sel_hi:[0,1]
    v_pk_mul_f32 v[112:113], v[110:111], v[100:101] op_sel_hi:[0,1]
    v_pk_mul_f32 v[234:235], v[232:233], v[102:103] op_sel_hi:[0,1]
    v_cvt_pk_bf16_f32 v220, v106, -v107
    v_cvt_pk_bf16_f32 v221, v110, v111
    v_cvt_pk_bf16_f32 v222, v232, -v233
    v_pk_fma_f32 v[108:109], v[106:107], v[102:103], v[108:109] op_sel:[1,1,0] op_sel_hi:[1,0,1] neg_lo:[0,1,0]
    v_pk_fma_f32 v[112:113], v[110:111], v[100:101], v[112:113] op_sel:[1,1,0] op_sel_hi:[1,0,1] neg_lo:[0,1,0]
    v_pk_fma_f32 v[234:235], v[232:233], v[102:103], v[234:235] op_sel:[1,1,0] op_sel_hi:[1,0,1] neg_lo:[0,1,0]
    ds_write_b32 v73, v220 offset:1056
    ds_write_b32 v72, v221 offset:1056
    ds_write_b32 v73, v222 offset:9504
    v_pk_mul_f32 v[106:107], v[108:109], v[102:103] op_sel_hi:[0,1]
    v_pk_mul_f32 v[110:111], v[112:113], v[100:101] op_sel_hi:[0,1]
    v_pk_mul_f32 v[232:233], v[234:235], v[102:103] op_sel_hi:[0,1]
    v_cvt_pk_bf16_f32 v224, v108, -v109
    v_cvt_pk_bf16_f32 v225, v112, v113
    v_cvt_pk_bf16_f32 v226, v234, -v235
    v_pk_fma_f32 v[106:107], v[108:109], v[102:103], v[106:107] op_sel:[1,1,0] op_sel_hi:[1,0,1] neg_lo:[0,1,0]
    v_pk_fma_f32 v[110:111], v[112:113], v[100:101], v[110:111] op_sel:[1,1,0] op_sel_hi:[1,0,1] neg_lo:[0,1,0]
    v_pk_fma_f32 v[232:233], v[234:235], v[102:103], v[232:233] op_sel:[1,1,0] op_sel_hi:[1,0,1] neg_lo:[0,1,0]
    ds_write_b32 v73, v224 offset:1584
    ds_write_b32 v72, v225 offset:1584
    ds_write_b32 v73, v226 offset:10032
    s_waitcnt lgkmcnt(12)
    v_add_f32 v195, v195, v53
    v_cndmask_b32 v196, v196, 0, s[28:29]
    v_cndmask_b32 v197, v197, 0, s[28:29]
    v_cndmask_b32 v198, v198, 0, s[28:29]
    v_cvt_pk_bf16_f32 v200, v188, v189
    v_cvt_pk_bf16_f32 v201, v190, v191
    v_cvt_pk_bf16_f32 v202, v192, v193
    v_cvt_pk_bf16_f32 v203, v194, v195
    ds_write_b128 v77, v[200:203] offset:0
    v_cvt_pk_bf16_f32 v204, v189, v190
    v_cvt_pk_bf16_f32 v205, v191, v192
    v_cvt_pk_bf16_f32 v206, v193, v194
    v_cvt_pk_bf16_f32 v207, v195, v196
    ds_write_b128 v77, v[204:207] offset:4160
    v_cvt_pk_bf16_f32 v208, v190, v191
    v_cvt_pk_bf16_f32 v209, v192, v193
    v_cvt_pk_bf16_f32 v210, v194, v195
    v_cvt_pk_bf16_f32 v211, v196, v197
    ds_write_b128 v77, v[208:211] offset:8320
    v_cvt_pk_bf16_f32 v212, v191, v192
    v_cvt_pk_bf16_f32 v213, v193, v194
    v_cvt_pk_bf16_f32 v214, v195, v196
    v_cvt_pk_bf16_f32 v215, v197, v198
    ds_write_b128 v77, v[212:215] offset:12480
    v_pk_mul_f32 v[108:109], v[106:107], v[102:103] op_sel_hi:[0,1]
    v_pk_mul_f32 v[112:113], v[110:111], v[100:101] op_sel_hi:[0,1]
    v_pk_mul_f32 v[234:235], v[232:233], v[102:103] op_sel_hi:[0,1]
    v_cvt_pk_bf16_f32 v220, v106, -v107
    v_cvt_pk_bf16_f32 v221, v110, v111
    v_cvt_pk_bf16_f32 v222, v232, -v233
    v_pk_fma_f32 v[108:109], v[106:107], v[102:103], v[108:109] op_sel:[1,1,0] op_sel_hi:[1,0,1] neg_lo:[0,1,0]
    v_pk_fma_f32 v[112:113], v[110:111], v[100:101], v[112:113] op_sel:[1,1,0] op_sel_hi:[1,0,1] neg_lo:[0,1,0]
    v_pk_fma_f32 v[234:235], v[232:233], v[102:103], v[234:235] op_sel:[1,1,0] op_sel_hi:[1,0,1] neg_lo:[0,1,0]
    ds_write_b32 v73, v220 offset:2112
    ds_write_b32 v72, v221 offset:2112
    ds_write_b32 v73, v222 offset:10560
    v_pk_mul_f32 v[106:107], v[108:109], v[102:103] op_sel_hi:[0,1]
    v_pk_mul_f32 v[110:111], v[112:113], v[100:101] op_sel_hi:[0,1]
    v_pk_mul_f32 v[232:233], v[234:235], v[102:103] op_sel_hi:[0,1]
    v_cvt_pk_bf16_f32 v224, v108, -v109
    v_cvt_pk_bf16_f32 v225, v112, v113
    v_cvt_pk_bf16_f32 v226, v234, -v235
    v_pk_fma_f32 v[106:107], v[108:109], v[102:103], v[106:107] op_sel:[1,1,0] op_sel_hi:[1,0,1] neg_lo:[0,1,0]
    v_pk_fma_f32 v[110:111], v[112:113], v[100:101], v[110:111] op_sel:[1,1,0] op_sel_hi:[1,0,1] neg_lo:[0,1,0]
    v_pk_fma_f32 v[232:233], v[234:235], v[102:103], v[232:233] op_sel:[1,1,0] op_sel_hi:[1,0,1] neg_lo:[0,1,0]
    ds_write_b32 v73, v224 offset:2640
    ds_write_b32 v72, v225 offset:2640
    ds_write_b32 v73, v226 offset:11088
    v_pk_mul_f32 v[108:109], v[106:107], v[102:103] op_sel_hi:[0,1]
    v_pk_mul_f32 v[112:113], v[110:111], v[100:101] op_sel_hi:[0,1]
    v_pk_mul_f32 v[234:235], v[232:233], v[102:103] op_sel_hi:[0,1]
    v_cvt_pk_bf16_f32 v220, v106, -v107
    v_cvt_pk_bf16_f32 v221, v110, v111
    v_cvt_pk_bf16_f32 v222, v232, -v233
    v_pk_fma_f32 v[108:109], v[106:107], v[102:103], v[108:109] op_sel:[1,1,0] op_sel_hi:[1,0,1] neg_lo:[0,1,0]
    v_pk_fma_f32 v[112:113], v[110:111], v[100:101], v[112:113] op_sel:[1,1,0] op_sel_hi:[1,0,1] neg_lo:[0,1,0]
    v_pk_fma_f32 v[234:235], v[232:233], v[102:103], v[234:235] op_sel:[1,1,0] op_sel_hi:[1,0,1] neg_lo:[0,1,0]
    ds_write_b32 v73, v220 offset:3168
    ds_write_b32 v72, v221 offset:3168
    ds_write_b32 v73, v222 offset:11616
    v_pk_mul_f32 v[106:107], v[108:109], v[102:103] op_sel_hi:[0,1]
    v_pk_mul_f32 v[110:111], v[112:113], v[100:101] op_sel_hi:[0,1]
    v_pk_mul_f32 v[232:233], v[234:235], v[102:103] op_sel_hi:[0,1]
    v_cvt_pk_bf16_f32 v224, v108, -v109
    v_cvt_pk_bf16_f32 v225, v112, v113
    v_cvt_pk_bf16_f32 v226, v234, -v235
    v_pk_fma_f32 v[106:107], v[108:109], v[102:103], v[106:107] op_sel:[1,1,0] op_sel_hi:[1,0,1] neg_lo:[0,1,0]
    v_pk_fma_f32 v[110:111], v[112:113], v[100:101], v[110:111] op_sel:[1,1,0] op_sel_hi:[1,0,1] neg_lo:[0,1,0]
    v_pk_fma_f32 v[232:233], v[234:235], v[102:103], v[232:233] op_sel:[1,1,0] op_sel_hi:[1,0,1] neg_lo:[0,1,0]
    ds_write_b32 v73, v224 offset:3696
    ds_write_b32 v72, v225 offset:3696
    ds_write_b32 v73, v226 offset:12144
    v_pk_mul_f32 v[108:109], v[106:107], v[102:103] op_sel_hi:[0,1]
    v_pk_mul_f32 v[112:113], v[110:111], v[100:101] op_sel_hi:[0,1]
    v_pk_mul_f32 v[234:235], v[232:233], v[102:103] op_sel_hi:[0,1]
    v_cvt_pk_bf16_f32 v220, v106, -v107
    v_cvt_pk_bf16_f32 v221, v110, v111
    v_cvt_pk_bf16_f32 v222, v232, -v233
    v_pk_fma_f32 v[108:109], v[106:107], v[102:103], v[108:109] op_sel:[1,1,0] op_sel_hi:[1,0,1] neg_lo:[0,1,0]
    v_pk_fma_f32 v[112:113], v[110:111], v[100:101], v[112:113] op_sel:[1,1,0] op_sel_hi:[1,0,1] neg_lo:[0,1,0]
    v_pk_fma_f32 v[234:235], v[232:233], v[102:103], v[234:235] op_sel:[1,1,0] op_sel_hi:[1,0,1] neg_lo:[0,1,0]
    ds_write_b32 v73, v220 offset:4224
    ds_write_b32 v72, v221 offset:4224
    ds_write_b32 v73, v222 offset:12672
    v_pk_mul_f32 v[106:107], v[108:109], v[102:103] op_sel_hi:[0,1]
    v_pk_mul_f32 v[110:111], v[112:113], v[100:101] op_sel_hi:[0,1]
    v_pk_mul_f32 v[232:233], v[234:235], v[102:103] op_sel_hi:[0,1]
    v_cvt_pk_bf16_f32 v224, v108, -v109
    v_cvt_pk_bf16_f32 v225, v112, v113
    v_cvt_pk_bf16_f32 v226, v234, -v235
    v_pk_fma_f32 v[106:107], v[108:109], v[102:103], v[106:107] op_sel:[1,1,0] op_sel_hi:[1,0,1] neg_lo:[0,1,0]
    v_pk_fma_f32 v[110:111], v[112:113], v[100:101], v[110:111] op_sel:[1,1,0] op_sel_hi:[1,0,1] neg_lo:[0,1,0]
    v_pk_fma_f32 v[232:233], v[234:235], v[102:103], v[232:233] op_sel:[1,1,0] op_sel_hi:[1,0,1] neg_lo:[0,1,0]
    ds_write_b32 v73, v224 offset:4752
    ds_write_b32 v72, v225 offset:4752
    ds_write_b32 v73, v226 offset:13200
    v_pk_mul_f32 v[108:109], v[106:107], v[102:103] op_sel_hi:[0,1]
    v_pk_mul_f32 v[112:113], v[110:111], v[100:101] op_sel_hi:[0,1]
    v_pk_mul_f32 v[234:235], v[232:233], v[102:103] op_sel_hi:[0,1]
    v_cvt_pk_bf16_f32 v220, v106, -v107
    v_cvt_pk_bf16_f32 v221, v110, v111
    v_cvt_pk_bf16_f32 v222, v232, -v233
    v_pk_fma_f32 v[108:109], v[106:107], v[102:103], v[108:109] op_sel:[1,1,0] op_sel_hi:[1,0,1] neg_lo:[0,1,0]
    v_pk_fma_f32 v[112:113], v[110:111], v[100:101], v[112:113] op_sel:[1,1,0] op_sel_hi:[1,0,1] neg_lo:[0,1,0]
    v_pk_fma_f32 v[234:235], v[232:233], v[102:103], v[234:235] op_sel:[1,1,0] op_sel_hi:[1,0,1] neg_lo:[0,1,0]
    ds_write_b32 v73, v220 offset:5280
    ds_write_b32 v72, v221 offset:5280
    ds_write_b32 v73, v222 offset:13728
    v_pk_mul_f32 v[106:107], v[108:109], v[102:103] op_sel_hi:[0,1]
    v_pk_mul_f32 v[110:111], v[112:113], v[100:101] op_sel_hi:[0,1]
    v_pk_mul_f32 v[232:233], v[234:235], v[102:103] op_sel_hi:[0,1]
    v_cvt_pk_bf16_f32 v224, v108, -v109
    v_cvt_pk_bf16_f32 v225, v112, v113
    v_cvt_pk_bf16_f32 v226, v234, -v235
    v_pk_fma_f32 v[106:107], v[108:109], v[102:103], v[106:107] op_sel:[1,1,0] op_sel_hi:[1,0,1] neg_lo:[0,1,0]
    v_pk_fma_f32 v[110:111], v[112:113], v[100:101], v[110:111] op_sel:[1,1,0] op_sel_hi:[1,0,1] neg_lo:[0,1,0]
    v_pk_fma_f32 v[232:233], v[234:235], v[102:103], v[232:233] op_sel:[1,1,0] op_sel_hi:[1,0,1] neg_lo:[0,1,0]
    ds_write_b32 v73, v224 offset:5808
    ds_write_b32 v72, v225 offset:5808
    ds_write_b32 v73, v226 offset:14256
    v_pk_mul_f32 v[108:109], v[106:107], v[102:103] op_sel_hi:[0,1]
    v_pk_mul_f32 v[112:113], v[110:111], v[100:101] op_sel_hi:[0,1]
    v_pk_mul_f32 v[234:235], v[232:233], v[102:103] op_sel_hi:[0,1]
    v_cvt_pk_bf16_f32 v220, v106, -v107
    v_cvt_pk_bf16_f32 v221, v110, v111
    v_cvt_pk_bf16_f32 v222, v232, -v233
    v_pk_fma_f32 v[108:109], v[106:107], v[102:103], v[108:109] op_sel:[1,1,0] op_sel_hi:[1,0,1] neg_lo:[0,1,0]
    v_pk_fma_f32 v[112:113], v[110:111], v[100:101], v[112:113] op_sel:[1,1,0] op_sel_hi:[1,0,1] neg_lo:[0,1,0]
    v_pk_fma_f32 v[234:235], v[232:233], v[102:103], v[234:235] op_sel:[1,1,0] op_sel_hi:[1,0,1] neg_lo:[0,1,0]
    ds_write_b32 v73, v220 offset:6336
    ds_write_b32 v72, v221 offset:6336
    ds_write_b32 v73, v222 offset:14784
    v_pk_mul_f32 v[106:107], v[108:109], v[102:103] op_sel_hi:[0,1]
    v_pk_mul_f32 v[110:111], v[112:113], v[100:101] op_sel_hi:[0,1]
    v_pk_mul_f32 v[232:233], v[234:235], v[102:103] op_sel_hi:[0,1]
    v_cvt_pk_bf16_f32 v224, v108, -v109
    v_cvt_pk_bf16_f32 v225, v112, v113
    v_cvt_pk_bf16_f32 v226, v234, -v235
    v_pk_fma_f32 v[106:107], v[108:109], v[102:103], v[106:107] op_sel:[1,1,0] op_sel_hi:[1,0,1] neg_lo:[0,1,0]
    v_pk_fma_f32 v[110:111], v[112:113], v[100:101], v[110:111] op_sel:[1,1,0] op_sel_hi:[1,0,1] neg_lo:[0,1,0]
    v_pk_fma_f32 v[232:233], v[234:235], v[102:103], v[232:233] op_sel:[1,1,0] op_sel_hi:[1,0,1] neg_lo:[0,1,0]
    ds_write_b32 v73, v224 offset:6864
    ds_write_b32 v72, v225 offset:6864
    ds_write_b32 v73, v226 offset:15312
    v_pk_mul_f32 v[108:109], v[106:107], v[102:103] op_sel_hi:[0,1]
    v_pk_mul_f32 v[112:113], v[110:111], v[100:101] op_sel_hi:[0,1]
    v_pk_mul_f32 v[234:235], v[232:233], v[102:103] op_sel_hi:[0,1]
    v_cvt_pk_bf16_f32 v220, v106, -v107
    v_cvt_pk_bf16_f32 v221, v110, v111
    v_cvt_pk_bf16_f32 v222, v232, -v233
    v_pk_fma_f32 v[108:109], v[106:107], v[102:103], v[108:109] op_sel:[1,1,0] op_sel_hi:[1,0,1] neg_lo:[0,1,0]
    v_pk_fma_f32 v[112:113], v[110:111], v[100:101], v[112:113] op_sel:[1,1,0] op_sel_hi:[1,0,1] neg_lo:[0,1,0]
    v_pk_fma_f32 v[234:235], v[232:233], v[102:103], v[234:235] op_sel:[1,1,0] op_sel_hi:[1,0,1] neg_lo:[0,1,0]
    ds_write_b32 v73, v220 offset:7392
    ds_write_b32 v72, v221 offset:7392
    ds_write_b32 v73, v222 offset:15840
    v_cvt_pk_bf16_f32 v224, v108, -v109
    v_cvt_pk_bf16_f32 v225, v112, v113
    v_cvt_pk_bf16_f32 v226, v234, -v235
    ds_write_b32 v73, v224 offset:7920
    ds_write_b32 v72, v225 offset:7920
    ds_write_b32 v73, v226 offset:16368
    s_waitcnt lgkmcnt(0)
    s_barrier
    s_add_u32 m0, s40, 16384
    s_add_u32 s48, s42, 1179648
    buffer_load_dwordx4 v6, s[12:15], s48 offen lds
    s_add_u32 m0, s40, 17408
    s_add_u32 s48, s42, 1327104
    buffer_load_dwordx4 v6, s[12:15], s48 offen lds
    s_add_u32 m0, s40, 24576
    s_add_u32 s48, s42, 1769472
    buffer_load_dwordx4 v6, s[12:15], s48 offen lds
    s_add_u32 m0, s40, 25600
    s_add_u32 s48, s42, 1916928
    buffer_load_dwordx4 v6, s[12:15], s48 offen lds
    buffer_load_dword v249, v245, s[12:15], 0 offen
    buffer_load_dword v249, v246, s[12:15], 0 offen
    ds_read_b128 v[120:123], v74 offset:0
    ds_read_b128 v[152:155], v75 offset:0
    ds_read_b128 v[124:127], v74 offset:64
    ds_read_b128 v[156:159], v75 offset:64
    ds_read_b128 v[128:131], v74 offset:128
    ds_read_b128 v[160:163], v75 offset:128
    ds_read_b128 v[132:135], v74 offset:192
    ds_read_b128 v[164:167], v75 offset:192
    ds_read_b128 v[136:139], v74 offset:256
    ds_read_b128 v[168:171], v75 offset:256
    ds_read_b128 v[140:143], v74 offset:320
    ds_read_b128 v[172:175], v75 offset:320
    ds_read_b128 v[144:147], v74 offset:384
    ds_read_b128 v[176:179], v75 offset:384
    ds_read_b128 v[148:151], v74 offset:448
    ds_read_b128 v[180:183], v75 offset:448
    v_lshlrev_b32 v64, 16, v64
    v_lshlrev_b32 v65, 16, v65
    v_lshlrev_b32 v66, 16, v66
    v_lshlrev_b32 v67, 16, v67
    v_lshlrev_b32 v68, 16, v68
    v_lshlrev_b32 v69, 16, v69
    v_mul_f32 v92, s24, v68
    v_fma_f32 v93, s24, v68, -v92
    v_exp_f32 v92, v92
    v_mul_f32 v93, s26, v93
    v_fmac_f32 v93, s25, v68
    v_fma_f32 v68, v92, v93, v92
    v_cvt_pk_bf16_f32 v68, v68, v68
    v_lshlrev_b32 v68, 16, v68
    v_mul_f32 v94, s24, v64
    v_fma_f32 v95, s24, v64, -v94
    v_exp_f32 v94, v94
    v_mul_f32 v95, s26, v95
    v_fmac_f32 v95, s25, v64
    v_fma_f32 v64, v94, v95, v94
    v_cvt_pk_bf16_f32 v64, v64, v64
    v_lshlrev_b32 v64, 16, v64
    v_mul_f32 v64, v64, v68
    v_mul_f32 v65, v65, v68
    v_mul_f32 v66, v66, v68
    v_mul_f32 v67, v67, v68
    v_mul_f32 v64, 0xbfb8aa3b, v64
    v_mul_f32 v65, 0.15915494, v65
    v_add_f32 v66, v66, v66
    v_add_f32 v67, v67, v67
    v_mul_f32 v92, s20, v64
    v_mul_f32 v93, s20, v65
    v_exp_f32 v92, v92
    v_fract_f32 v93, v93
    s_nop 0
    v_cos_f32 v100, v93
    v_sin_f32 v101, v93
    s_nop 0
    v_mul_f32 v100, v100, v92
    v_mul_f32 v101, v101, v92
    v_mul_f32 v94, s21, v64
    v_mul_f32 v95, s21, v65
    v_exp_f32 v94, v94
    v_fract_f32 v95, v95
    s_nop 0
    v_cos_f32 v102, v95
    v_sin_f32 v103, v95
    s_nop 0
    v_mul_f32 v102, v102, v94
    v_mul_f32 v103, v103, v94
    v_mul_f32 v92, s22, v64
    v_mul_f32 v93, s22, v65
    v_exp_f32 v92, v92
    v_fract_f32 v93, v93
    s_nop 0
    v_cos_f32 v104, v93
    v_sin_f32 v105, v93
    s_nop 0
    v_mul_f32 v104, v104, v92
    v_mul_f32 v105, v105, v92
    v_mul_f32 v106, v66, v104
    v_mul_f32 v107, v66, v105
    v_fma_f32 v106, -v67, v105, v106
    v_fmac_f32 v107, v67, v104
    v_mul_f32 v92, s23, v64
    v_mul_f32 v93, s23, v65
    v_exp_f32 v92, v92
    v_fract_f32 v93, v93
    s_nop 0
    v_cos_f32 v104, v93
    v_sin_f32 v105, v93
    s_nop 0
    v_mul_f32 v104, v104, v92
    v_mul_f32 v105, v105, v92
    v_mul_f32 v232, v66, v104
    v_mul_f32 v233, v66, v105
    v_fma_f32 v232, -v67, v105, v232
    v_fmac_f32 v233, v67, v104
    v_mov_b32 v110, 1.0
    v_mov_b32 v111, 0
    s_waitcnt lgkmcnt(0)
    v_mfma_f32_16x16x32_bf16 v[184:187], v[120:123], v[152:155], 0
    v_mfma_f32_16x16x32_bf16 v[228:231], v[124:127], v[156:159], 0
    v_mfma_f32_16x16x32_bf16 v[184:187], v[128:131], v[160:163], v[184:187]
    v_mfma_f32_16x16x32_bf16 v[228:231], v[132:135], v[164:167], v[228:231]
    v_mfma_f32_16x16x32_bf16 v[184:187], v[136:139], v[168:171], v[184:187]
    v_mfma_f32_16x16x32_bf16 v[228:231], v[140:143], v[172:175], v[228:231]
    v_mfma_f32_16x16x32_bf16 v[184:187], v[144:147], v[176:179], v[184:187]
    v_mfma_f32_16x16x32_bf16 v[228:231], v[148:151], v[180:183], v[228:231]
    s_nop 7
    v_add_f32 v184, v184, v228
    v_add_f32 v185, v185, v229
    v_add_f32 v186, v186, v230
    v_add_f32 v187, v187, v231
    ds_write_b128 v76, v[184:187]
    v_lshrrev_b32 v11, 4, v0
    v_bfe_u32 v12, v0, 2, 2
    v_lshl_add_u32 v12, v11, 3, v12
    v_and_b32 v13, 3, v0
    v_lshlrev_b32 v13, 3, v13
    v_and_b32 v11, 1, v11
    v_lshl_add_u32 v2, v12, 6, v13
    v_lshl_add_u32 v2, v11, 5, v2
    v_xor_b32 v3, 32, v2
    v_lshl_add_u32 v4, v12, 5, v13
    v_lshl_add_u32 v4, v11, 7, v4
    v_lshlrev_b32 v11, 8, v11
    v_sub_u32 v5, v4, v11
    v_add_u32 v5, 128, v5
    s_and_b32 s68, s64, 1
    s_lshl_b32 s66, s63, 4
    s_lshl_b32 s67, s3, 2
    s_add_u32 s66, s66, s67
    s_mul_i32 s44, s66, 18432
    s_add_u32 s69, s44, 18432
    s_add_u32 s70, s44, 36864
    s_add_u32 s71, s44, 55296
    s_lshl_b32 s67, s62, 7
    s_add_u32 s66, s66, s67
    s_mul_i32 s66, s66, 18432
    s_lshl_b32 s67, s64, 11
    s_add_u32 s45, s66, s67
    s_lshl_b32 s67, s64, 10
    s_add_u32 s67, s67, s66
    s_add_u32 s79, s67, 8192
    s_lshr_b32 s67, s64, 1
    s_lshl_b32 s67, s67, 10
    s_add_u32 s66, s66, s67
    s_lshl_b32 s67, s68, 3
    s_add_u32 s66, s66, s67
    s_add_u32 s101, s66, 16384
    s_lshl_b32 s66, s60, 8
    s_lshl_b32 s67, s58, 3
    s_add_u32 s66, s66, s67
    s_lshl_b32 s67, s3, 1
    s_add_u32 s66, s66, s67
    s_mul_i32 s75, s66, 18432
    s_add_u32 s76, s75, 18432
    s_add_u32 s77, s75, 2359296
    s_add_u32 s78, s75, 2377728
    s_mov_b32 s47, 0xbfb8aa3b
    s_mov_b32 s100, 0
    s_lshl_b32 s52, s63, 2
    s_add_u32 s52, s52, s60
    s_lshl_b32 s52, s52, 7
    s_lshl_b32 s53, s58, 2
    s_add_u32 s53, s53, s64
    s_lshl_b32 s53, s53, 7
    s_add_u32 s53, s53, 4096
    s_min_u32 s65, s3, 2
    s_mul_i32 s51, s65, 21248
    s_add_u32 s51, s51, 99840
    v_and_b32 v11, 3, v0
    v_sub_u32 v11, 3, v11
    v_mul_u32_u24 v8, 4160, v11
    v_bfe_u32 v11, v0, 2, 2
    v_lshlrev_b32 v11, 3, v11
    v_sub_u32 v8, v8, v11
    v_bfe_u32 v11, v0, 4, 1
    v_lshlrev_b32 v11, 4, v11
    v_lshrrev_b32 v12, 5, v0
    v_lshlrev_b32 v12, 5, v12
    v_sub_u32 v11, v11, v12
    v_add_u32 v8, v8, v11
    v_add_u32 v8, 56, v8
    v_add_u32 v8, s51, v8
    v_and_b32 v12, 15, v0
    v_lshl_add_u32 v9, v12, 5, v11
    v_add_u32 v9, 16704, v9
    v_add_u32 v9, s51, v9
    v_lshlrev_b32 v10, 5, v12
    v_lshrrev_b32 v12, 4, v0
    v_lshl_add_u32 v10, v12, 3, v10
    s_waitcnt lgkmcnt(0)
    s_barrier
    ds_read_b32 v188, v80
    ds_read_b32 v189, v81
    ds_read_b32 v190, v82
    ds_read_b32 v191, v83
    ds_read_b32 v192, v84
    ds_read_b32 v193, v85
    ds_read_b32 v194, v86
    ds_read_b32 v195, v87
    ds_read_b32 v196, v88
    ds_read_b32 v197, v89
    ds_read_b32 v198, v90
    v_cndmask_b32 v61, 0, v61, s[28:29]
    v_pk_mul_f32 v[108:109], v[106:107], v[102:103] op_sel_hi:[0,1]
    v_pk_mul_f32 v[112:113], v[110:111], v[100:101] op_sel_hi:[0,1]
    v_pk_mul_f32 v[234:235], v[232:233], v[102:103] op_sel_hi:[0,1]
    v_cvt_pk_bf16_f32 v220, v106, -v107
    v_cvt_pk_bf16_f32 v221, v110, v111
    v_cvt_pk_bf16_f32 v222, v232, -v233
    v_pk_fma_f32 v[108:109], v[106:107], v[102:103], v[108:109] op_sel:[1,1,0] op_sel_hi:[1,0,1] neg_lo:[0,1,0]
    v_pk_fma_f32 v[112:113], v[110:111], v[100:101], v[112:113] op_sel:[1,1,0] op_sel_hi:[1,0,1] neg_lo:[0,1,0]
    v_pk_fma_f32 v[234:235], v[232:233], v[102:103], v[234:235] op_sel:[1,1,0] op_sel_hi:[1,0,1] neg_lo:[0,1,0]
    ds_write_b32 v73, v220 offset:0
    ds_write_b32 v72, v221 offset:0
    ds_write_b32 v73, v222 offset:8448
    v_pk_mul_f32 v[106:107], v[108:109], v[102:103] op_sel_hi:[0,1]
    v_pk_mul_f32 v[110:111], v[112:113], v[100:101] op_sel_hi:[0,1]
    v_pk_mul_f32 v[232:233], v[234:235], v[102:103] op_sel_hi:[0,1]
    v_cvt_pk_bf16_f32 v224, v108, -v109
    v_cvt_pk_bf16_f32 v225, v112, v113
    v_cvt_pk_bf16_f32 v226, v234, -v235
    v_pk_fma_f32 v[106:107], v[108:109], v[102:103], v[106:107] op_sel:[1,1,0] op_sel_hi:[1,0,1] neg_lo:[0,1,0]
    v_pk_fma_f32 v[110:111], v[112:113], v[100:101], v[110:111] op_sel:[1,1,0] op_sel_hi:[1,0,1] neg_lo:[0,1,0]
    v_pk_fma_f32 v[232:233], v[234:235], v[102:103], v[232:233] op_sel:[1,1,0] op_sel_hi:[1,0,1] neg_lo:[0,1,0]
    ds_write_b32 v73, v224 offset:528
    ds_write_b32 v72, v225 offset:528
    ds_write_b32 v73, v226 offset:8976
    v_pk_mul_f32 v[108:109], v[106:107], v[102:103] op_sel_hi:[0,1]
    v_pk_mul_f32 v[112:113], v[110:111], v[100:101] op_sel_hi:[0,1]
    v_pk_mul_f32 v[234:235], v[232:233], v[102:103] op_sel_hi:[0,1]
    v_cvt_pk_bf16_f32 v220, v106, -v107
    v_cvt_pk_bf16_f32 v221, v110, v111
    v_cvt_pk_bf16_f32 v222, v232, -v233
    v_pk_fma_f32 v[108:109], v[106:107], v[102:103], v[108:109] op_sel:[1,1,0] op_sel_hi:[1,0,1] neg_lo:[0,1,0]
    v_pk_fma_f32 v[112:113], v[110:111], v[100:101], v[112:113] op_sel:[1,1,0] op_sel_hi:[1,0,1] neg_lo:[0,1,0]
    v_pk_fma_f32 v[234:235], v[232:233], v[102:103], v[234:235] op_sel:[1,1,0] op_sel_hi:[1,0,1] neg_lo:[0,1,0]
    ds_write_b32 v73, v220 offset:1056
    ds_write_b32 v72, v221 offset:1056
    ds_write_b32 v73, v222 offset:9504
    v_pk_mul_f32 v[106:107], v[108:109], v[102:103] op_sel_hi:[0,1]
    v_pk_mul_f32 v[110:111], v[112:113], v[100:101] op_sel_hi:[0,1]
    v_pk_mul_f32 v[232:233], v[234:235], v[102:103] op_sel_hi:[0,1]
    v_cvt_pk_bf16_f32 v224, v108, -v109
    v_cvt_pk_bf16_f32 v225, v112, v113
    v_cvt_pk_bf16_f32 v226, v234, -v235
    v_pk_fma_f32 v[106:107], v[108:109], v[102:103], v[106:107] op_sel:[1,1,0] op_sel_hi:[1,0,1] neg_lo:[0,1,0]
    v_pk_fma_f32 v[110:111], v[112:113], v[100:101], v[110:111] op_sel:[1,1,0] op_sel_hi:[1,0,1] neg_lo:[0,1,0]
    v_pk_fma_f32 v[232:233], v[234:235], v[102:103], v[232:233] op_sel:[1,1,0] op_sel_hi:[1,0,1] neg_lo:[0,1,0]
    ds_write_b32 v73, v224 offset:1584
    ds_write_b32 v72, v225 offset:1584
    ds_write_b32 v73, v226 offset:10032
    s_waitcnt lgkmcnt(12)
    v_add_f32 v195, v195, v61
    v_cndmask_b32 v196, v196, 0, s[28:29]
    v_cndmask_b32 v197, v197, 0, s[28:29]
    v_cndmask_b32 v198, v198, 0, s[28:29]
    v_cvt_pk_bf16_f32 v200, v188, v189
    v_cvt_pk_bf16_f32 v201, v190, v191
    v_cvt_pk_bf16_f32 v202, v192, v193
    v_cvt_pk_bf16_f32 v203, v194, v195
    ds_write_b128 v77, v[200:203] offset:21248
    v_cvt_pk_bf16_f32 v204, v189, v190
    v_cvt_pk_bf16_f32 v205, v191, v192
    v_cvt_pk_bf16_f32 v206, v193, v194
    v_cvt_pk_bf16_f32 v207, v195, v196
    ds_write_b128 v77, v[204:207] offset:25408
    v_cvt_pk_bf16_f32 v208, v190, v191
    v_cvt_pk_bf16_f32 v209, v192, v193
    v_cvt_pk_bf16_f32 v210, v194, v195
    v_cvt_pk_bf16_f32 v211, v196, v197
    ds_write_b128 v77, v[208:211] offset:29568
    v_cvt_pk_bf16_f32 v212, v191, v192
    v_cvt_pk_bf16_f32 v213, v193, v194
    v_cvt_pk_bf16_f32 v214, v195, v196
    v_cvt_pk_bf16_f32 v215, v197, v198
    ds_write_b128 v77, v[212:215] offset:33728
    v_pk_mul_f32 v[108:109], v[106:107], v[102:103] op_sel_hi:[0,1]
    v_pk_mul_f32 v[112:113], v[110:111], v[100:101] op_sel_hi:[0,1]
    v_pk_mul_f32 v[234:235], v[232:233], v[102:103] op_sel_hi:[0,1]
    v_cvt_pk_bf16_f32 v220, v106, -v107
    v_cvt_pk_bf16_f32 v221, v110, v111
    v_cvt_pk_bf16_f32 v222, v232, -v233
    v_pk_fma_f32 v[108:109], v[106:107], v[102:103], v[108:109] op_sel:[1,1,0] op_sel_hi:[1,0,1] neg_lo:[0,1,0]
    v_pk_fma_f32 v[112:113], v[110:111], v[100:101], v[112:113] op_sel:[1,1,0] op_sel_hi:[1,0,1] neg_lo:[0,1,0]
    v_pk_fma_f32 v[234:235], v[232:233], v[102:103], v[234:235] op_sel:[1,1,0] op_sel_hi:[1,0,1] neg_lo:[0,1,0]
    ds_write_b32 v73, v220 offset:2112
    ds_write_b32 v72, v221 offset:2112
    ds_write_b32 v73, v222 offset:10560
    v_pk_mul_f32 v[106:107], v[108:109], v[102:103] op_sel_hi:[0,1]
    v_pk_mul_f32 v[110:111], v[112:113], v[100:101] op_sel_hi:[0,1]
    v_pk_mul_f32 v[232:233], v[234:235], v[102:103] op_sel_hi:[0,1]
    v_cvt_pk_bf16_f32 v224, v108, -v109
    v_cvt_pk_bf16_f32 v225, v112, v113
    v_cvt_pk_bf16_f32 v226, v234, -v235
    v_pk_fma_f32 v[106:107], v[108:109], v[102:103], v[106:107] op_sel:[1,1,0] op_sel_hi:[1,0,1] neg_lo:[0,1,0]
    v_pk_fma_f32 v[110:111], v[112:113], v[100:101], v[110:111] op_sel:[1,1,0] op_sel_hi:[1,0,1] neg_lo:[0,1,0]
    v_pk_fma_f32 v[232:233], v[234:235], v[102:103], v[232:233] op_sel:[1,1,0] op_sel_hi:[1,0,1] neg_lo:[0,1,0]
    ds_write_b32 v73, v224 offset:2640
    ds_write_b32 v72, v225 offset:2640
    ds_write_b32 v73, v226 offset:11088
    v_pk_mul_f32 v[108:109], v[106:107], v[102:103] op_sel_hi:[0,1]
    v_pk_mul_f32 v[112:113], v[110:111], v[100:101] op_sel_hi:[0,1]
    v_pk_mul_f32 v[234:235], v[232:233], v[102:103] op_sel_hi:[0,1]
    v_cvt_pk_bf16_f32 v220, v106, -v107
    v_cvt_pk_bf16_f32 v221, v110, v111
    v_cvt_pk_bf16_f32 v222, v232, -v233
    v_pk_fma_f32 v[108:109], v[106:107], v[102:103], v[108:109] op_sel:[1,1,0] op_sel_hi:[1,0,1] neg_lo:[0,1,0]
    v_pk_fma_f32 v[112:113], v[110:111], v[100:101], v[112:113] op_sel:[1,1,0] op_sel_hi:[1,0,1] neg_lo:[0,1,0]
    v_pk_fma_f32 v[234:235], v[232:233], v[102:103], v[234:235] op_sel:[1,1,0] op_sel_hi:[1,0,1] neg_lo:[0,1,0]
    ds_write_b32 v73, v220 offset:3168
    ds_write_b32 v72, v221 offset:3168
    ds_write_b32 v73, v222 offset:11616
    v_pk_mul_f32 v[106:107], v[108:109], v[102:103] op_sel_hi:[0,1]
    v_pk_mul_f32 v[110:111], v[112:113], v[100:101] op_sel_hi:[0,1]
    v_pk_mul_f32 v[232:233], v[234:235], v[102:103] op_sel_hi:[0,1]
    v_cvt_pk_bf16_f32 v224, v108, -v109
    v_cvt_pk_bf16_f32 v225, v112, v113
    v_cvt_pk_bf16_f32 v226, v234, -v235
    v_pk_fma_f32 v[106:107], v[108:109], v[102:103], v[106:107] op_sel:[1,1,0] op_sel_hi:[1,0,1] neg_lo:[0,1,0]
    v_pk_fma_f32 v[110:111], v[112:113], v[100:101], v[110:111] op_sel:[1,1,0] op_sel_hi:[1,0,1] neg_lo:[0,1,0]
    v_pk_fma_f32 v[232:233], v[234:235], v[102:103], v[232:233] op_sel:[1,1,0] op_sel_hi:[1,0,1] neg_lo:[0,1,0]
    ds_write_b32 v73, v224 offset:3696
    ds_write_b32 v72, v225 offset:3696
    ds_write_b32 v73, v226 offset:12144
    v_pk_mul_f32 v[108:109], v[106:107], v[102:103] op_sel_hi:[0,1]
    v_pk_mul_f32 v[112:113], v[110:111], v[100:101] op_sel_hi:[0,1]
    v_pk_mul_f32 v[234:235], v[232:233], v[102:103] op_sel_hi:[0,1]
    v_cvt_pk_bf16_f32 v220, v106, -v107
    v_cvt_pk_bf16_f32 v221, v110, v111
    v_cvt_pk_bf16_f32 v222, v232, -v233
    v_pk_fma_f32 v[108:109], v[106:107], v[102:103], v[108:109] op_sel:[1,1,0] op_sel_hi:[1,0,1] neg_lo:[0,1,0]
    v_pk_fma_f32 v[112:113], v[110:111], v[100:101], v[112:113] op_sel:[1,1,0] op_sel_hi:[1,0,1] neg_lo:[0,1,0]
    v_pk_fma_f32 v[234:235], v[232:233], v[102:103], v[234:235] op_sel:[1,1,0] op_sel_hi:[1,0,1] neg_lo:[0,1,0]
    ds_write_b32 v73, v220 offset:4224
    ds_write_b32 v72, v221 offset:4224
    ds_write_b32 v73, v222 offset:12672
    v_pk_mul_f32 v[106:107], v[108:109], v[102:103] op_sel_hi:[0,1]
    v_pk_mul_f32 v[110:111], v[112:113], v[100:101] op_sel_hi:[0,1]
    v_pk_mul_f32 v[232:233], v[234:235], v[102:103] op_sel_hi:[0,1]
    v_cvt_pk_bf16_f32 v224, v108, -v109
    v_cvt_pk_bf16_f32 v225, v112, v113
    v_cvt_pk_bf16_f32 v226, v234, -v235
    v_pk_fma_f32 v[106:107], v[108:109], v[102:103], v[106:107] op_sel:[1,1,0] op_sel_hi:[1,0,1] neg_lo:[0,1,0]
    v_pk_fma_f32 v[110:111], v[112:113], v[100:101], v[110:111] op_sel:[1,1,0] op_sel_hi:[1,0,1] neg_lo:[0,1,0]
    v_pk_fma_f32 v[232:233], v[234:235], v[102:103], v[232:233] op_sel:[1,1,0] op_sel_hi:[1,0,1] neg_lo:[0,1,0]
    ds_write_b32 v73, v224 offset:4752
    ds_write_b32 v72, v225 offset:4752
    ds_write_b32 v73, v226 offset:13200
    v_pk_mul_f32 v[108:109], v[106:107], v[102:103] op_sel_hi:[0,1]
    v_pk_mul_f32 v[112:113], v[110:111], v[100:101] op_sel_hi:[0,1]
    v_pk_mul_f32 v[234:235], v[232:233], v[102:103] op_sel_hi:[0,1]
    v_cvt_pk_bf16_f32 v220, v106, -v107
    v_cvt_pk_bf16_f32 v221, v110, v111
    v_cvt_pk_bf16_f32 v222, v232, -v233
    v_pk_fma_f32 v[108:109], v[106:107], v[102:103], v[108:109] op_sel:[1,1,0] op_sel_hi:[1,0,1] neg_lo:[0,1,0]
    v_pk_fma_f32 v[112:113], v[110:111], v[100:101], v[112:113] op_sel:[1,1,0] op_sel_hi:[1,0,1] neg_lo:[0,1,0]
    v_pk_fma_f32 v[234:235], v[232:233], v[102:103], v[234:235] op_sel:[1,1,0] op_sel_hi:[1,0,1] neg_lo:[0,1,0]
    ds_write_b32 v73, v220 offset:5280
    ds_write_b32 v72, v221 offset:5280
    ds_write_b32 v73, v222 offset:13728
    v_pk_mul_f32 v[106:107], v[108:109], v[102:103] op_sel_hi:[0,1]
    v_pk_mul_f32 v[110:111], v[112:113], v[100:101] op_sel_hi:[0,1]
    v_pk_mul_f32 v[232:233], v[234:235], v[102:103] op_sel_hi:[0,1]
    v_cvt_pk_bf16_f32 v224, v108, -v109
    v_cvt_pk_bf16_f32 v225, v112, v113
    v_cvt_pk_bf16_f32 v226, v234, -v235
    v_pk_fma_f32 v[106:107], v[108:109], v[102:103], v[106:107] op_sel:[1,1,0] op_sel_hi:[1,0,1] neg_lo:[0,1,0]
    v_pk_fma_f32 v[110:111], v[112:113], v[100:101], v[110:111] op_sel:[1,1,0] op_sel_hi:[1,0,1] neg_lo:[0,1,0]
    v_pk_fma_f32 v[232:233], v[234:235], v[102:103], v[232:233] op_sel:[1,1,0] op_sel_hi:[1,0,1] neg_lo:[0,1,0]
    ds_write_b32 v73, v224 offset:5808
    ds_write_b32 v72, v225 offset:5808
    ds_write_b32 v73, v226 offset:14256
    v_pk_mul_f32 v[108:109], v[106:107], v[102:103] op_sel_hi:[0,1]
    v_pk_mul_f32 v[112:113], v[110:111], v[100:101] op_sel_hi:[0,1]
    v_pk_mul_f32 v[234:235], v[232:233], v[102:103] op_sel_hi:[0,1]
    v_cvt_pk_bf16_f32 v220, v106, -v107
    v_cvt_pk_bf16_f32 v221, v110, v111
    v_cvt_pk_bf16_f32 v222, v232, -v233
    v_pk_fma_f32 v[108:109], v[106:107], v[102:103], v[108:109] op_sel:[1,1,0] op_sel_hi:[1,0,1] neg_lo:[0,1,0]
    v_pk_fma_f32 v[112:113], v[110:111], v[100:101], v[112:113] op_sel:[1,1,0] op_sel_hi:[1,0,1] neg_lo:[0,1,0]
    v_pk_fma_f32 v[234:235], v[232:233], v[102:103], v[234:235] op_sel:[1,1,0] op_sel_hi:[1,0,1] neg_lo:[0,1,0]
    ds_write_b32 v73, v220 offset:6336
    ds_write_b32 v72, v221 offset:6336
    ds_write_b32 v73, v222 offset:14784
    v_pk_mul_f32 v[106:107], v[108:109], v[102:103] op_sel_hi:[0,1]
    v_pk_mul_f32 v[110:111], v[112:113], v[100:101] op_sel_hi:[0,1]
    v_pk_mul_f32 v[232:233], v[234:235], v[102:103] op_sel_hi:[0,1]
    v_cvt_pk_bf16_f32 v224, v108, -v109
    v_cvt_pk_bf16_f32 v225, v112, v113
    v_cvt_pk_bf16_f32 v226, v234, -v235
    v_pk_fma_f32 v[106:107], v[108:109], v[102:103], v[106:107] op_sel:[1,1,0] op_sel_hi:[1,0,1] neg_lo:[0,1,0]
    v_pk_fma_f32 v[110:111], v[112:113], v[100:101], v[110:111] op_sel:[1,1,0] op_sel_hi:[1,0,1] neg_lo:[0,1,0]
    v_pk_fma_f32 v[232:233], v[234:235], v[102:103], v[232:233] op_sel:[1,1,0] op_sel_hi:[1,0,1] neg_lo:[0,1,0]
    ds_write_b32 v73, v224 offset:6864
    ds_write_b32 v72, v225 offset:6864
    ds_write_b32 v73, v226 offset:15312
    v_pk_mul_f32 v[108:109], v[106:107], v[102:103] op_sel_hi:[0,1]
    v_pk_mul_f32 v[112:113], v[110:111], v[100:101] op_sel_hi:[0,1]
    v_pk_mul_f32 v[234:235], v[232:233], v[102:103] op_sel_hi:[0,1]
    v_cvt_pk_bf16_f32 v220, v106, -v107
    v_cvt_pk_bf16_f32 v221, v110, v111
    v_cvt_pk_bf16_f32 v222, v232, -v233
    v_pk_fma_f32 v[108:109], v[106:107], v[102:103], v[108:109] op_sel:[1,1,0] op_sel_hi:[1,0,1] neg_lo:[0,1,0]
    v_pk_fma_f32 v[112:113], v[110:111], v[100:101], v[112:113] op_sel:[1,1,0] op_sel_hi:[1,0,1] neg_lo:[0,1,0]
    v_pk_fma_f32 v[234:235], v[232:233], v[102:103], v[234:235] op_sel:[1,1,0] op_sel_hi:[1,0,1] neg_lo:[0,1,0]
    ds_write_b32 v73, v220 offset:7392
    ds_write_b32 v72, v221 offset:7392
    ds_write_b32 v73, v222 offset:15840
    v_cvt_pk_bf16_f32 v224, v108, -v109
    v_cvt_pk_bf16_f32 v225, v112, v113
    v_cvt_pk_bf16_f32 v226, v234, -v235
    ds_write_b32 v73, v224 offset:7920
    ds_write_b32 v72, v225 offset:7920
    ds_write_b32 v73, v226 offset:16368
    s_waitcnt lgkmcnt(0)
    s_barrier
    v_lshlrev_b32 v240, 2, v0
    buffer_load_dword v14, v240, s[32:35], 0 offen sc1
    s_add_u32 m0, s40, 32768
    s_add_u32 s48, s42, 2359296
    buffer_load_dwordx4 v6, s[12:15], s48 offen lds
    s_add_u32 m0, s40, 33792
    s_add_u32 s48, s42, 2506752
    buffer_load_dwordx4 v6, s[12:15], s48 offen lds
    s_add_u32 m0, s40, 40960
    s_add_u32 s48, s42, 2949120
    buffer_load_dwordx4 v6, s[12:15], s48 offen lds
    s_add_u32 m0, s40, 41984
    s_add_u32 s48, s42, 3096576
    buffer_load_dwordx4 v6, s[12:15], s48 offen lds
    ds_read_b128 v[120:123], v74 offset:0
    ds_read_b128 v[152:155], v75 offset:0
    ds_read_b128 v[124:127], v74 offset:64
    ds_read_b128 v[156:159], v75 offset:64
    ds_read_b128 v[128:131], v74 offset:128
    ds_read_b128 v[160:163], v75 offset:128
    ds_read_b128 v[132:135], v74 offset:192
    ds_read_b128 v[164:167], v75 offset:192
    ds_read_b128 v[136:139], v74 offset:256
    ds_read_b128 v[168:171], v75 offset:256
    ds_read_b128 v[140:143], v74 offset:320
    ds_read_b128 v[172:175], v75 offset:320
    ds_read_b128 v[144:147], v74 offset:384
    ds_read_b128 v[176:179], v75 offset:384
    ds_read_b128 v[148:151], v74 offset:448
    ds_read_b128 v[180:183], v75 offset:448
    s_waitcnt vmcnt(4)
    v_cmp_ne_u32 vcc, 1, v14
    s_nop 4
    s_cbranch_vccnz M_notyet
    s_mov_b32 s72, 1
    s_cmp_eq_u32 s3, 3
    s_cbranch_scc1 M_notyet
    s_add_u32 s48, s50, s3
    s_lshl_b32 s48, s48, 6
    v_lshrrev_b32 v240, 2, v0
    v_mul_u32_u24 v240, 36864, v240
    v_and_b32 v241, 3, v0
    v_lshl_add_u32 v240, v241, 4, v240
    buffer_load_dwordx4 v[16:19], v240, s[36:39], s48 offen sc1
    s_add_u32 s48, s48, 589824
    buffer_load_dwordx4 v[20:23], v240, s[36:39], s48 offen sc1
    s_add_u32 s48, s48, 589824
    buffer_load_dwordx4 v[24:27], v240, s[36:39], s48 offen sc1
    s_add_u32 s48, s48, 589824
    buffer_load_dwordx4 v[28:31], v240, s[36:39], s48 offen sc1
M_notyet:
    s_waitcnt lgkmcnt(0)
    v_mfma_f32_16x16x32_bf16 v[184:187], v[120:123], v[152:155], 0
    v_mfma_f32_16x16x32_bf16 v[228:231], v[124:127], v[156:159], 0
    v_mfma_f32_16x16x32_bf16 v[184:187], v[128:131], v[160:163], v[184:187]
    v_mfma_f32_16x16x32_bf16 v[228:231], v[132:135], v[164:167], v[228:231]
    v_mfma_f32_16x16x32_bf16 v[184:187], v[136:139], v[168:171], v[184:187]
    v_mfma_f32_16x16x32_bf16 v[228:231], v[140:143], v[172:175], v[228:231]
    v_mfma_f32_16x16x32_bf16 v[184:187], v[144:147], v[176:179], v[184:187]
    v_mfma_f32_16x16x32_bf16 v[228:231], v[148:151], v[180:183], v[228:231]
    s_nop 7
    v_add_f32 v184, v184, v228
    v_add_f32 v185, v185, v229
    v_add_f32 v186, v186, v230
    v_add_f32 v187, v187, v231
    ds_write_b128 v76, v[184:187]
    s_waitcnt lgkmcnt(0)
    s_barrier
    ds_read_b32 v188, v80
    ds_read_b32 v189, v81
    ds_read_b32 v190, v82
    ds_read_b32 v191, v83
    ds_read_b32 v192, v84
    ds_read_b32 v193, v85
    ds_read_b32 v194, v86
    ds_read_b32 v195, v87
    ds_read_b32 v196, v88
    ds_read_b32 v197, v89
    ds_read_b32 v198, v90
    v_cndmask_b32 v69, 0, v69, s[28:29]
    s_waitcnt lgkmcnt(0)
    v_add_f32 v195, v195, v69
    v_cndmask_b32 v196, v196, 0, s[28:29]
    v_cndmask_b32 v197, v197, 0, s[28:29]
    v_cndmask_b32 v198, v198, 0, s[28:29]
    v_cvt_pk_bf16_f32 v200, v188, v189
    v_cvt_pk_bf16_f32 v201, v190, v191
    v_cvt_pk_bf16_f32 v202, v192, v193
    v_cvt_pk_bf16_f32 v203, v194, v195
    ds_write_b128 v77, v[200:203] offset:42496
    v_cvt_pk_bf16_f32 v204, v189, v190
    v_cvt_pk_bf16_f32 v205, v191, v192
    v_cvt_pk_bf16_f32 v206, v193, v194
    v_cvt_pk_bf16_f32 v207, v195, v196
    ds_write_b128 v77, v[204:207] offset:46656
    v_cvt_pk_bf16_f32 v208, v190, v191
    v_cvt_pk_bf16_f32 v209, v192, v193
    v_cvt_pk_bf16_f32 v210, v194, v195
    v_cvt_pk_bf16_f32 v211, v196, v197
    ds_write_b128 v77, v[208:211] offset:50816
    v_cvt_pk_bf16_f32 v212, v191, v192
    v_cvt_pk_bf16_f32 v213, v193, v194
    v_cvt_pk_bf16_f32 v214, v195, v196
    v_cvt_pk_bf16_f32 v215, v197, v198
    ds_write_b128 v77, v[212:215] offset:54976
    s_min_u32 s65, s3, 2
    s_add_u32 s50, s50, s65
    s_cmp_lt_u32 s3, 3
    s_cselect_b32 s68, 1, 0
    s_waitcnt lgkmcnt(0)
M_pre:
    s_cmp_lg_u32 s3, 0
    s_cbranch_scc1 M_pl_out
    s_cmp_eq_u32 s72, 1
    s_cbranch_scc1 M_pl_out
    s_load_dwordx2 s[24:25], s[0:1], 96
    v_lshlrev_b32 v11, 2, v0
    s_mov_b32 s26, 256
    s_mov_b32 s27, 0x00020000
    s_waitcnt lgkmcnt(0)
M_pl:
    buffer_load_dword v14, v11, s[24:27], 0 offen sc1
    s_waitcnt vmcnt(0)
    s_add_u32 s100, s100, 1
    s_cmp_ge_u32 s100, 262144
    s_cbranch_scc1 M_pl_out
    v_cmp_ne_u32 vcc, 1, v14
    s_nop 4
    s_cbranch_vccz M_pl_out
    s_sleep 3
    s_branch M_pl
M_pl_out:
    s_mov_b32 s16, s4
    s_mov_b32 s17, s5
    s_mov_b32 s18, 2359296
    s_mov_b32 s19, 0x00020000
    s_add_u32 s20, s4, 11870208
    s_addc_u32 s21, s5, 0
    s_mov_b32 s22, 18874368
    s_mov_b32 s23, 0x00020000
    s_add_u32 s28, s4, 7151616
    s_addc_u32 s29, s5, 0
    s_mov_b32 s30, 2359296
    s_mov_b32 s31, 0x00020000
    s_add_u32 s32, s4, 9510912
    s_addc_u32 s33, s5, 0
    s_mov_b32 s34, 2359296
    s_mov_b32 s35, 0x00020000
    s_add_u32 s36, s4, 40181760
    s_addc_u32 s37, s5, 0
    s_mov_b32 s38, 13312
    s_mov_b32 s39, 0x00020000
    s_barrier
    s_cmp_eq_u32 s68, 0
    s_cbranch_scc1 M_noconv
    s_lshl_b32 s66, s50, 6
    s_add_u32 s67, s51, 17152
    v_add_u32 v13, s67, v1
    s_cmp_eq_u32 s72, 1
    s_cbranch_scc1 M_havext
    v_lshrrev_b32 v11, 2, v0
    v_mul_u32_u24 v11, 36864, v11
    v_and_b32 v12, 3, v0
    v_lshl_add_u32 v11, v12, 4, v11
    buffer_load_dwordx4 v[16:19], v11, s[28:31], s66 offen sc1
    s_add_u32 s66, s66, 589824
    buffer_load_dwordx4 v[20:23], v11, s[28:31], s66 offen sc1
    s_add_u32 s66, s66, 589824
    buffer_load_dwordx4 v[24:27], v11, s[28:31], s66 offen sc1
    s_add_u32 s66, s66, 589824
    buffer_load_dwordx4 v[28:31], v11, s[28:31], s66 offen sc1
M_havext:
    s_waitcnt vmcnt(0)
    ds_write_b128 v13, v[16:19] offset:0
    ds_write_b128 v13, v[20:23] offset:1024
    ds_write_b128 v13, v[24:27] offset:2048
    ds_write_b128 v13, v[28:31] offset:3072
    s_waitcnt lgkmcnt(0)
    ds_read_b128 v[112:115], v9 offset:448
    ds_read_b64 v[80:81], v8 offset:4032
    ds_read_b64 v[82:83], v8 offset:4040
    ds_read_b128 v[116:119], v9 offset:960
    ds_read_b64 v[84:85], v8 offset:3520
    ds_read_b64 v[86:87], v8 offset:3528
    ds_read_b128 v[120:123], v9 offset:1472
    ds_read_b64 v[88:89], v8 offset:3008
    ds_read_b64 v[90:91], v8 offset:3016
    ds_read_b128 v[124:127], v9 offset:1984
    ds_read_b64 v[92:93], v8 offset:2496
    ds_read_b64 v[94:95], v8 offset:2504
    ds_read_b128 v[128:131], v9 offset:2496
    ds_read_b64 v[96:97], v8 offset:1984
    ds_read_b64 v[98:99], v8 offset:1992
    ds_read_b128 v[132:135], v9 offset:3008
    ds_read_b64 v[100:101], v8 offset:1472
    ds_read_b64 v[102:103], v8 offset:1480
    ds_read_b128 v[136:139], v9 offset:3520
    ds_read_b64 v[104:105], v8 offset:960
    ds_read_b64 v[106:107], v8 offset:968
    ds_read_b128 v[140:143], v9 offset:4032
    ds_read_b64 v[108:109], v8 offset:448
    ds_read_b64 v[110:111], v8 offset:456
    s_waitcnt lgkmcnt(0)
    v_mfma_f32_16x16x32_bf16 v[48:51], v[80:83], v[112:115], 0
    ds_read_b128 v[176:179], v9 offset:384
    v_mfma_f32_16x16x32_bf16 v[52:55], v[80:83], v[116:119], 0
    ds_read_b64 v[144:145], v8 offset:3968
    v_mfma_f32_16x16x32_bf16 v[56:59], v[80:83], v[120:123], 0
    ds_read_b64 v[146:147], v8 offset:3976
    v_mfma_f32_16x16x32_bf16 v[60:63], v[80:83], v[124:127], 0
    ds_read_b128 v[180:183], v9 offset:896
    v_mfma_f32_16x16x32_bf16 v[64:67], v[80:83], v[128:131], 0
    ds_read_b64 v[148:149], v8 offset:3456
    v_mfma_f32_16x16x32_bf16 v[68:71], v[80:83], v[132:135], 0
    ds_read_b64 v[150:151], v8 offset:3464
    v_mfma_f32_16x16x32_bf16 v[72:75], v[80:83], v[136:139], 0
    ds_read_b128 v[184:187], v9 offset:1408
    v_mfma_f32_16x16x32_bf16 v[76:79], v[80:83], v[140:143], 0
    ds_read_b64 v[152:153], v8 offset:2944
    v_mfma_f32_16x16x32_bf16 v[52:55], v[84:87], v[112:115], v[52:55]
    ds_read_b64 v[154:155], v8 offset:2952
    v_mfma_f32_16x16x32_bf16 v[56:59], v[84:87], v[116:119], v[56:59]
    ds_read_b128 v[188:191], v9 offset:1920
    v_mfma_f32_16x16x32_bf16 v[60:63], v[84:87], v[120:123], v[60:63]
    ds_read_b64 v[156:157], v8 offset:2432
    v_mfma_f32_16x16x32_bf16 v[64:67], v[84:87], v[124:127], v[64:67]
    ds_read_b64 v[158:159], v8 offset:2440
    v_mfma_f32_16x16x32_bf16 v[68:71], v[84:87], v[128:131], v[68:71]
    ds_read_b128 v[192:195], v9 offset:2432
    v_mfma_f32_16x16x32_bf16 v[72:75], v[84:87], v[132:135], v[72:75]
    ds_read_b64 v[160:161], v8 offset:1920
    v_mfma_f32_16x16x32_bf16 v[76:79], v[84:87], v[136:139], v[76:79]
    ds_read_b64 v[162:163], v8 offset:1928
    v_mfma_f32_16x16x32_bf16 v[56:59], v[88:91], v[112:115], v[56:59]
    ds_read_b128 v[196:199], v9 offset:2944
    v_mfma_f32_16x16x32_bf16 v[60:63], v[88:91], v[116:119], v[60:63]
    ds_read_b64 v[164:165], v8 offset:1408
    v_mfma_f32_16x16x32_bf16 v[64:67], v[88:91], v[120:123], v[64:67]
    ds_read_b64 v[166:167], v8 offset:1416
    v_mfma_f32_16x16x32_bf16 v[68:71], v[88:91], v[124:127], v[68:71]
    ds_read_b128 v[200:203], v9 offset:3456
    v_mfma_f32_16x16x32_bf16 v[72:75], v[88:91], v[128:131], v[72:75]
    ds_read_b64 v[168:169], v8 offset:896
    v_mfma_f32_16x16x32_bf16 v[76:79], v[88:91], v[132:135], v[76:79]
    ds_read_b64 v[170:171], v8 offset:904
    v_mfma_f32_16x16x32_bf16 v[60:63], v[92:95], v[112:115], v[60:63]
    ds_read_b128 v[204:207], v9 offset:3968
    v_mfma_f32_16x16x32_bf16 v[64:67], v[92:95], v[116:119], v[64:67]
    ds_read_b64 v[172:173], v8 offset:384
    v_mfma_f32_16x16x32_bf16 v[68:71], v[92:95], v[120:123], v[68:71]
    ds_read_b64 v[174:175], v8 offset:392
    v_mfma_f32_16x16x32_bf16 v[72:75], v[92:95], v[124:127], v[72:75]
    v_mfma_f32_16x16x32_bf16 v[76:79], v[92:95], v[128:131], v[76:79]
    s_add_u32 m0, s40, 49152
    s_add_u32 s48, s42, 3538944
    buffer_load_dwordx4 v6, s[12:15], s48 offen lds
    v_mfma_f32_16x16x32_bf16 v[64:67], v[96:99], v[112:115], v[64:67]
    v_mfma_f32_16x16x32_bf16 v[68:71], v[96:99], v[116:119], v[68:71]
    s_add_u32 m0, s40, 50176
    s_add_u32 s48, s42, 3686400
    buffer_load_dwordx4 v6, s[12:15], s48 offen lds
    v_mfma_f32_16x16x32_bf16 v[72:75], v[96:99], v[120:123], v[72:75]
    v_mfma_f32_16x16x32_bf16 v[76:79], v[96:99], v[124:127], v[76:79]
    s_add_u32 m0, s40, 57344
    s_add_u32 s48, s42, 4128768
    buffer_load_dwordx4 v6, s[12:15], s48 offen lds
    v_mfma_f32_16x16x32_bf16 v[68:71], v[100:103], v[112:115], v[68:71]
    s_add_u32 m0, s40, 58368
    s_add_u32 s48, s42, 4276224
    buffer_load_dwordx4 v6, s[12:15], s48 offen lds
    v_mfma_f32_16x16x32_bf16 v[72:75], v[100:103], v[116:119], v[72:75]
    v_mfma_f32_16x16x32_bf16 v[76:79], v[100:103], v[120:123], v[76:79]
    buffer_load_dwordx4 a[0:3], v1, s[16:19], s44 offen offset:0 sc1
    v_mfma_f32_16x16x32_bf16 v[72:75], v[104:107], v[112:115], v[72:75]
    v_mfma_f32_16x16x32_bf16 v[76:79], v[104:107], v[116:119], v[76:79]
    buffer_load_dwordx4 a[4:7], v1, s[16:19], s69 offen offset:0 sc1
    v_mfma_f32_16x16x32_bf16 v[76:79], v[108:111], v[112:115], v[76:79]
    s_waitcnt lgkmcnt(0)
    v_mfma_f32_16x16x32_bf16 v[48:51], v[144:147], v[176:179], v[48:51]
    ds_read_b128 v[112:115], v9 offset:320
    v_mfma_f32_16x16x32_bf16 v[52:55], v[144:147], v[180:183], v[52:55]
    ds_read_b64 v[80:81], v8 offset:3904
    v_mfma_f32_16x16x32_bf16 v[56:59], v[144:147], v[184:187], v[56:59]
    ds_read_b64 v[82:83], v8 offset:3912
    v_mfma_f32_16x16x32_bf16 v[60:63], v[144:147], v[188:191], v[60:63]
    ds_read_b128 v[116:119], v9 offset:832
    v_mfma_f32_16x16x32_bf16 v[64:67], v[144:147], v[192:195], v[64:67]
    ds_read_b64 v[84:85], v8 offset:3392
    v_mfma_f32_16x16x32_bf16 v[68:71], v[144:147], v[196:199], v[68:71]
    ds_read_b64 v[86:87], v8 offset:3400
    v_mfma_f32_16x16x32_bf16 v[72:75], v[144:147], v[200:203], v[72:75]
    ds_read_b128 v[120:123], v9 offset:1344
    v_mfma_f32_16x16x32_bf16 v[76:79], v[144:147], v[204:207], v[76:79]
    ds_read_b64 v[88:89], v8 offset:2880
    v_mfma_f32_16x16x32_bf16 v[52:55], v[148:151], v[176:179], v[52:55]
    ds_read_b64 v[90:91], v8 offset:2888
    v_mfma_f32_16x16x32_bf16 v[56:59], v[148:151], v[180:183], v[56:59]
    ds_read_b128 v[124:127], v9 offset:1856
    v_mfma_f32_16x16x32_bf16 v[60:63], v[148:151], v[184:187], v[60:63]
    ds_read_b64 v[92:93], v8 offset:2368
    v_mfma_f32_16x16x32_bf16 v[64:67], v[148:151], v[188:191], v[64:67]
    ds_read_b64 v[94:95], v8 offset:2376
    v_mfma_f32_16x16x32_bf16 v[68:71], v[148:151], v[192:195], v[68:71]
    ds_read_b128 v[128:131], v9 offset:2368
    v_mfma_f32_16x16x32_bf16 v[72:75], v[148:151], v[196:199], v[72:75]
    ds_read_b64 v[96:97], v8 offset:1856
    v_mfma_f32_16x16x32_bf16 v[76:79], v[148:151], v[200:203], v[76:79]
    ds_read_b64 v[98:99], v8 offset:1864
    v_mfma_f32_16x16x32_bf16 v[56:59], v[152:155], v[176:179], v[56:59]
    ds_read_b128 v[132:135], v9 offset:2880
    v_mfma_f32_16x16x32_bf16 v[60:63], v[152:155], v[180:183], v[60:63]
    ds_read_b64 v[100:101], v8 offset:1344
    v_mfma_f32_16x16x32_bf16 v[64:67], v[152:155], v[184:187], v[64:67]
    ds_read_b64 v[102:103], v8 offset:1352
    v_mfma_f32_16x16x32_bf16 v[68:71], v[152:155], v[188:191], v[68:71]
    ds_read_b128 v[136:139], v9 offset:3392
    v_mfma_f32_16x16x32_bf16 v[72:75], v[152:155], v[192:195], v[72:75]
    ds_read_b64 v[104:105], v8 offset:832
    v_mfma_f32_16x16x32_bf16 v[76:79], v[152:155], v[196:199], v[76:79]
    ds_read_b64 v[106:107], v8 offset:840
    v_mfma_f32_16x16x32_bf16 v[60:63], v[156:159], v[176:179], v[60:63]
    ds_read_b128 v[140:143], v9 offset:3904
    v_mfma_f32_16x16x32_bf16 v[64:67], v[156:159], v[180:183], v[64:67]
    ds_read_b64 v[108:109], v8 offset:320
    v_mfma_f32_16x16x32_bf16 v[68:71], v[156:159], v[184:187], v[68:71]
    ds_read_b64 v[110:111], v8 offset:328
    v_mfma_f32_16x16x32_bf16 v[72:75], v[156:159], v[188:191], v[72:75]
    buffer_load_dwordx4 a[8:11], v1, s[16:19], s70 offen offset:0 sc1
    v_mfma_f32_16x16x32_bf16 v[76:79], v[156:159], v[192:195], v[76:79]
    buffer_load_dwordx4 a[12:15], v1, s[16:19], s71 offen offset:0 sc1
    v_mfma_f32_16x16x32_bf16 v[64:67], v[160:163], v[176:179], v[64:67]
    v_mfma_f32_16x16x32_bf16 v[68:71], v[160:163], v[180:183], v[68:71]
    buffer_load_dwordx4 a[16:19], v1, s[16:19], s44 offen offset:1024 sc1
    v_mfma_f32_16x16x32_bf16 v[72:75], v[160:163], v[184:187], v[72:75]
    v_mfma_f32_16x16x32_bf16 v[76:79], v[160:163], v[188:191], v[76:79]
    buffer_load_dwordx4 a[20:23], v1, s[16:19], s69 offen offset:1024 sc1
    v_mfma_f32_16x16x32_bf16 v[68:71], v[164:167], v[176:179], v[68:71]
    v_mfma_f32_16x16x32_bf16 v[72:75], v[164:167], v[180:183], v[72:75]
    buffer_load_dwordx4 a[24:27], v1, s[16:19], s70 offen offset:1024 sc1
    v_mfma_f32_16x16x32_bf16 v[76:79], v[164:167], v[184:187], v[76:79]
    buffer_load_dwordx4 a[28:31], v1, s[16:19], s71 offen offset:1024 sc1
    v_mfma_f32_16x16x32_bf16 v[72:75], v[168:171], v[176:179], v[72:75]
    v_mfma_f32_16x16x32_bf16 v[76:79], v[168:171], v[180:183], v[76:79]
    buffer_load_dwordx4 a[32:35], v1, s[16:19], s44 offen offset:2048 sc1
    v_mfma_f32_16x16x32_bf16 v[76:79], v[172:175], v[176:179], v[76:79]
    s_waitcnt lgkmcnt(0)
    v_mfma_f32_16x16x32_bf16 v[48:51], v[80:83], v[112:115], v[48:51]
    ds_read_b128 v[176:179], v9 offset:256
    v_mfma_f32_16x16x32_bf16 v[52:55], v[80:83], v[116:119], v[52:55]
    ds_read_b64 v[144:145], v8 offset:3840
    v_mfma_f32_16x16x32_bf16 v[56:59], v[80:83], v[120:123], v[56:59]
    ds_read_b64 v[146:147], v8 offset:3848
    v_mfma_f32_16x16x32_bf16 v[60:63], v[80:83], v[124:127], v[60:63]
    ds_read_b128 v[180:183], v9 offset:768
    v_mfma_f32_16x16x32_bf16 v[64:67], v[80:83], v[128:131], v[64:67]
    ds_read_b64 v[148:149], v8 offset:3328
    v_mfma_f32_16x16x32_bf16 v[68:71], v[80:83], v[132:135], v[68:71]
    ds_read_b64 v[150:151], v8 offset:3336
    v_mfma_f32_16x16x32_bf16 v[72:75], v[80:83], v[136:139], v[72:75]
    ds_read_b128 v[184:187], v9 offset:1280
    v_mfma_f32_16x16x32_bf16 v[76:79], v[80:83], v[140:143], v[76:79]
    ds_read_b64 v[152:153], v8 offset:2816
    v_mfma_f32_16x16x32_bf16 v[52:55], v[84:87], v[112:115], v[52:55]
    ds_read_b64 v[154:155], v8 offset:2824
    v_mfma_f32_16x16x32_bf16 v[56:59], v[84:87], v[116:119], v[56:59]
    ds_read_b128 v[188:191], v9 offset:1792
    v_mfma_f32_16x16x32_bf16 v[60:63], v[84:87], v[120:123], v[60:63]
    ds_read_b64 v[156:157], v8 offset:2304
    v_mfma_f32_16x16x32_bf16 v[64:67], v[84:87], v[124:127], v[64:67]
    ds_read_b64 v[158:159], v8 offset:2312
    v_mfma_f32_16x16x32_bf16 v[68:71], v[84:87], v[128:131], v[68:71]
    ds_read_b128 v[192:195], v9 offset:2304
    v_mfma_f32_16x16x32_bf16 v[72:75], v[84:87], v[132:135], v[72:75]
    ds_read_b64 v[160:161], v8 offset:1792
    v_mfma_f32_16x16x32_bf16 v[76:79], v[84:87], v[136:139], v[76:79]
    ds_read_b64 v[162:163], v8 offset:1800
    v_mfma_f32_16x16x32_bf16 v[56:59], v[88:91], v[112:115], v[56:59]
    ds_read_b128 v[196:199], v9 offset:2816
    v_mfma_f32_16x16x32_bf16 v[60:63], v[88:91], v[116:119], v[60:63]
    ds_read_b64 v[164:165], v8 offset:1280
    v_mfma_f32_16x16x32_bf16 v[64:67], v[88:91], v[120:123], v[64:67]
    ds_read_b64 v[166:167], v8 offset:1288
    v_mfma_f32_16x16x32_bf16 v[68:71], v[88:91], v[124:127], v[68:71]
    ds_read_b128 v[200:203], v9 offset:3328
    v_mfma_f32_16x16x32_bf16 v[72:75], v[88:91], v[128:131], v[72:75]
    ds_read_b64 v[168:169], v8 offset:768
    v_mfma_f32_16x16x32_bf16 v[76:79], v[88:91], v[132:135], v[76:79]
    ds_read_b64 v[170:171], v8 offset:776
    v_mfma_f32_16x16x32_bf16 v[60:63], v[92:95], v[112:115], v[60:63]
    ds_read_b128 v[204:207], v9 offset:3840
    v_mfma_f32_16x16x32_bf16 v[64:67], v[92:95], v[116:119], v[64:67]
    ds_read_b64 v[172:173], v8 offset:256
    v_mfma_f32_16x16x32_bf16 v[68:71], v[92:95], v[120:123], v[68:71]
    ds_read_b64 v[174:175], v8 offset:264
    v_mfma_f32_16x16x32_bf16 v[72:75], v[92:95], v[124:127], v[72:75]
    buffer_load_dwordx4 a[36:39], v1, s[16:19], s69 offen offset:2048 sc1
    v_mfma_f32_16x16x32_bf16 v[76:79], v[92:95], v[128:131], v[76:79]
    v_mfma_f32_16x16x32_bf16 v[64:67], v[96:99], v[112:115], v[64:67]
    buffer_load_dwordx4 a[40:43], v1, s[16:19], s70 offen offset:2048 sc1
    v_mfma_f32_16x16x32_bf16 v[68:71], v[96:99], v[116:119], v[68:71]
    buffer_load_dwordx4 a[44:47], v1, s[16:19], s71 offen offset:2048 sc1
    v_mfma_f32_16x16x32_bf16 v[72:75], v[96:99], v[120:123], v[72:75]
    v_mfma_f32_16x16x32_bf16 v[76:79], v[96:99], v[124:127], v[76:79]
    buffer_load_dwordx4 a[48:51], v1, s[16:19], s44 offen offset:3072 sc1
    v_mfma_f32_16x16x32_bf16 v[68:71], v[100:103], v[112:115], v[68:71]
    v_mfma_f32_16x16x32_bf16 v[72:75], v[100:103], v[116:119], v[72:75]
    buffer_load_dwordx4 a[52:55], v1, s[16:19], s69 offen offset:3072 sc1
    v_mfma_f32_16x16x32_bf16 v[76:79], v[100:103], v[120:123], v[76:79]
    v_mfma_f32_16x16x32_bf16 v[72:75], v[104:107], v[112:115], v[72:75]
    buffer_load_dwordx4 a[56:59], v1, s[16:19], s70 offen offset:3072 sc1
    v_mfma_f32_16x16x32_bf16 v[76:79], v[104:107], v[116:119], v[76:79]
    buffer_load_dwordx4 a[60:63], v1, s[16:19], s71 offen offset:3072 sc1
    v_mfma_f32_16x16x32_bf16 v[76:79], v[108:111], v[112:115], v[76:79]
    s_waitcnt lgkmcnt(0)
    v_mfma_f32_16x16x32_bf16 v[48:51], v[144:147], v[176:179], v[48:51]
    ds_read_b128 v[112:115], v9 offset:192
    v_mfma_f32_16x16x32_bf16 v[52:55], v[144:147], v[180:183], v[52:55]
    ds_read_b64 v[80:81], v8 offset:3776
    v_mfma_f32_16x16x32_bf16 v[56:59], v[144:147], v[184:187], v[56:59]
    ds_read_b64 v[82:83], v8 offset:3784
    v_mfma_f32_16x16x32_bf16 v[60:63], v[144:147], v[188:191], v[60:63]
    ds_read_b128 v[116:119], v9 offset:704
    v_mfma_f32_16x16x32_bf16 v[64:67], v[144:147], v[192:195], v[64:67]
    ds_read_b64 v[84:85], v8 offset:3264
    v_mfma_f32_16x16x32_bf16 v[68:71], v[144:147], v[196:199], v[68:71]
    ds_read_b64 v[86:87], v8 offset:3272
    v_mfma_f32_16x16x32_bf16 v[72:75], v[144:147], v[200:203], v[72:75]
    ds_read_b128 v[120:123], v9 offset:1216
    v_mfma_f32_16x16x32_bf16 v[76:79], v[144:147], v[204:207], v[76:79]
    ds_read_b64 v[88:89], v8 offset:2752
    v_mfma_f32_16x16x32_bf16 v[52:55], v[148:151], v[176:179], v[52:55]
    ds_read_b64 v[90:91], v8 offset:2760
    v_mfma_f32_16x16x32_bf16 v[56:59], v[148:151], v[180:183], v[56:59]
    ds_read_b128 v[124:127], v9 offset:1728
    v_mfma_f32_16x16x32_bf16 v[60:63], v[148:151], v[184:187], v[60:63]
    ds_read_b64 v[92:93], v8 offset:2240
    v_mfma_f32_16x16x32_bf16 v[64:67], v[148:151], v[188:191], v[64:67]
    ds_read_b64 v[94:95], v8 offset:2248
    v_mfma_f32_16x16x32_bf16 v[68:71], v[148:151], v[192:195], v[68:71]
    ds_read_b128 v[128:131], v9 offset:2240
    v_mfma_f32_16x16x32_bf16 v[72:75], v[148:151], v[196:199], v[72:75]
    ds_read_b64 v[96:97], v8 offset:1728
    v_mfma_f32_16x16x32_bf16 v[76:79], v[148:151], v[200:203], v[76:79]
    ds_read_b64 v[98:99], v8 offset:1736
    v_mfma_f32_16x16x32_bf16 v[56:59], v[152:155], v[176:179], v[56:59]
    ds_read_b128 v[132:135], v9 offset:2752
    v_mfma_f32_16x16x32_bf16 v[60:63], v[152:155], v[180:183], v[60:63]
    ds_read_b64 v[100:101], v8 offset:1216
    v_mfma_f32_16x16x32_bf16 v[64:67], v[152:155], v[184:187], v[64:67]
    ds_read_b64 v[102:103], v8 offset:1224
    v_mfma_f32_16x16x32_bf16 v[68:71], v[152:155], v[188:191], v[68:71]
    ds_read_b128 v[136:139], v9 offset:3264
    v_mfma_f32_16x16x32_bf16 v[72:75], v[152:155], v[192:195], v[72:75]
    ds_read_b64 v[104:105], v8 offset:704
    v_mfma_f32_16x16x32_bf16 v[76:79], v[152:155], v[196:199], v[76:79]
    ds_read_b64 v[106:107], v8 offset:712
    v_mfma_f32_16x16x32_bf16 v[60:63], v[156:159], v[176:179], v[60:63]
    ds_read_b128 v[140:143], v9 offset:3776
    v_mfma_f32_16x16x32_bf16 v[64:67], v[156:159], v[180:183], v[64:67]
    ds_read_b64 v[108:109], v8 offset:192
    v_mfma_f32_16x16x32_bf16 v[68:71], v[156:159], v[184:187], v[68:71]
    ds_read_b64 v[110:111], v8 offset:200
    v_mfma_f32_16x16x32_bf16 v[72:75], v[156:159], v[188:191], v[72:75]
    s_add_u32 s44, s44, 4096
    s_add_u32 s69, s69, 4096
    s_add_u32 s70, s70, 4096
    s_add_u32 s71, s71, 4096
    v_mfma_f32_16x16x32_bf16 v[76:79], v[156:159], v[192:195], v[76:79]
    v_mfma_f32_16x16x32_bf16 v[64:67], v[160:163], v[176:179], v[64:67]
    buffer_load_dwordx4 a[64:67], v1, s[16:19], s44 offen offset:0 sc1
    v_mfma_f32_16x16x32_bf16 v[68:71], v[160:163], v[180:183], v[68:71]
    v_mfma_f32_16x16x32_bf16 v[72:75], v[160:163], v[184:187], v[72:75]
    buffer_load_dwordx4 a[68:71], v1, s[16:19], s69 offen offset:0 sc1
    v_mfma_f32_16x16x32_bf16 v[76:79], v[160:163], v[188:191], v[76:79]
    buffer_load_dwordx4 a[72:75], v1, s[16:19], s70 offen offset:0 sc1
    v_mfma_f32_16x16x32_bf16 v[68:71], v[164:167], v[176:179], v[68:71]
    v_mfma_f32_16x16x32_bf16 v[72:75], v[164:167], v[180:183], v[72:75]
    buffer_load_dwordx4 a[76:79], v1, s[16:19], s71 offen offset:0 sc1
    v_mfma_f32_16x16x32_bf16 v[76:79], v[164:167], v[184:187], v[76:79]
    v_mfma_f32_16x16x32_bf16 v[72:75], v[168:171], v[176:179], v[72:75]
    buffer_load_dwordx4 a[80:83], v1, s[16:19], s44 offen offset:1024 sc1
    v_mfma_f32_16x16x32_bf16 v[76:79], v[168:171], v[180:183], v[76:79]
    v_mfma_f32_16x16x32_bf16 v[76:79], v[172:175], v[176:179], v[76:79]
    buffer_load_dwordx4 a[84:87], v1, s[16:19], s69 offen offset:1024 sc1
    s_waitcnt lgkmcnt(0)
    v_mfma_f32_16x16x32_bf16 v[48:51], v[80:83], v[112:115], v[48:51]
    ds_read_b128 v[176:179], v9 offset:128
    v_mfma_f32_16x16x32_bf16 v[52:55], v[80:83], v[116:119], v[52:55]
    ds_read_b64 v[144:145], v8 offset:3712
    v_mfma_f32_16x16x32_bf16 v[56:59], v[80:83], v[120:123], v[56:59]
    ds_read_b64 v[146:147], v8 offset:3720
    v_mfma_f32_16x16x32_bf16 v[60:63], v[80:83], v[124:127], v[60:63]
    ds_read_b128 v[180:183], v9 offset:640
    v_mfma_f32_16x16x32_bf16 v[64:67], v[80:83], v[128:131], v[64:67]
    ds_read_b64 v[148:149], v8 offset:3200
    v_mfma_f32_16x16x32_bf16 v[68:71], v[80:83], v[132:135], v[68:71]
    ds_read_b64 v[150:151], v8 offset:3208
    v_mfma_f32_16x16x32_bf16 v[72:75], v[80:83], v[136:139], v[72:75]
    ds_read_b128 v[184:187], v9 offset:1152
    v_mfma_f32_16x16x32_bf16 v[76:79], v[80:83], v[140:143], v[76:79]
    ds_read_b64 v[152:153], v8 offset:2688
    v_mfma_f32_16x16x32_bf16 v[52:55], v[84:87], v[112:115], v[52:55]
    ds_read_b64 v[154:155], v8 offset:2696
    v_mfma_f32_16x16x32_bf16 v[56:59], v[84:87], v[116:119], v[56:59]
    ds_read_b128 v[188:191], v9 offset:1664
    v_mfma_f32_16x16x32_bf16 v[60:63], v[84:87], v[120:123], v[60:63]
    ds_read_b64 v[156:157], v8 offset:2176
    v_mfma_f32_16x16x32_bf16 v[64:67], v[84:87], v[124:127], v[64:67]
    ds_read_b64 v[158:159], v8 offset:2184
    v_mfma_f32_16x16x32_bf16 v[68:71], v[84:87], v[128:131], v[68:71]
    ds_read_b128 v[192:195], v9 offset:2176
    v_mfma_f32_16x16x32_bf16 v[72:75], v[84:87], v[132:135], v[72:75]
    ds_read_b64 v[160:161], v8 offset:1664
    v_mfma_f32_16x16x32_bf16 v[76:79], v[84:87], v[136:139], v[76:79]
    ds_read_b64 v[162:163], v8 offset:1672
    v_mfma_f32_16x16x32_bf16 v[56:59], v[88:91], v[112:115], v[56:59]
    ds_read_b128 v[196:199], v9 offset:2688
    v_mfma_f32_16x16x32_bf16 v[60:63], v[88:91], v[116:119], v[60:63]
    ds_read_b64 v[164:165], v8 offset:1152
    v_mfma_f32_16x16x32_bf16 v[64:67], v[88:91], v[120:123], v[64:67]
    ds_read_b64 v[166:167], v8 offset:1160
    v_mfma_f32_16x16x32_bf16 v[68:71], v[88:91], v[124:127], v[68:71]
    ds_read_b128 v[200:203], v9 offset:3200
    v_mfma_f32_16x16x32_bf16 v[72:75], v[88:91], v[128:131], v[72:75]
    ds_read_b64 v[168:169], v8 offset:640
    v_mfma_f32_16x16x32_bf16 v[76:79], v[88:91], v[132:135], v[76:79]
    ds_read_b64 v[170:171], v8 offset:648
    v_mfma_f32_16x16x32_bf16 v[60:63], v[92:95], v[112:115], v[60:63]
    ds_read_b128 v[204:207], v9 offset:3712
    v_mfma_f32_16x16x32_bf16 v[64:67], v[92:95], v[116:119], v[64:67]
    ds_read_b64 v[172:173], v8 offset:128
    v_mfma_f32_16x16x32_bf16 v[68:71], v[92:95], v[120:123], v[68:71]
    ds_read_b64 v[174:175], v8 offset:136
    v_mfma_f32_16x16x32_bf16 v[72:75], v[92:95], v[124:127], v[72:75]
    buffer_load_dwordx4 a[88:91], v1, s[16:19], s70 offen offset:1024 sc1
    v_mfma_f32_16x16x32_bf16 v[76:79], v[92:95], v[128:131], v[76:79]
    v_mfma_f32_16x16x32_bf16 v[64:67], v[96:99], v[112:115], v[64:67]
    buffer_load_dwordx4 a[92:95], v1, s[16:19], s71 offen offset:1024 sc1
    v_mfma_f32_16x16x32_bf16 v[68:71], v[96:99], v[116:119], v[68:71]
    v_mfma_f32_16x16x32_bf16 v[72:75], v[96:99], v[120:123], v[72:75]
    buffer_load_dwordx4 a[96:99], v1, s[16:19], s44 offen offset:2048 sc1
    v_mfma_f32_16x16x32_bf16 v[76:79], v[96:99], v[124:127], v[76:79]
    v_mfma_f32_16x16x32_bf16 v[68:71], v[100:103], v[112:115], v[68:71]
    buffer_load_dwordx4 a[100:103], v1, s[16:19], s69 offen offset:2048 sc1
    v_mfma_f32_16x16x32_bf16 v[72:75], v[100:103], v[116:119], v[72:75]
    buffer_load_dwordx4 a[104:107], v1, s[16:19], s70 offen offset:2048 sc1
    v_mfma_f32_16x16x32_bf16 v[76:79], v[100:103], v[120:123], v[76:79]
    v_mfma_f32_16x16x32_bf16 v[72:75], v[104:107], v[112:115], v[72:75]
    buffer_load_dwordx4 a[108:111], v1, s[16:19], s71 offen offset:2048 sc1
    v_mfma_f32_16x16x32_bf16 v[76:79], v[104:107], v[116:119], v[76:79]
    v_mfma_f32_16x16x32_bf16 v[76:79], v[108:111], v[112:115], v[76:79]
    buffer_load_dwordx4 a[112:115], v1, s[16:19], s44 offen offset:3072 sc1
    s_waitcnt lgkmcnt(0)
    v_mfma_f32_16x16x32_bf16 v[48:51], v[144:147], v[176:179], v[48:51]
    ds_read_b128 v[112:115], v9 offset:64
    v_mfma_f32_16x16x32_bf16 v[52:55], v[144:147], v[180:183], v[52:55]
    ds_read_b64 v[80:81], v8 offset:3648
    v_mfma_f32_16x16x32_bf16 v[56:59], v[144:147], v[184:187], v[56:59]
    ds_read_b64 v[82:83], v8 offset:3656
    v_mfma_f32_16x16x32_bf16 v[60:63], v[144:147], v[188:191], v[60:63]
    ds_read_b128 v[116:119], v9 offset:576
    v_mfma_f32_16x16x32_bf16 v[64:67], v[144:147], v[192:195], v[64:67]
    ds_read_b64 v[84:85], v8 offset:3136
    v_mfma_f32_16x16x32_bf16 v[68:71], v[144:147], v[196:199], v[68:71]
    ds_read_b64 v[86:87], v8 offset:3144
    v_mfma_f32_16x16x32_bf16 v[72:75], v[144:147], v[200:203], v[72:75]
    ds_read_b128 v[120:123], v9 offset:1088
    v_mfma_f32_16x16x32_bf16 v[76:79], v[144:147], v[204:207], v[76:79]
    ds_read_b64 v[88:89], v8 offset:2624
    v_mfma_f32_16x16x32_bf16 v[52:55], v[148:151], v[176:179], v[52:55]
    ds_read_b64 v[90:91], v8 offset:2632
    v_mfma_f32_16x16x32_bf16 v[56:59], v[148:151], v[180:183], v[56:59]
    ds_read_b128 v[124:127], v9 offset:1600
    v_mfma_f32_16x16x32_bf16 v[60:63], v[148:151], v[184:187], v[60:63]
    ds_read_b64 v[92:93], v8 offset:2112
    v_mfma_f32_16x16x32_bf16 v[64:67], v[148:151], v[188:191], v[64:67]
    ds_read_b64 v[94:95], v8 offset:2120
    v_mfma_f32_16x16x32_bf16 v[68:71], v[148:151], v[192:195], v[68:71]
    ds_read_b128 v[128:131], v9 offset:2112
    v_mfma_f32_16x16x32_bf16 v[72:75], v[148:151], v[196:199], v[72:75]
    ds_read_b64 v[96:97], v8 offset:1600
    v_mfma_f32_16x16x32_bf16 v[76:79], v[148:151], v[200:203], v[76:79]
    ds_read_b64 v[98:99], v8 offset:1608
    v_mfma_f32_16x16x32_bf16 v[56:59], v[152:155], v[176:179], v[56:59]
    ds_read_b128 v[132:135], v9 offset:2624
    v_mfma_f32_16x16x32_bf16 v[60:63], v[152:155], v[180:183], v[60:63]
    ds_read_b64 v[100:101], v8 offset:1088
    v_mfma_f32_16x16x32_bf16 v[64:67], v[152:155], v[184:187], v[64:67]
    ds_read_b64 v[102:103], v8 offset:1096
    v_mfma_f32_16x16x32_bf16 v[68:71], v[152:155], v[188:191], v[68:71]
    ds_read_b128 v[136:139], v9 offset:3136
    v_mfma_f32_16x16x32_bf16 v[72:75], v[152:155], v[192:195], v[72:75]
    ds_read_b64 v[104:105], v8 offset:576
    v_mfma_f32_16x16x32_bf16 v[76:79], v[152:155], v[196:199], v[76:79]
    ds_read_b64 v[106:107], v8 offset:584
    v_mfma_f32_16x16x32_bf16 v[60:63], v[156:159], v[176:179], v[60:63]
    ds_read_b128 v[140:143], v9 offset:3648
    v_mfma_f32_16x16x32_bf16 v[64:67], v[156:159], v[180:183], v[64:67]
    ds_read_b64 v[108:109], v8 offset:64
    v_mfma_f32_16x16x32_bf16 v[68:71], v[156:159], v[184:187], v[68:71]
    ds_read_b64 v[110:111], v8 offset:72
    v_mfma_f32_16x16x32_bf16 v[72:75], v[156:159], v[188:191], v[72:75]
    v_mfma_f32_16x16x32_bf16 v[76:79], v[156:159], v[192:195], v[76:79]
    buffer_load_dwordx4 a[116:119], v1, s[16:19], s69 offen offset:3072 sc1
    v_mfma_f32_16x16x32_bf16 v[64:67], v[160:163], v[176:179], v[64:67]
    buffer_load_dwordx4 a[120:123], v1, s[16:19], s70 offen offset:3072 sc1
    v_mfma_f32_16x16x32_bf16 v[68:71], v[160:163], v[180:183], v[68:71]
    v_mfma_f32_16x16x32_bf16 v[72:75], v[160:163], v[184:187], v[72:75]
    buffer_load_dwordx4 a[124:127], v1, s[16:19], s71 offen offset:3072 sc1
    v_mfma_f32_16x16x32_bf16 v[76:79], v[160:163], v[188:191], v[76:79]
    v_mfma_f32_16x16x32_bf16 v[68:71], v[164:167], v[176:179], v[68:71]
    s_add_u32 s44, s44, 4096
    s_add_u32 s69, s69, 4096
    s_add_u32 s70, s70, 4096
    s_add_u32 s71, s71, 4096
    v_mfma_f32_16x16x32_bf16 v[72:75], v[164:167], v[180:183], v[72:75]
    v_mfma_f32_16x16x32_bf16 v[76:79], v[164:167], v[184:187], v[76:79]
    buffer_load_dwordx4 a[128:131], v1, s[16:19], s44 offen offset:0 sc1
    v_mfma_f32_16x16x32_bf16 v[72:75], v[168:171], v[176:179], v[72:75]
    buffer_load_dwordx4 a[132:135], v1, s[16:19], s69 offen offset:0 sc1
    v_mfma_f32_16x16x32_bf16 v[76:79], v[168:171], v[180:183], v[76:79]
    v_mfma_f32_16x16x32_bf16 v[76:79], v[172:175], v[176:179], v[76:79]
    buffer_load_dwordx4 a[136:139], v1, s[16:19], s70 offen offset:0 sc1
    s_waitcnt lgkmcnt(0)
    v_mfma_f32_16x16x32_bf16 v[48:51], v[80:83], v[112:115], v[48:51]
    ds_read_b128 v[176:179], v9 offset:0
    v_mfma_f32_16x16x32_bf16 v[52:55], v[80:83], v[116:119], v[52:55]
    ds_read_b64 v[144:145], v8 offset:3584
    v_mfma_f32_16x16x32_bf16 v[56:59], v[80:83], v[120:123], v[56:59]
    ds_read_b64 v[146:147], v8 offset:3592
    v_mfma_f32_16x16x32_bf16 v[60:63], v[80:83], v[124:127], v[60:63]
    ds_read_b128 v[180:183], v9 offset:512
    v_mfma_f32_16x16x32_bf16 v[64:67], v[80:83], v[128:131], v[64:67]
    ds_read_b64 v[148:149], v8 offset:3072
    v_mfma_f32_16x16x32_bf16 v[68:71], v[80:83], v[132:135], v[68:71]
    ds_read_b64 v[150:151], v8 offset:3080
    v_mfma_f32_16x16x32_bf16 v[72:75], v[80:83], v[136:139], v[72:75]
    ds_read_b128 v[184:187], v9 offset:1024
    v_mfma_f32_16x16x32_bf16 v[76:79], v[80:83], v[140:143], v[76:79]
    ds_read_b64 v[152:153], v8 offset:2560
    v_mfma_f32_16x16x32_bf16 v[52:55], v[84:87], v[112:115], v[52:55]
    ds_read_b64 v[154:155], v8 offset:2568
    v_mfma_f32_16x16x32_bf16 v[56:59], v[84:87], v[116:119], v[56:59]
    ds_read_b128 v[188:191], v9 offset:1536
    v_mfma_f32_16x16x32_bf16 v[60:63], v[84:87], v[120:123], v[60:63]
    ds_read_b64 v[156:157], v8 offset:2048
    v_mfma_f32_16x16x32_bf16 v[64:67], v[84:87], v[124:127], v[64:67]
    ds_read_b64 v[158:159], v8 offset:2056
    v_mfma_f32_16x16x32_bf16 v[68:71], v[84:87], v[128:131], v[68:71]
    ds_read_b128 v[192:195], v9 offset:2048
    v_mfma_f32_16x16x32_bf16 v[72:75], v[84:87], v[132:135], v[72:75]
    ds_read_b64 v[160:161], v8 offset:1536
    v_mfma_f32_16x16x32_bf16 v[76:79], v[84:87], v[136:139], v[76:79]
    ds_read_b64 v[162:163], v8 offset:1544
    v_mfma_f32_16x16x32_bf16 v[56:59], v[88:91], v[112:115], v[56:59]
    ds_read_b128 v[196:199], v9 offset:2560
    v_mfma_f32_16x16x32_bf16 v[60:63], v[88:91], v[116:119], v[60:63]
    ds_read_b64 v[164:165], v8 offset:1024
    v_mfma_f32_16x16x32_bf16 v[64:67], v[88:91], v[120:123], v[64:67]
    ds_read_b64 v[166:167], v8 offset:1032
    v_mfma_f32_16x16x32_bf16 v[68:71], v[88:91], v[124:127], v[68:71]
    ds_read_b128 v[200:203], v9 offset:3072
    v_mfma_f32_16x16x32_bf16 v[72:75], v[88:91], v[128:131], v[72:75]
    ds_read_b64 v[168:169], v8 offset:512
    v_mfma_f32_16x16x32_bf16 v[76:79], v[88:91], v[132:135], v[76:79]
    ds_read_b64 v[170:171], v8 offset:520
    v_mfma_f32_16x16x32_bf16 v[60:63], v[92:95], v[112:115], v[60:63]
    ds_read_b128 v[204:207], v9 offset:3584
    v_mfma_f32_16x16x32_bf16 v[64:67], v[92:95], v[116:119], v[64:67]
    ds_read_b64 v[172:173], v8 offset:0
    v_mfma_f32_16x16x32_bf16 v[68:71], v[92:95], v[120:123], v[68:71]
    ds_read_b64 v[174:175], v8 offset:8
    v_mfma_f32_16x16x32_bf16 v[72:75], v[92:95], v[124:127], v[72:75]
    v_mfma_f32_16x16x32_bf16 v[76:79], v[92:95], v[128:131], v[76:79]
    buffer_load_dwordx4 a[140:143], v1, s[16:19], s71 offen offset:0 sc1
    v_mfma_f32_16x16x32_bf16 v[64:67], v[96:99], v[112:115], v[64:67]
    v_mfma_f32_16x16x32_bf16 v[68:71], v[96:99], v[116:119], v[68:71]
    buffer_load_dwordx4 a[144:147], v1, s[16:19], s44 offen offset:1024 sc1
    v_mfma_f32_16x16x32_bf16 v[72:75], v[96:99], v[120:123], v[72:75]
    buffer_load_dwordx4 a[148:151], v1, s[16:19], s69 offen offset:1024 sc1
    v_mfma_f32_16x16x32_bf16 v[76:79], v[96:99], v[124:127], v[76:79]
    v_mfma_f32_16x16x32_bf16 v[68:71], v[100:103], v[112:115], v[68:71]
    buffer_load_dwordx4 a[152:155], v1, s[16:19], s70 offen offset:1024 sc1
    v_mfma_f32_16x16x32_bf16 v[72:75], v[100:103], v[116:119], v[72:75]
    v_mfma_f32_16x16x32_bf16 v[76:79], v[100:103], v[120:123], v[76:79]
    buffer_load_dwordx4 a[156:159], v1, s[16:19], s71 offen offset:1024 sc1
    v_mfma_f32_16x16x32_bf16 v[72:75], v[104:107], v[112:115], v[72:75]
    v_mfma_f32_16x16x32_bf16 v[76:79], v[104:107], v[116:119], v[76:79]
    buffer_load_dwordx4 a[160:163], v1, s[16:19], s44 offen offset:2048 sc1
    v_mfma_f32_16x16x32_bf16 v[76:79], v[108:111], v[112:115], v[76:79]
    buffer_load_dwordx4 a[164:167], v1, s[16:19], s69 offen offset:2048 sc1
    s_waitcnt lgkmcnt(0)
    v_mfma_f32_16x16x32_bf16 v[48:51], v[144:147], v[176:179], v[48:51]
    v_mfma_f32_16x16x32_bf16 v[52:55], v[144:147], v[180:183], v[52:55]
    buffer_load_dwordx4 a[168:171], v1, s[16:19], s70 offen offset:2048 sc1
    v_mfma_f32_16x16x32_bf16 v[56:59], v[144:147], v[184:187], v[56:59]
    v_mfma_f32_16x16x32_bf16 v[60:63], v[144:147], v[188:191], v[60:63]
    buffer_load_dwordx4 a[172:175], v1, s[16:19], s71 offen offset:2048 sc1
    v_mfma_f32_16x16x32_bf16 v[64:67], v[144:147], v[192:195], v[64:67]
    v_mfma_f32_16x16x32_bf16 v[68:71], v[144:147], v[196:199], v[68:71]
    buffer_load_dwordx4 a[176:179], v1, s[16:19], s44 offen offset:3072 sc1
    v_mfma_f32_16x16x32_bf16 v[72:75], v[144:147], v[200:203], v[72:75]
    buffer_load_dwordx4 a[180:183], v1, s[16:19], s69 offen offset:3072 sc1
    v_mfma_f32_16x16x32_bf16 v[76:79], v[144:147], v[204:207], v[76:79]
    v_mfma_f32_16x16x32_bf16 v[52:55], v[148:151], v[176:179], v[52:55]
    buffer_load_dwordx4 a[184:187], v1, s[16:19], s70 offen offset:3072 sc1
    v_mfma_f32_16x16x32_bf16 v[56:59], v[148:151], v[180:183], v[56:59]
    v_mfma_f32_16x16x32_bf16 v[60:63], v[148:151], v[184:187], v[60:63]
    buffer_load_dwordx4 a[188:191], v1, s[16:19], s71 offen offset:3072 sc1
    v_mfma_f32_16x16x32_bf16 v[64:67], v[148:151], v[188:191], v[64:67]
    s_add_u32 s44, s44, 4096
    s_add_u32 s69, s69, 4096
    s_add_u32 s70, s70, 4096
    s_add_u32 s71, s71, 4096
    v_mfma_f32_16x16x32_bf16 v[68:71], v[148:151], v[192:195], v[68:71]
    v_mfma_f32_16x16x32_bf16 v[72:75], v[148:151], v[196:199], v[72:75]
    v_mfma_f32_16x16x32_bf16 v[76:79], v[148:151], v[200:203], v[76:79]
    v_mfma_f32_16x16x32_bf16 v[56:59], v[152:155], v[176:179], v[56:59]
    v_mfma_f32_16x16x32_bf16 v[60:63], v[152:155], v[180:183], v[60:63]
    v_mfma_f32_16x16x32_bf16 v[64:67], v[152:155], v[184:187], v[64:67]
    v_mfma_f32_16x16x32_bf16 v[68:71], v[152:155], v[188:191], v[68:71]
    v_mfma_f32_16x16x32_bf16 v[72:75], v[152:155], v[192:195], v[72:75]
    v_mfma_f32_16x16x32_bf16 v[76:79], v[152:155], v[196:199], v[76:79]
    v_mfma_f32_16x16x32_bf16 v[60:63], v[156:159], v[176:179], v[60:63]
    v_mfma_f32_16x16x32_bf16 v[64:67], v[156:159], v[180:183], v[64:67]
    v_mfma_f32_16x16x32_bf16 v[68:71], v[156:159], v[184:187], v[68:71]
    v_mfma_f32_16x16x32_bf16 v[72:75], v[156:159], v[188:191], v[72:75]
    v_mfma_f32_16x16x32_bf16 v[76:79], v[156:159], v[192:195], v[76:79]
    v_mfma_f32_16x16x32_bf16 v[64:67], v[160:163], v[176:179], v[64:67]
    v_mfma_f32_16x16x32_bf16 v[68:71], v[160:163], v[180:183], v[68:71]
    v_mfma_f32_16x16x32_bf16 v[72:75], v[160:163], v[184:187], v[72:75]
    v_mfma_f32_16x16x32_bf16 v[76:79], v[160:163], v[188:191], v[76:79]
    v_mfma_f32_16x16x32_bf16 v[68:71], v[164:167], v[176:179], v[68:71]
    v_mfma_f32_16x16x32_bf16 v[72:75], v[164:167], v[180:183], v[72:75]
    v_mfma_f32_16x16x32_bf16 v[76:79], v[164:167], v[184:187], v[76:79]
    v_mfma_f32_16x16x32_bf16 v[72:75], v[168:171], v[176:179], v[72:75]
    v_mfma_f32_16x16x32_bf16 v[76:79], v[168:171], v[180:183], v[76:79]
    v_mfma_f32_16x16x32_bf16 v[76:79], v[172:175], v[176:179], v[76:79]
    s_lshl_b32 s66, s50, 12
    s_nop 7
    v_cvt_pk_bf16_f32 v208, v48, v49
    v_cvt_pk_bf16_f32 v209, v50, v51
    buffer_store_dwordx2 v[208:209], v10, s[32:35], s66 offen offset:0 sc1
    v_cvt_pk_bf16_f32 v210, v52, v53
    v_cvt_pk_bf16_f32 v211, v54, v55
    buffer_store_dwordx2 v[210:211], v10, s[32:35], s66 offen offset:512 sc1
    v_cvt_pk_bf16_f32 v212, v56, v57
    v_cvt_pk_bf16_f32 v213, v58, v59
    buffer_store_dwordx2 v[212:213], v10, s[32:35], s66 offen offset:1024 sc1
    v_cvt_pk_bf16_f32 v214, v60, v61
    v_cvt_pk_bf16_f32 v215, v62, v63
    buffer_store_dwordx2 v[214:215], v10, s[32:35], s66 offen offset:1536 sc1
    v_cvt_pk_bf16_f32 v208, v64, v65
    v_cvt_pk_bf16_f32 v209, v66, v67
    buffer_store_dwordx2 v[208:209], v10, s[32:35], s66 offen offset:2048 sc1
    v_cvt_pk_bf16_f32 v210, v68, v69
    v_cvt_pk_bf16_f32 v211, v70, v71
    buffer_store_dwordx2 v[210:211], v10, s[32:35], s66 offen offset:2560 sc1
    v_cvt_pk_bf16_f32 v212, v72, v73
    v_cvt_pk_bf16_f32 v213, v74, v75
    buffer_store_dwordx2 v[212:213], v10, s[32:35], s66 offen offset:3072 sc1
    v_cvt_pk_bf16_f32 v214, v76, v77
    v_cvt_pk_bf16_f32 v215, v78, v79
    buffer_store_dwordx2 v[214:215], v10, s[32:35], s66 offen offset:3584 sc1
    s_branch M_join
M_noconv:
    s_add_u32 m0, s40, 49152
    s_add_u32 s48, s42, 3538944
    buffer_load_dwordx4 v6, s[12:15], s48 offen lds
    s_add_u32 m0, s40, 50176
    s_add_u32 s48, s42, 3686400
    buffer_load_dwordx4 v6, s[12:15], s48 offen lds
    s_add_u32 m0, s40, 57344
    s_add_u32 s48, s42, 4128768
    buffer_load_dwordx4 v6, s[12:15], s48 offen lds
    s_add_u32 m0, s40, 58368
    s_add_u32 s48, s42, 4276224
    buffer_load_dwordx4 v6, s[12:15], s48 offen lds
    buffer_load_dwordx4 a[0:3], v1, s[16:19], s44 offen offset:0 sc1
    buffer_load_dwordx4 a[4:7], v1, s[16:19], s69 offen offset:0 sc1
    buffer_load_dwordx4 a[8:11], v1, s[16:19], s70 offen offset:0 sc1
    buffer_load_dwordx4 a[12:15], v1, s[16:19], s71 offen offset:0 sc1
    buffer_load_dwordx4 a[16:19], v1, s[16:19], s44 offen offset:1024 sc1
    buffer_load_dwordx4 a[20:23], v1, s[16:19], s69 offen offset:1024 sc1
    buffer_load_dwordx4 a[24:27], v1, s[16:19], s70 offen offset:1024 sc1
    buffer_load_dwordx4 a[28:31], v1, s[16:19], s71 offen offset:1024 sc1
    buffer_load_dwordx4 a[32:35], v1, s[16:19], s44 offen offset:2048 sc1
    buffer_load_dwordx4 a[36:39], v1, s[16:19], s69 offen offset:2048 sc1
    buffer_load_dwordx4 a[40:43], v1, s[16:19], s70 offen offset:2048 sc1
    buffer_load_dwordx4 a[44:47], v1, s[16:19], s71 offen offset:2048 sc1
    buffer_load_dwordx4 a[48:51], v1, s[16:19], s44 offen offset:3072 sc1
    buffer_load_dwordx4 a[52:55], v1, s[16:19], s69 offen offset:3072 sc1
    buffer_load_dwordx4 a[56:59], v1, s[16:19], s70 offen offset:3072 sc1
    buffer_load_dwordx4 a[60:63], v1, s[16:19], s71 offen offset:3072 sc1
    s_add_u32 s44, s44, 4096
    s_add_u32 s69, s69, 4096
    s_add_u32 s70, s70, 4096
    s_add_u32 s71, s71, 4096
    buffer_load_dwordx4 a[64:67], v1, s[16:19], s44 offen offset:0 sc1
    buffer_load_dwordx4 a[68:71], v1, s[16:19], s69 offen offset:0 sc1
    buffer_load_dwordx4 a[72:75], v1, s[16:19], s70 offen offset:0 sc1
    buffer_load_dwordx4 a[76:79], v1, s[16:19], s71 offen offset:0 sc1
    buffer_load_dwordx4 a[80:83], v1, s[16:19], s44 offen offset:1024 sc1
    buffer_load_dwordx4 a[84:87], v1, s[16:19], s69 offen offset:1024 sc1
    buffer_load_dwordx4 a[88:91], v1, s[16:19], s70 offen offset:1024 sc1
    buffer_load_dwordx4 a[92:95], v1, s[16:19], s71 offen offset:1024 sc1
    buffer_load_dwordx4 a[96:99], v1, s[16:19], s44 offen offset:2048 sc1
    buffer_load_dwordx4 a[100:103], v1, s[16:19], s69 offen offset:2048 sc1
    buffer_load_dwordx4 a[104:107], v1, s[16:19], s70 offen offset:2048 sc1
    buffer_load_dwordx4 a[108:111], v1, s[16:19], s71 offen offset:2048 sc1
    buffer_load_dwordx4 a[112:115], v1, s[16:19], s44 offen offset:3072 sc1
    buffer_load_dwordx4 a[116:119], v1, s[16:19], s69 offen offset:3072 sc1
    buffer_load_dwordx4 a[120:123], v1, s[16:19], s70 offen offset:3072 sc1
    buffer_load_dwordx4 a[124:127], v1, s[16:19], s71 offen offset:3072 sc1
    s_add_u32 s44, s44, 4096
    s_add_u32 s69, s69, 4096
    s_add_u32 s70, s70, 4096
    s_add_u32 s71, s71, 4096
    buffer_load_dwordx4 a[128:131], v1, s[16:19], s44 offen offset:0 sc1
    buffer_load_dwordx4 a[132:135], v1, s[16:19], s69 offen offset:0 sc1
    buffer_load_dwordx4 a[136:139], v1, s[16:19], s70 offen offset:0 sc1
    buffer_load_dwordx4 a[140:143], v1, s[16:19], s71 offen offset:0 sc1
    buffer_load_dwordx4 a[144:147], v1, s[16:19], s44 offen offset:1024 sc1
    buffer_load_dwordx4 a[148:151], v1, s[16:19], s69 offen offset:1024 sc1
    buffer_load_dwordx4 a[152:155], v1, s[16:19], s70 offen offset:1024 sc1
    buffer_load_dwordx4 a[156:159], v1, s[16:19], s71 offen offset:1024 sc1
    buffer_load_dwordx4 a[160:163], v1, s[16:19], s44 offen offset:2048 sc1
    buffer_load_dwordx4 a[164:167], v1, s[16:19], s69 offen offset:2048 sc1
    buffer_load_dwordx4 a[168:171], v1, s[16:19], s70 offen offset:2048 sc1
    buffer_load_dwordx4 a[172:175], v1, s[16:19], s71 offen offset:2048 sc1
    buffer_load_dwordx4 a[176:179], v1, s[16:19], s44 offen offset:3072 sc1
    buffer_load_dwordx4 a[180:183], v1, s[16:19], s69 offen offset:3072 sc1
    buffer_load_dwordx4 a[184:187], v1, s[16:19], s70 offen offset:3072 sc1
    buffer_load_dwordx4 a[188:191], v1, s[16:19], s71 offen offset:3072 sc1
    s_add_u32 s44, s44, 4096
    s_add_u32 s69, s69, 4096
    s_add_u32 s70, s70, 4096
    s_add_u32 s71, s71, 4096
M_join:
    s_waitcnt vmcnt(60)
    s_barrier
    ds_read_b64_tr_b16 v[176:177], v2 offset:0
    ds_read_b64_tr_b16 v[178:179], v2 offset:256
    ds_read_b64_tr_b16 v[180:181], v2 offset:2048
    ds_read_b64_tr_b16 v[182:183], v2 offset:2304
    ds_read_b64_tr_b16 v[184:185], v3 offset:0
    ds_read_b64_tr_b16 v[186:187], v3 offset:256
    ds_read_b64_tr_b16 v[188:189], v3 offset:2048
    ds_read_b64_tr_b16 v[190:191], v3 offset:2304
    s_waitcnt lgkmcnt(4)
    s_waitcnt vmcnt(40)
    v_mfma_f32_16x16x32_bf16 v[48:51], v[176:179], a[0:3], 0
    ds_read_b64_tr_b16 v[192:193], v2 offset:4096
    buffer_load_dwordx4 a[192:195], v1, s[16:19], s44 offen offset:0 sc1
    v_mfma_f32_16x16x32_bf16 v[52:55], v[176:179], a[4:7], 0
    v_mfma_f32_16x16x32_bf16 v[56:59], v[176:179], a[8:11], 0
    ds_read_b64_tr_b16 v[194:195], v2 offset:4352
    v_mfma_f32_16x16x32_bf16 v[60:63], v[176:179], a[12:15], 0
    v_mfma_f32_16x16x32_bf16 v[64:67], v[180:183], a[0:3], 0
    ds_read_b64_tr_b16 v[196:197], v2 offset:6144
    v_mfma_f32_16x16x32_bf16 v[68:71], v[180:183], a[4:7], 0
    v_mfma_f32_16x16x32_bf16 v[72:75], v[180:183], a[8:11], 0
    ds_read_b64_tr_b16 v[198:199], v2 offset:6400
    v_mfma_f32_16x16x32_bf16 v[76:79], v[180:183], a[12:15], 0
    s_waitcnt lgkmcnt(4)
    v_mfma_f32_16x16x32_bf16 v[80:83], v[184:187], a[0:3], 0
    ds_read_b64_tr_b16 v[176:177], v3 offset:4096
    buffer_load_dwordx4 a[196:199], v1, s[16:19], s69 offen offset:0 sc1
    v_mfma_f32_16x16x32_bf16 v[84:87], v[184:187], a[4:7], 0
    v_mfma_f32_16x16x32_bf16 v[88:91], v[184:187], a[8:11], 0
    ds_read_b64_tr_b16 v[178:179], v3 offset:4352
    v_mfma_f32_16x16x32_bf16 v[92:95], v[184:187], a[12:15], 0
    v_mfma_f32_16x16x32_bf16 v[96:99], v[188:191], a[0:3], 0
    ds_read_b64_tr_b16 v[180:181], v3 offset:6144
    v_mfma_f32_16x16x32_bf16 v[100:103], v[188:191], a[4:7], 0
    v_mfma_f32_16x16x32_bf16 v[104:107], v[188:191], a[8:11], 0
    ds_read_b64_tr_b16 v[182:183], v3 offset:6400
    v_mfma_f32_16x16x32_bf16 v[108:111], v[188:191], a[12:15], 0
    s_waitcnt lgkmcnt(4)
    v_mfma_f32_16x16x32_bf16 v[48:51], v[192:195], a[16:19], v[48:51]
    ds_read_b64_tr_b16 v[184:185], v2 offset:8192
    buffer_load_dwordx4 a[200:203], v1, s[16:19], s70 offen offset:0 sc1
    v_mfma_f32_16x16x32_bf16 v[52:55], v[192:195], a[20:23], v[52:55]
    v_mfma_f32_16x16x32_bf16 v[56:59], v[192:195], a[24:27], v[56:59]
    ds_read_b64_tr_b16 v[186:187], v2 offset:8448
    v_mfma_f32_16x16x32_bf16 v[60:63], v[192:195], a[28:31], v[60:63]
    v_mfma_f32_16x16x32_bf16 v[64:67], v[196:199], a[16:19], v[64:67]
    ds_read_b64_tr_b16 v[188:189], v2 offset:10240
    v_mfma_f32_16x16x32_bf16 v[68:71], v[196:199], a[20:23], v[68:71]
    v_mfma_f32_16x16x32_bf16 v[72:75], v[196:199], a[24:27], v[72:75]
    ds_read_b64_tr_b16 v[190:191], v2 offset:10496
    v_mfma_f32_16x16x32_bf16 v[76:79], v[196:199], a[28:31], v[76:79]
    s_waitcnt lgkmcnt(4)
    v_mfma_f32_16x16x32_bf16 v[80:83], v[176:179], a[16:19], v[80:83]
    ds_read_b64_tr_b16 v[192:193], v3 offset:8192
    buffer_load_dwordx4 a[204:207], v1, s[16:19], s71 offen offset:0 sc1
    v_mfma_f32_16x16x32_bf16 v[84:87], v[176:179], a[20:23], v[84:87]
    v_mfma_f32_16x16x32_bf16 v[88:91], v[176:179], a[24:27], v[88:91]
    ds_read_b64_tr_b16 v[194:195], v3 offset:8448
    v_mfma_f32_16x16x32_bf16 v[92:95], v[176:179], a[28:31], v[92:95]
    v_mfma_f32_16x16x32_bf16 v[96:99], v[180:183], a[16:19], v[96:99]
    ds_read_b64_tr_b16 v[196:197], v3 offset:10240
    v_mfma_f32_16x16x32_bf16 v[100:103], v[180:183], a[20:23], v[100:103]
    v_mfma_f32_16x16x32_bf16 v[104:107], v[180:183], a[24:27], v[104:107]
    ds_read_b64_tr_b16 v[198:199], v3 offset:10496
    v_mfma_f32_16x16x32_bf16 v[108:111], v[180:183], a[28:31], v[108:111]
    s_waitcnt lgkmcnt(4)
    s_waitcnt vmcnt(36)
    v_mfma_f32_16x16x32_bf16 v[48:51], v[184:187], a[32:35], v[48:51]
    ds_read_b64_tr_b16 v[176:177], v2 offset:12288
    buffer_load_dwordx4 a[208:211], v1, s[16:19], s44 offen offset:1024 sc1
    v_mfma_f32_16x16x32_bf16 v[52:55], v[184:187], a[36:39], v[52:55]
    v_mfma_f32_16x16x32_bf16 v[56:59], v[184:187], a[40:43], v[56:59]
    ds_read_b64_tr_b16 v[178:179], v2 offset:12544
    v_mfma_f32_16x16x32_bf16 v[60:63], v[184:187], a[44:47], v[60:63]
    v_mfma_f32_16x16x32_bf16 v[64:67], v[188:191], a[32:35], v[64:67]
    ds_read_b64_tr_b16 v[180:181], v2 offset:14336
    v_mfma_f32_16x16x32_bf16 v[68:71], v[188:191], a[36:39], v[68:71]
    v_mfma_f32_16x16x32_bf16 v[72:75], v[188:191], a[40:43], v[72:75]
    ds_read_b64_tr_b16 v[182:183], v2 offset:14592
    v_mfma_f32_16x16x32_bf16 v[76:79], v[188:191], a[44:47], v[76:79]
    s_waitcnt lgkmcnt(4)
    v_mfma_f32_16x16x32_bf16 v[80:83], v[192:195], a[32:35], v[80:83]
    ds_read_b64_tr_b16 v[184:185], v3 offset:12288
    buffer_load_dwordx4 a[212:215], v1, s[16:19], s69 offen offset:1024 sc1
    v_mfma_f32_16x16x32_bf16 v[84:87], v[192:195], a[36:39], v[84:87]
    v_mfma_f32_16x16x32_bf16 v[88:91], v[192:195], a[40:43], v[88:91]
    ds_read_b64_tr_b16 v[186:187], v3 offset:12544
    v_mfma_f32_16x16x32_bf16 v[92:95], v[192:195], a[44:47], v[92:95]
    v_mfma_f32_16x16x32_bf16 v[96:99], v[196:199], a[32:35], v[96:99]
    ds_read_b64_tr_b16 v[188:189], v3 offset:14336
    v_mfma_f32_16x16x32_bf16 v[100:103], v[196:199], a[36:39], v[100:103]
    v_mfma_f32_16x16x32_bf16 v[104:107], v[196:199], a[40:43], v[104:107]
    ds_read_b64_tr_b16 v[190:191], v3 offset:14592
    v_mfma_f32_16x16x32_bf16 v[108:111], v[196:199], a[44:47], v[108:111]
    s_waitcnt vmcnt(62)
    s_barrier
    s_waitcnt lgkmcnt(4)
    v_mfma_f32_16x16x32_bf16 v[48:51], v[176:179], a[48:51], v[48:51]
    ds_read_b64_tr_b16 v[192:193], v2 offset:16384
    buffer_load_dwordx4 a[216:219], v1, s[16:19], s70 offen offset:1024 sc1
    v_mfma_f32_16x16x32_bf16 v[52:55], v[176:179], a[52:55], v[52:55]
    s_add_u32 m0, s40, 0
    s_add_u32 s48, s42, 4718592
    buffer_load_dwordx4 v6, s[12:15], s48 offen lds
    v_mfma_f32_16x16x32_bf16 v[56:59], v[176:179], a[56:59], v[56:59]
    ds_read_b64_tr_b16 v[194:195], v2 offset:16640
    v_mfma_f32_16x16x32_bf16 v[60:63], v[176:179], a[60:63], v[60:63]
    v_mfma_f32_16x16x32_bf16 v[64:67], v[180:183], a[48:51], v[64:67]
    ds_read_b64_tr_b16 v[196:197], v2 offset:18432
    v_mfma_f32_16x16x32_bf16 v[68:71], v[180:183], a[52:55], v[68:71]
    v_mfma_f32_16x16x32_bf16 v[72:75], v[180:183], a[56:59], v[72:75]
    ds_read_b64_tr_b16 v[198:199], v2 offset:18688
    v_mfma_f32_16x16x32_bf16 v[76:79], v[180:183], a[60:63], v[76:79]
    s_waitcnt lgkmcnt(4)
    v_mfma_f32_16x16x32_bf16 v[80:83], v[184:187], a[48:51], v[80:83]
    ds_read_b64_tr_b16 v[176:177], v3 offset:16384
    buffer_load_dwordx4 a[220:223], v1, s[16:19], s71 offen offset:1024 sc1
    v_mfma_f32_16x16x32_bf16 v[84:87], v[184:187], a[52:55], v[84:87]
    v_mfma_f32_16x16x32_bf16 v[88:91], v[184:187], a[56:59], v[88:91]
    ds_read_b64_tr_b16 v[178:179], v3 offset:16640
    v_mfma_f32_16x16x32_bf16 v[92:95], v[184:187], a[60:63], v[92:95]
    v_mfma_f32_16x16x32_bf16 v[96:99], v[188:191], a[48:51], v[96:99]
    ds_read_b64_tr_b16 v[180:181], v3 offset:18432
    v_mfma_f32_16x16x32_bf16 v[100:103], v[188:191], a[52:55], v[100:103]
    v_mfma_f32_16x16x32_bf16 v[104:107], v[188:191], a[56:59], v[104:107]
    ds_read_b64_tr_b16 v[182:183], v3 offset:18688
    v_mfma_f32_16x16x32_bf16 v[108:111], v[188:191], a[60:63], v[108:111]
    s_waitcnt lgkmcnt(4)
    s_waitcnt vmcnt(33)
    v_mfma_f32_16x16x32_bf16 v[48:51], v[192:195], a[64:67], v[48:51]
    ds_read_b64_tr_b16 v[184:185], v2 offset:20480
    buffer_load_dwordx4 a[224:227], v1, s[16:19], s44 offen offset:2048 sc1
    v_mfma_f32_16x16x32_bf16 v[52:55], v[192:195], a[68:71], v[52:55]
    s_add_u32 m0, s40, 1024
    s_add_u32 s48, s42, 4866048
    buffer_load_dwordx4 v6, s[12:15], s48 offen lds
    v_mfma_f32_16x16x32_bf16 v[56:59], v[192:195], a[72:75], v[56:59]
    ds_read_b64_tr_b16 v[186:187], v2 offset:20736
    v_mfma_f32_16x16x32_bf16 v[60:63], v[192:195], a[76:79], v[60:63]
    v_mfma_f32_16x16x32_bf16 v[64:67], v[196:199], a[64:67], v[64:67]
    ds_read_b64_tr_b16 v[188:189], v2 offset:22528
    v_mfma_f32_16x16x32_bf16 v[68:71], v[196:199], a[68:71], v[68:71]
    buffer_load_dwordx4 a[228:231], v1, s[16:19], s69 offen offset:2048 sc1
    v_mfma_f32_16x16x32_bf16 v[72:75], v[196:199], a[72:75], v[72:75]
    ds_read_b64_tr_b16 v[190:191], v2 offset:22784
    v_mfma_f32_16x16x32_bf16 v[76:79], v[196:199], a[76:79], v[76:79]
    s_waitcnt lgkmcnt(4)
    v_mfma_f32_16x16x32_bf16 v[80:83], v[176:179], a[64:67], v[80:83]
    ds_read_b64_tr_b16 v[192:193], v3 offset:20480
    v_mfma_f32_16x16x32_bf16 v[84:87], v[176:179], a[68:71], v[84:87]
    v_mfma_f32_16x16x32_bf16 v[88:91], v[176:179], a[72:75], v[88:91]
    ds_read_b64_tr_b16 v[194:195], v3 offset:20736
    buffer_load_dwordx4 a[232:235], v1, s[16:19], s70 offen offset:2048 sc1
    v_mfma_f32_16x16x32_bf16 v[92:95], v[176:179], a[76:79], v[92:95]
    v_mfma_f32_16x16x32_bf16 v[96:99], v[180:183], a[64:67], v[96:99]
    ds_read_b64_tr_b16 v[196:197], v3 offset:22528
    v_mfma_f32_16x16x32_bf16 v[100:103], v[180:183], a[68:71], v[100:103]
    v_mfma_f32_16x16x32_bf16 v[104:107], v[180:183], a[72:75], v[104:107]
    ds_read_b64_tr_b16 v[198:199], v3 offset:22784
    v_mfma_f32_16x16x32_bf16 v[108:111], v[180:183], a[76:79], v[108:111]
    s_waitcnt lgkmcnt(4)
    v_mfma_f32_16x16x32_bf16 v[48:51], v[184:187], a[80:83], v[48:51]
    ds_read_b64_tr_b16 v[176:177], v2 offset:24576
    buffer_load_dwordx4 a[236:239], v1, s[16:19], s71 offen offset:2048 sc1
    v_mfma_f32_16x16x32_bf16 v[52:55], v[184:187], a[84:87], v[52:55]
    v_mfma_f32_16x16x32_bf16 v[56:59], v[184:187], a[88:91], v[56:59]
    ds_read_b64_tr_b16 v[178:179], v2 offset:24832
    v_mfma_f32_16x16x32_bf16 v[60:63], v[184:187], a[92:95], v[60:63]
    v_mfma_f32_16x16x32_bf16 v[64:67], v[188:191], a[80:83], v[64:67]
    ds_read_b64_tr_b16 v[180:181], v2 offset:26624
    v_mfma_f32_16x16x32_bf16 v[68:71], v[188:191], a[84:87], v[68:71]
    buffer_load_dwordx4 a[240:243], v1, s[16:19], s44 offen offset:3072 sc1
    v_mfma_f32_16x16x32_bf16 v[72:75], v[188:191], a[88:91], v[72:75]
    ds_read_b64_tr_b16 v[182:183], v2 offset:26880
    v_mfma_f32_16x16x32_bf16 v[76:79], v[188:191], a[92:95], v[76:79]
    s_waitcnt lgkmcnt(4)
    v_mfma_f32_16x16x32_bf16 v[80:83], v[192:195], a[80:83], v[80:83]
    ds_read_b64_tr_b16 v[184:185], v3 offset:24576
    v_mfma_f32_16x16x32_bf16 v[84:87], v[192:195], a[84:87], v[84:87]
    v_mfma_f32_16x16x32_bf16 v[88:91], v[192:195], a[88:91], v[88:91]
    ds_read_b64_tr_b16 v[186:187], v3 offset:24832
    buffer_load_dwordx4 a[244:247], v1, s[16:19], s69 offen offset:3072 sc1
    v_mfma_f32_16x16x32_bf16 v[92:95], v[192:195], a[92:95], v[92:95]
    v_mfma_f32_16x16x32_bf16 v[96:99], v[196:199], a[80:83], v[96:99]
    ds_read_b64_tr_b16 v[188:189], v3 offset:26624
    v_mfma_f32_16x16x32_bf16 v[100:103], v[196:199], a[84:87], v[100:103]
    v_mfma_f32_16x16x32_bf16 v[104:107], v[196:199], a[88:91], v[104:107]
    ds_read_b64_tr_b16 v[190:191], v3 offset:26880
    v_mfma_f32_16x16x32_bf16 v[108:111], v[196:199], a[92:95], v[108:111]
    s_waitcnt lgkmcnt(4)
    s_waitcnt vmcnt(32)
    v_mfma_f32_16x16x32_bf16 v[48:51], v[176:179], a[96:99], v[48:51]
    ds_read_b64_tr_b16 v[192:193], v2 offset:28672
    buffer_load_dwordx4 a[248:251], v1, s[16:19], s70 offen offset:3072 sc1
    v_mfma_f32_16x16x32_bf16 v[52:55], v[176:179], a[100:103], v[52:55]
    v_mfma_f32_16x16x32_bf16 v[56:59], v[176:179], a[104:107], v[56:59]
    ds_read_b64_tr_b16 v[194:195], v2 offset:28928
    v_mfma_f32_16x16x32_bf16 v[60:63], v[176:179], a[108:111], v[60:63]
    v_mfma_f32_16x16x32_bf16 v[64:67], v[180:183], a[96:99], v[64:67]
    ds_read_b64_tr_b16 v[196:197], v2 offset:30720
    v_mfma_f32_16x16x32_bf16 v[68:71], v[180:183], a[100:103], v[68:71]
    buffer_load_dwordx4 a[252:255], v1, s[16:19], s71 offen offset:3072 sc1
    v_mfma_f32_16x16x32_bf16 v[72:75], v[180:183], a[104:107], v[72:75]
    ds_read_b64_tr_b16 v[198:199], v2 offset:30976
    v_mfma_f32_16x16x32_bf16 v[76:79], v[180:183], a[108:111], v[76:79]
    s_waitcnt lgkmcnt(4)
    v_mfma_f32_16x16x32_bf16 v[80:83], v[184:187], a[96:99], v[80:83]
    ds_read_b64_tr_b16 v[176:177], v3 offset:28672
    v_mfma_f32_16x16x32_bf16 v[84:87], v[184:187], a[100:103], v[84:87]
    v_mfma_f32_16x16x32_bf16 v[88:91], v[184:187], a[104:107], v[88:91]
    ds_read_b64_tr_b16 v[178:179], v3 offset:28928
    v_mfma_f32_16x16x32_bf16 v[92:95], v[184:187], a[108:111], v[92:95]
    s_add_u32 s44, s44, 4096
    s_add_u32 s69, s69, 4096
    s_add_u32 s70, s70, 4096
    s_add_u32 s71, s71, 4096
    v_mfma_f32_16x16x32_bf16 v[96:99], v[188:191], a[96:99], v[96:99]
    ds_read_b64_tr_b16 v[180:181], v3 offset:30720
    v_mfma_f32_16x16x32_bf16 v[100:103], v[188:191], a[100:103], v[100:103]
    v_mfma_f32_16x16x32_bf16 v[104:107], v[188:191], a[104:107], v[104:107]
    ds_read_b64_tr_b16 v[182:183], v3 offset:30976
    v_mfma_f32_16x16x32_bf16 v[108:111], v[188:191], a[108:111], v[108:111]
    s_waitcnt vmcnt(63)
    s_barrier
    s_waitcnt lgkmcnt(4)
    v_mfma_f32_16x16x32_bf16 v[48:51], v[192:195], a[112:115], v[48:51]
    ds_read_b64_tr_b16 v[184:185], v2 offset:32768
    v_mfma_f32_16x16x32_bf16 v[52:55], v[192:195], a[116:119], v[52:55]
    s_add_u32 m0, s40, 8192
    s_add_u32 s48, s42, 64
    buffer_load_dwordx4 v6, s[12:15], s48 offen lds
    v_mfma_f32_16x16x32_bf16 v[56:59], v[192:195], a[120:123], v[56:59]
    ds_read_b64_tr_b16 v[186:187], v2 offset:33024
    v_mfma_f32_16x16x32_bf16 v[60:63], v[192:195], a[124:127], v[60:63]
    v_mfma_f32_16x16x32_bf16 v[64:67], v[196:199], a[112:115], v[64:67]
    ds_read_b64_tr_b16 v[188:189], v2 offset:34816
    v_mfma_f32_16x16x32_bf16 v[68:71], v[196:199], a[116:119], v[68:71]
    v_mfma_f32_16x16x32_bf16 v[72:75], v[196:199], a[120:123], v[72:75]
    ds_read_b64_tr_b16 v[190:191], v2 offset:35072
    v_mfma_f32_16x16x32_bf16 v[76:79], v[196:199], a[124:127], v[76:79]
    s_waitcnt lgkmcnt(4)
    v_mfma_f32_16x16x32_bf16 v[80:83], v[176:179], a[112:115], v[80:83]
    ds_read_b64_tr_b16 v[192:193], v3 offset:32768
    v_mfma_f32_16x16x32_bf16 v[84:87], v[176:179], a[116:119], v[84:87]
    v_mfma_f32_16x16x32_bf16 v[88:91], v[176:179], a[120:123], v[88:91]
    ds_read_b64_tr_b16 v[194:195], v3 offset:33024
    v_mfma_f32_16x16x32_bf16 v[92:95], v[176:179], a[124:127], v[92:95]
    v_mfma_f32_16x16x32_bf16 v[96:99], v[180:183], a[112:115], v[96:99]
    ds_read_b64_tr_b16 v[196:197], v3 offset:34816
    v_mfma_f32_16x16x32_bf16 v[100:103], v[180:183], a[116:119], v[100:103]
    v_mfma_f32_16x16x32_bf16 v[104:107], v[180:183], a[120:123], v[104:107]
    ds_read_b64_tr_b16 v[198:199], v3 offset:35072
    v_mfma_f32_16x16x32_bf16 v[108:111], v[180:183], a[124:127], v[108:111]
    s_waitcnt lgkmcnt(4)
    s_waitcnt vmcnt(27)
    v_mfma_f32_16x16x32_bf16 v[48:51], v[184:187], a[128:131], v[48:51]
    ds_read_b64_tr_b16 v[176:177], v2 offset:36864
    buffer_load_dwordx4 v[16:19], v1, s[16:19], s44 offen offset:0 sc1
    v_mfma_f32_16x16x32_bf16 v[52:55], v[184:187], a[132:135], v[52:55]
    s_add_u32 m0, s40, 9216
    s_add_u32 s48, s42, 147520
    buffer_load_dwordx4 v6, s[12:15], s48 offen lds
    v_mfma_f32_16x16x32_bf16 v[56:59], v[184:187], a[136:139], v[56:59]
    ds_read_b64_tr_b16 v[178:179], v2 offset:37120
    v_mfma_f32_16x16x32_bf16 v[60:63], v[184:187], a[140:143], v[60:63]
    v_mfma_f32_16x16x32_bf16 v[64:67], v[188:191], a[128:131], v[64:67]
    ds_read_b64_tr_b16 v[180:181], v2 offset:38912
    v_mfma_f32_16x16x32_bf16 v[68:71], v[188:191], a[132:135], v[68:71]
    v_mfma_f32_16x16x32_bf16 v[72:75], v[188:191], a[136:139], v[72:75]
    ds_read_b64_tr_b16 v[182:183], v2 offset:39168
    v_mfma_f32_16x16x32_bf16 v[76:79], v[188:191], a[140:143], v[76:79]
    s_waitcnt lgkmcnt(4)
    v_mfma_f32_16x16x32_bf16 v[80:83], v[192:195], a[128:131], v[80:83]
    ds_read_b64_tr_b16 v[184:185], v3 offset:36864
    buffer_load_dwordx4 v[20:23], v1, s[16:19], s69 offen offset:0 sc1
    v_mfma_f32_16x16x32_bf16 v[84:87], v[192:195], a[132:135], v[84:87]
    v_mfma_f32_16x16x32_bf16 v[88:91], v[192:195], a[136:139], v[88:91]
    ds_read_b64_tr_b16 v[186:187], v3 offset:37120
    v_mfma_f32_16x16x32_bf16 v[92:95], v[192:195], a[140:143], v[92:95]
    v_mfma_f32_16x16x32_bf16 v[96:99], v[196:199], a[128:131], v[96:99]
    ds_read_b64_tr_b16 v[188:189], v3 offset:38912
    v_mfma_f32_16x16x32_bf16 v[100:103], v[196:199], a[132:135], v[100:103]
    s_add_u32 m0, s40, 16384
    s_add_u32 s48, s42, 589888
    buffer_load_dwordx4 v6, s[12:15], s48 offen lds
    v_mfma_f32_16x16x32_bf16 v[104:107], v[196:199], a[136:139], v[104:107]
    ds_read_b64_tr_b16 v[190:191], v3 offset:39168
    v_mfma_f32_16x16x32_bf16 v[108:111], v[196:199], a[140:143], v[108:111]
    s_waitcnt lgkmcnt(4)
    v_mfma_f32_16x16x32_bf16 v[48:51], v[176:179], a[144:147], v[48:51]
    ds_read_b64_tr_b16 v[192:193], v2 offset:40960
    buffer_load_dwordx4 v[24:27], v1, s[16:19], s70 offen offset:0 sc1
    v_mfma_f32_16x16x32_bf16 v[52:55], v[176:179], a[148:151], v[52:55]
    v_mfma_f32_16x16x32_bf16 v[56:59], v[176:179], a[152:155], v[56:59]
    ds_read_b64_tr_b16 v[194:195], v2 offset:41216
    v_mfma_f32_16x16x32_bf16 v[60:63], v[176:179], a[156:159], v[60:63]
    v_mfma_f32_16x16x32_bf16 v[64:67], v[180:183], a[144:147], v[64:67]
    ds_read_b64_tr_b16 v[196:197], v2 offset:43008
    v_mfma_f32_16x16x32_bf16 v[68:71], v[180:183], a[148:151], v[68:71]
    v_mfma_f32_16x16x32_bf16 v[72:75], v[180:183], a[152:155], v[72:75]
    ds_read_b64_tr_b16 v[198:199], v2 offset:43264
    s_mov_b32 s65, 14913081
    v_mfma_f32_16x16x32_bf16 v[76:79], v[180:183], a[156:159], v[76:79]
    v_add_u32 v11, 0, v1
    s_waitcnt lgkmcnt(4)
    v_mfma_f32_16x16x32_bf16 v[80:83], v[184:187], a[144:147], v[80:83]
    ds_read_b64_tr_b16 v[176:177], v3 offset:40960
    buffer_load_dwordx4 v[28:31], v1, s[16:19], s71 offen offset:0 sc1
    v_mfma_f32_16x16x32_bf16 v[84:87], v[184:187], a[148:151], v[84:87]
    v_mul_hi_u32 v216, v11, s65
    v_mfma_f32_16x16x32_bf16 v[88:91], v[184:187], a[152:155], v[88:91]
    ds_read_b64_tr_b16 v[178:179], v3 offset:41216
    v_mfma_f32_16x16x32_bf16 v[92:95], v[184:187], a[156:159], v[92:95]
    s_add_u32 m0, s40, 17408
    s_add_u32 s48, s42, 737344
    buffer_load_dwordx4 v6, s[12:15], s48 offen lds
    v_mfma_f32_16x16x32_bf16 v[96:99], v[188:191], a[144:147], v[96:99]
    ds_read_b64_tr_b16 v[180:181], v3 offset:43008
    v_mul_u32_u24 v216, 864, v216
    v_mfma_f32_16x16x32_bf16 v[100:103], v[188:191], a[148:151], v[100:103]
    v_add_u32 v216, v216, v11
    v_mfma_f32_16x16x32_bf16 v[104:107], v[188:191], a[152:155], v[104:107]
    ds_read_b64_tr_b16 v[182:183], v3 offset:43264
    v_mfma_f32_16x16x32_bf16 v[108:111], v[188:191], a[156:159], v[108:111]
    s_waitcnt lgkmcnt(4)
    s_waitcnt vmcnt(26)
    v_mfma_f32_16x16x32_bf16 v[48:51], v[192:195], a[160:163], v[48:51]
    ds_read_b64_tr_b16 v[184:185], v2 offset:45056
    v_add_u32 v11, 1024, v1
    v_mfma_f32_16x16x32_bf16 v[52:55], v[192:195], a[164:167], v[52:55]
    v_mul_hi_u32 v217, v11, s65
    buffer_load_dwordx4 v[32:35], v1, s[16:19], s44 offen offset:1024 sc1
    v_mfma_f32_16x16x32_bf16 v[56:59], v[192:195], a[168:171], v[56:59]
    ds_read_b64_tr_b16 v[186:187], v2 offset:45312
    v_mfma_f32_16x16x32_bf16 v[60:63], v[192:195], a[172:175], v[60:63]
    v_mul_u32_u24 v217, 864, v217
    v_mfma_f32_16x16x32_bf16 v[64:67], v[196:199], a[160:163], v[64:67]
    ds_read_b64_tr_b16 v[188:189], v2 offset:47104
    v_mfma_f32_16x16x32_bf16 v[68:71], v[196:199], a[164:167], v[68:71]
    v_add_u32 v217, v217, v11
    v_mfma_f32_16x16x32_bf16 v[72:75], v[196:199], a[168:171], v[72:75]
    ds_read_b64_tr_b16 v[190:191], v2 offset:47360
    v_mfma_f32_16x16x32_bf16 v[76:79], v[196:199], a[172:175], v[76:79]
    v_add_u32 v11, 2048, v1
    s_waitcnt lgkmcnt(4)
    v_mfma_f32_16x16x32_bf16 v[80:83], v[176:179], a[160:163], v[80:83]
    ds_read_b64_tr_b16 v[192:193], v3 offset:45056
    buffer_load_dwordx4 v[36:39], v1, s[16:19], s69 offen offset:1024 sc1
    v_mfma_f32_16x16x32_bf16 v[84:87], v[176:179], a[164:167], v[84:87]
    v_mul_hi_u32 v218, v11, s65
    v_mfma_f32_16x16x32_bf16 v[88:91], v[176:179], a[168:171], v[88:91]
    ds_read_b64_tr_b16 v[194:195], v3 offset:45312
    v_mfma_f32_16x16x32_bf16 v[92:95], v[176:179], a[172:175], v[92:95]
    v_mul_u32_u24 v218, 864, v218
    v_mfma_f32_16x16x32_bf16 v[96:99], v[180:183], a[160:163], v[96:99]
    ds_read_b64_tr_b16 v[196:197], v3 offset:47104
    v_mfma_f32_16x16x32_bf16 v[100:103], v[180:183], a[164:167], v[100:103]
    v_add_u32 v218, v218, v11
    v_mfma_f32_16x16x32_bf16 v[104:107], v[180:183], a[168:171], v[104:107]
    ds_read_b64_tr_b16 v[198:199], v3 offset:47360
    v_mfma_f32_16x16x32_bf16 v[108:111], v[180:183], a[172:175], v[108:111]
    s_waitcnt vmcnt(63)
    s_barrier
    s_waitcnt lgkmcnt(4)
    v_mfma_f32_16x16x32_bf16 v[48:51], v[184:187], a[176:179], v[48:51]
    ds_read_b64_tr_b16 v[176:177], v2 offset:49152
    v_add_u32 v11, 3072, v1
    v_mfma_f32_16x16x32_bf16 v[52:55], v[184:187], a[180:183], v[52:55]
    s_add_u32 m0, s40, 24576
    s_add_u32 s48, s42, 1179712
    buffer_load_dwordx4 v6, s[12:15], s48 offen lds
    v_mfma_f32_16x16x32_bf16 v[56:59], v[184:187], a[184:187], v[56:59]
    ds_read_b64_tr_b16 v[178:179], v2 offset:49408
    v_mul_hi_u32 v219, v11, s65
    v_mfma_f32_16x16x32_bf16 v[60:63], v[184:187], a[188:191], v[60:63]
    v_mul_u32_u24 v219, 864, v219
    buffer_load_dwordx4 v[40:43], v1, s[16:19], s70 offen offset:1024 sc1
    v_mfma_f32_16x16x32_bf16 v[64:67], v[188:191], a[176:179], v[64:67]
    ds_read_b64_tr_b16 v[180:181], v2 offset:51200
    v_mfma_f32_16x16x32_bf16 v[68:71], v[188:191], a[180:183], v[68:71]
    v_add_u32 v219, v219, v11
    v_mfma_f32_16x16x32_bf16 v[72:75], v[188:191], a[184:187], v[72:75]
    ds_read_b64_tr_b16 v[182:183], v2 offset:51456
    v_mfma_f32_16x16x32_bf16 v[76:79], v[188:191], a[188:191], v[76:79]
    v_add_u32 v11, 4096, v1
    s_waitcnt lgkmcnt(4)
    v_mfma_f32_16x16x32_bf16 v[80:83], v[192:195], a[176:179], v[80:83]
    ds_read_b64_tr_b16 v[184:185], v3 offset:49152
    buffer_load_dwordx4 v[44:47], v1, s[16:19], s71 offen offset:1024 sc1
    v_mfma_f32_16x16x32_bf16 v[84:87], v[192:195], a[180:183], v[84:87]
    v_mul_hi_u32 v220, v11, s65
    v_mfma_f32_16x16x32_bf16 v[88:91], v[192:195], a[184:187], v[88:91]
    ds_read_b64_tr_b16 v[186:187], v3 offset:49408
    v_mfma_f32_16x16x32_bf16 v[92:95], v[192:195], a[188:191], v[92:95]
    v_mul_u32_u24 v220, 864, v220
    v_mfma_f32_16x16x32_bf16 v[96:99], v[196:199], a[176:179], v[96:99]
    ds_read_b64_tr_b16 v[188:189], v3 offset:51200
    v_mfma_f32_16x16x32_bf16 v[100:103], v[196:199], a[180:183], v[100:103]
    v_add_u32 v220, v220, v11
    v_mfma_f32_16x16x32_bf16 v[104:107], v[196:199], a[184:187], v[104:107]
    ds_read_b64_tr_b16 v[190:191], v3 offset:51456
    v_mfma_f32_16x16x32_bf16 v[108:111], v[196:199], a[188:191], v[108:111]
    s_waitcnt lgkmcnt(4)
    s_waitcnt vmcnt(22)
    v_mfma_f32_16x16x32_bf16 v[48:51], v[176:179], a[192:195], v[48:51]
    ds_read_b64_tr_b16 v[192:193], v2 offset:53248
    v_add_u32 v11, 5120, v1
    v_mfma_f32_16x16x32_bf16 v[52:55], v[176:179], a[196:199], v[52:55]
    s_add_u32 m0, s40, 25600
    s_add_u32 s48, s42, 1327168
    buffer_load_dwordx4 v6, s[12:15], s48 offen lds
    v_mfma_f32_16x16x32_bf16 v[56:59], v[176:179], a[200:203], v[56:59]
    ds_read_b64_tr_b16 v[194:195], v2 offset:53504
    v_mul_hi_u32 v221, v11, s65
    v_mfma_f32_16x16x32_bf16 v[60:63], v[176:179], a[204:207], v[60:63]
    v_mul_u32_u24 v221, 864, v221
    v_mfma_f32_16x16x32_bf16 v[64:67], v[180:183], a[192:195], v[64:67]
    ds_read_b64_tr_b16 v[196:197], v2 offset:55296
    v_mfma_f32_16x16x32_bf16 v[68:71], v[180:183], a[196:199], v[68:71]
    v_add_u32 v221, v221, v11
    v_mfma_f32_16x16x32_bf16 v[72:75], v[180:183], a[200:203], v[72:75]
    ds_read_b64_tr_b16 v[198:199], v2 offset:55552
    v_mfma_f32_16x16x32_bf16 v[76:79], v[180:183], a[204:207], v[76:79]
    v_add_u32 v11, 6144, v1
    s_waitcnt lgkmcnt(4)
    v_mfma_f32_16x16x32_bf16 v[80:83], v[184:187], a[192:195], v[80:83]
    ds_read_b64_tr_b16 v[176:177], v3 offset:53248
    v_mfma_f32_16x16x32_bf16 v[84:87], v[184:187], a[196:199], v[84:87]
    v_mul_hi_u32 v222, v11, s65
    v_mfma_f32_16x16x32_bf16 v[88:91], v[184:187], a[200:203], v[88:91]
    ds_read_b64_tr_b16 v[178:179], v3 offset:53504
    v_mfma_f32_16x16x32_bf16 v[92:95], v[184:187], a[204:207], v[92:95]
    v_mul_u32_u24 v222, 864, v222
    v_mfma_f32_16x16x32_bf16 v[96:99], v[188:191], a[192:195], v[96:99]
    ds_read_b64_tr_b16 v[180:181], v3 offset:55296
    v_mfma_f32_16x16x32_bf16 v[100:103], v[188:191], a[196:199], v[100:103]
    s_add_u32 m0, s40, 32768
    s_add_u32 s48, s42, 1769536
    buffer_load_dwordx4 v6, s[12:15], s48 offen lds
    v_mfma_f32_16x16x32_bf16 v[104:107], v[188:191], a[200:203], v[104:107]
    ds_read_b64_tr_b16 v[182:183], v3 offset:55552
    v_add_u32 v222, v222, v11
    v_mfma_f32_16x16x32_bf16 v[108:111], v[188:191], a[204:207], v[108:111]
    v_add_u32 v11, 7168, v1
    s_waitcnt lgkmcnt(4)
    v_mfma_f32_16x16x32_bf16 v[48:51], v[192:195], a[208:211], v[48:51]
    ds_read_b64_tr_b16 v[184:185], v2 offset:57344
    v_mfma_f32_16x16x32_bf16 v[52:55], v[192:195], a[212:215], v[52:55]
    v_mul_hi_u32 v223, v11, s65
    v_mfma_f32_16x16x32_bf16 v[56:59], v[192:195], a[216:219], v[56:59]
    ds_read_b64_tr_b16 v[186:187], v2 offset:57600
    v_mfma_f32_16x16x32_bf16 v[60:63], v[192:195], a[220:223], v[60:63]
    v_mul_u32_u24 v223, 864, v223
    v_mfma_f32_16x16x32_bf16 v[64:67], v[196:199], a[208:211], v[64:67]
    ds_read_b64_tr_b16 v[188:189], v2 offset:59392
    v_mfma_f32_16x16x32_bf16 v[68:71], v[196:199], a[212:215], v[68:71]
    v_add_u32 v223, v223, v11
    v_mfma_f32_16x16x32_bf16 v[72:75], v[196:199], a[216:219], v[72:75]
    ds_read_b64_tr_b16 v[190:191], v2 offset:59648
    v_mfma_f32_16x16x32_bf16 v[76:79], v[196:199], a[220:223], v[76:79]
    v_add_u32 v11, 8192, v1
    s_waitcnt lgkmcnt(4)
    v_mfma_f32_16x16x32_bf16 v[80:83], v[176:179], a[208:211], v[80:83]
    ds_read_b64_tr_b16 v[192:193], v3 offset:57344
    v_mul_hi_u32 v224, v11, s65
    v_mfma_f32_16x16x32_bf16 v[84:87], v[176:179], a[212:215], v[84:87]
    v_mfma_f32_16x16x32_bf16 v[88:91], v[176:179], a[216:219], v[88:91]
    ds_read_b64_tr_b16 v[194:195], v3 offset:57600
    v_mul_u32_u24 v224, 864, v224
    v_mfma_f32_16x16x32_bf16 v[92:95], v[176:179], a[220:223], v[92:95]
    s_add_u32 m0, s40, 33792
    s_add_u32 s48, s42, 1916992
    buffer_load_dwordx4 v6, s[12:15], s48 offen lds
    v_mfma_f32_16x16x32_bf16 v[96:99], v[180:183], a[208:211], v[96:99]
    ds_read_b64_tr_b16 v[196:197], v3 offset:59392
    v_add_u32 v224, v224, v11
    v_mfma_f32_16x16x32_bf16 v[100:103], v[180:183], a[212:215], v[100:103]
    v_mfma_f32_16x16x32_bf16 v[104:107], v[180:183], a[216:219], v[104:107]
    ds_read_b64_tr_b16 v[198:199], v3 offset:59648
    v_lshrrev_b32 v11, 4, v0
    v_mfma_f32_16x16x32_bf16 v[108:111], v[180:183], a[220:223], v[108:111]
    s_waitcnt lgkmcnt(4)
    s_waitcnt vmcnt(16)
    v_mfma_f32_16x16x32_bf16 v[48:51], v[184:187], a[224:227], v[48:51]
    ds_read_b64_tr_b16 v[176:177], v2 offset:61440
    v_bfe_u32 v12, v0, 2, 2
    v_mfma_f32_16x16x32_bf16 v[52:55], v[184:187], a[228:231], v[52:55]
    v_mfma_f32_16x16x32_bf16 v[56:59], v[184:187], a[232:235], v[56:59]
    ds_read_b64_tr_b16 v[178:179], v2 offset:61696
    v_lshl_add_u32 v11, v11, 2, v12
    v_mfma_f32_16x16x32_bf16 v[60:63], v[184:187], a[236:239], v[60:63]
    v_mfma_f32_16x16x32_bf16 v[64:67], v[188:191], a[224:227], v[64:67]
    ds_read_b64_tr_b16 v[180:181], v2 offset:63488
    v_mul_u32_u24 v11, 288, v11
    v_mfma_f32_16x16x32_bf16 v[68:71], v[188:191], a[228:231], v[68:71]
    v_mfma_f32_16x16x32_bf16 v[72:75], v[188:191], a[232:235], v[72:75]
    ds_read_b64_tr_b16 v[182:183], v2 offset:63744
    v_and_b32 v12, 3, v0
    v_mfma_f32_16x16x32_bf16 v[76:79], v[188:191], a[236:239], v[76:79]
    s_waitcnt lgkmcnt(4)
    v_mfma_f32_16x16x32_bf16 v[80:83], v[192:195], a[224:227], v[80:83]
    ds_read_b64_tr_b16 v[184:185], v3 offset:61440
    v_lshl_add_u32 v225, v12, 3, v11
    v_mfma_f32_16x16x32_bf16 v[84:87], v[192:195], a[228:231], v[84:87]
    v_mfma_f32_16x16x32_bf16 v[88:91], v[192:195], a[232:235], v[88:91]
    ds_read_b64_tr_b16 v[186:187], v3 offset:61696
    v_add_u32 v226, 61440, v225
    v_mfma_f32_16x16x32_bf16 v[92:95], v[192:195], a[236:239], v[92:95]
    v_mfma_f32_16x16x32_bf16 v[96:99], v[196:199], a[224:227], v[96:99]
    ds_read_b64_tr_b16 v[188:189], v3 offset:63488
    v_add_u32 v227, 122880, v225
    v_mfma_f32_16x16x32_bf16 v[100:103], v[196:199], a[228:231], v[100:103]
    v_mfma_f32_16x16x32_bf16 v[104:107], v[196:199], a[232:235], v[104:107]
    ds_read_b64_tr_b16 v[190:191], v3 offset:63744
    s_mul_i32 s65, s3, 9216
    v_mfma_f32_16x16x32_bf16 v[108:111], v[196:199], a[236:239], v[108:111]
    s_waitcnt vmcnt(13)
    s_barrier
    s_waitcnt lgkmcnt(4)
    v_mfma_f32_16x16x32_bf16 v[48:51], v[176:179], a[240:243], v[48:51]
    ds_read_b64_tr_b16 v[192:193], v2 offset:0
    s_add_u32 s54, s65, 65536
    v_mfma_f32_16x16x32_bf16 v[52:55], v[176:179], a[244:247], v[52:55]
    s_add_u32 m0, s40, 40960
    s_add_u32 s48, s42, 2359360
    buffer_load_dwordx4 v6, s[12:15], s48 offen lds
    v_mfma_f32_16x16x32_bf16 v[56:59], v[176:179], a[248:251], v[56:59]
    ds_read_b64_tr_b16 v[194:195], v2 offset:256
    s_add_u32 s55, s65, 102400
    v_mfma_f32_16x16x32_bf16 v[60:63], v[176:179], a[252:255], v[60:63]
    v_mfma_f32_16x16x32_bf16 v[64:67], v[180:183], a[240:243], v[64:67]
    ds_read_b64_tr_b16 v[196:197], v2 offset:2048
    s_add_u32 s57, s65, 18432
    v_mfma_f32_16x16x32_bf16 v[68:71], v[180:183], a[244:247], v[68:71]
    v_mfma_f32_16x16x32_bf16 v[72:75], v[180:183], a[248:251], v[72:75]
    ds_read_b64_tr_b16 v[198:199], v2 offset:2304
    s_add_u32 s66, s65, 139264
    v_mfma_f32_16x16x32_bf16 v[76:79], v[180:183], a[252:255], v[76:79]
    s_waitcnt lgkmcnt(4)
    v_mfma_f32_16x16x32_bf16 v[80:83], v[184:187], a[240:243], v[80:83]
    ds_read_b64_tr_b16 v[176:177], v3 offset:0
    s_sub_u32 s67, s65, 18432
    v_mfma_f32_16x16x32_bf16 v[84:87], v[184:187], a[244:247], v[84:87]
    v_mfma_f32_16x16x32_bf16 v[88:91], v[184:187], a[248:251], v[88:91]
    ds_read_b64_tr_b16 v[178:179], v3 offset:256
    v_mfma_f32_16x16x32_bf16 v[92:95], v[184:187], a[252:255], v[92:95]
    s_cmp_lt_u32 s3, 2
    s_cselect_b32 s56, s66, s67
    v_mfma_f32_16x16x32_bf16 v[96:99], v[188:191], a[240:243], v[96:99]
    ds_read_b64_tr_b16 v[180:181], v3 offset:2048
    v_mfma_f32_16x16x32_bf16 v[100:103], v[188:191], a[244:247], v[100:103]
    s_add_u32 m0, s40, 41984
    s_add_u32 s48, s42, 2506816
    buffer_load_dwordx4 v6, s[12:15], s48 offen lds
    v_mfma_f32_16x16x32_bf16 v[104:107], v[188:191], a[248:251], v[104:107]
    ds_read_b64_tr_b16 v[182:183], v3 offset:2304
    s_mul_i32 s46, s60, 1327104
    v_mfma_f32_16x16x32_bf16 v[108:111], v[188:191], a[252:255], v[108:111]
    s_waitcnt lgkmcnt(4)
    s_waitcnt vmcnt(5)
    v_mfma_f32_16x16x32_bf16 v[48:51], v[192:195], v[16:19], v[48:51]
    ds_read_b64_tr_b16 v[184:185], v2 offset:4096
    s_mul_i32 s65, s64, 288
    v_mfma_f32_16x16x32_bf16 v[52:55], v[192:195], v[20:23], v[52:55]
    v_mfma_f32_16x16x32_bf16 v[56:59], v[192:195], v[24:27], v[56:59]
    ds_read_b64_tr_b16 v[186:187], v2 offset:4352
    s_add_u32 s46, s46, s65
    v_mfma_f32_16x16x32_bf16 v[60:63], v[192:195], v[28:31], v[60:63]
    v_mfma_f32_16x16x32_bf16 v[64:67], v[196:199], v[16:19], v[64:67]
    ds_read_b64_tr_b16 v[188:189], v2 offset:6144
    s_and_b32 s65, s3, 1
    v_mfma_f32_16x16x32_bf16 v[68:71], v[196:199], v[20:23], v[68:71]
    v_mfma_f32_16x16x32_bf16 v[72:75], v[196:199], v[24:27], v[72:75]
    ds_read_b64_tr_b16 v[190:191], v2 offset:6400
    s_mul_i32 s65, s65, 663552
    v_mfma_f32_16x16x32_bf16 v[76:79], v[196:199], v[28:31], v[76:79]
    s_waitcnt lgkmcnt(4)
    v_mfma_f32_16x16x32_bf16 v[80:83], v[176:179], v[16:19], v[80:83]
    ds_read_b64_tr_b16 v[192:193], v3 offset:4096
    s_add_u32 s46, s46, s65
    v_mfma_f32_16x16x32_bf16 v[84:87], v[176:179], v[20:23], v[84:87]
    s_add_u32 m0, s40, 49152
    s_add_u32 s48, s42, 2949184
    buffer_load_dwordx4 v6, s[12:15], s48 offen lds
    v_mfma_f32_16x16x32_bf16 v[88:91], v[176:179], v[24:27], v[88:91]
    ds_read_b64_tr_b16 v[194:195], v3 offset:4352
    s_lshl_b32 s65, s58, 2
    v_mfma_f32_16x16x32_bf16 v[92:95], v[176:179], v[28:31], v[92:95]
    v_mfma_f32_16x16x32_bf16 v[96:99], v[180:183], v[16:19], v[96:99]
    ds_read_b64_tr_b16 v[196:197], v3 offset:6144
    s_add_u32 s65, s65, s64
    v_mfma_f32_16x16x32_bf16 v[100:103], v[180:183], v[20:23], v[100:103]
    v_mfma_f32_16x16x32_bf16 v[104:107], v[180:183], v[24:27], v[104:107]
    ds_read_b64_tr_b16 v[198:199], v3 offset:6400
    s_lshl_b32 s65, s65, 2
    v_mfma_f32_16x16x32_bf16 v[108:111], v[180:183], v[28:31], v[108:111]
    s_waitcnt lgkmcnt(4)
    v_mfma_f32_16x16x32_bf16 v[48:51], v[184:187], v[32:35], v[48:51]
    ds_read_b64_tr_b16 v[176:177], v2 offset:8192
    s_add_u32 s65, s65, s3
    v_mfma_f32_16x16x32_bf16 v[52:55], v[184:187], v[36:39], v[52:55]
    v_mfma_f32_16x16x32_bf16 v[56:59], v[184:187], v[40:43], v[56:59]
    ds_read_b64_tr_b16 v[178:179], v2 offset:8448
    s_mul_i32 s65, s65, 36
    v_mfma_f32_16x16x32_bf16 v[60:63], v[184:187], v[44:47], v[60:63]
    v_mfma_f32_16x16x32_bf16 v[64:67], v[188:191], v[32:35], v[64:67]
    ds_read_b64_tr_b16 v[180:181], v2 offset:10240
    s_add_u32 s65, s65, s60
    v_mfma_f32_16x16x32_bf16 v[68:71], v[188:191], v[36:39], v[68:71]
    s_add_u32 m0, s40, 50176
    s_add_u32 s48, s42, 3096640
    buffer_load_dwordx4 v6, s[12:15], s48 offen lds
    v_mfma_f32_16x16x32_bf16 v[72:75], v[188:191], v[40:43], v[72:75]
    ds_read_b64_tr_b16 v[182:183], v2 offset:10496
    s_lshl_b32 s61, s65, 10
    v_mfma_f32_16x16x32_bf16 v[76:79], v[188:191], v[44:47], v[76:79]
    s_waitcnt lgkmcnt(4)
    v_mfma_f32_16x16x32_bf16 v[80:83], v[192:195], v[32:35], v[80:83]
    ds_read_b64_tr_b16 v[184:185], v3 offset:8192
    v_mfma_f32_16x16x32_bf16 v[84:87], v[192:195], v[36:39], v[84:87]
    v_mfma_f32_16x16x32_bf16 v[88:91], v[192:195], v[40:43], v[88:91]
    ds_read_b64_tr_b16 v[186:187], v3 offset:8448
    v_mfma_f32_16x16x32_bf16 v[92:95], v[192:195], v[44:47], v[92:95]
    v_mfma_f32_16x16x32_bf16 v[96:99], v[196:199], v[32:35], v[96:99]
    ds_read_b64_tr_b16 v[188:189], v3 offset:10240
    v_mfma_f32_16x16x32_bf16 v[100:103], v[196:199], v[36:39], v[100:103]
    v_mfma_f32_16x16x32_bf16 v[104:107], v[196:199], v[40:43], v[104:107]
    ds_read_b64_tr_b16 v[190:191], v3 offset:10496
    v_mfma_f32_16x16x32_bf16 v[108:111], v[196:199], v[44:47], v[108:111]
    s_waitcnt lgkmcnt(4)
    v_mfma_f32_16x16x32_bf16 v[112:115], v[176:179], a[0:3], 0
    ds_read_b64_tr_b16 v[192:193], v2 offset:12288
    v_mfma_f32_16x16x32_bf16 v[116:119], v[176:179], a[4:7], 0
    v_mfma_f32_16x16x32_bf16 v[120:123], v[176:179], a[8:11], 0
    ds_read_b64_tr_b16 v[194:195], v2 offset:12544
    v_mul_f32 v200, s47, v48
    v_mfma_f32_16x16x32_bf16 v[124:127], v[176:179], a[12:15], 0
    v_mul_f32 v201, s47, v49
    v_mfma_f32_16x16x32_bf16 v[128:131], v[180:183], a[0:3], 0
    ds_read_b64_tr_b16 v[196:197], v2 offset:14336
    v_mfma_f32_16x16x32_bf16 v[132:135], v[180:183], a[4:7], 0
    v_exp_f32 v200, v200
    v_mfma_f32_16x16x32_bf16 v[136:139], v[180:183], a[8:11], 0
    ds_read_b64_tr_b16 v[198:199], v2 offset:14592
    v_mfma_f32_16x16x32_bf16 v[140:143], v[180:183], a[12:15], 0
    s_waitcnt lgkmcnt(4)
    v_mfma_f32_16x16x32_bf16 v[144:147], v[184:187], a[0:3], 0
    ds_read_b64_tr_b16 v[176:177], v3 offset:12288
    v_mfma_f32_16x16x32_bf16 v[148:151], v[184:187], a[4:7], 0
    s_mov_b32 s24, s10
    s_mov_b32 s25, s11
    s_mov_b32 s26, 5308416
    s_mov_b32 s27, 0x00020000
    v_mfma_f32_16x16x32_bf16 v[152:155], v[184:187], a[8:11], 0
    ds_read_b64_tr_b16 v[178:179], v3 offset:12544
    v_mfma_f32_16x16x32_bf16 v[156:159], v[184:187], a[12:15], 0
    v_exp_f32 v201, v201
    v_mfma_f32_16x16x32_bf16 v[160:163], v[188:191], a[0:3], 0
    ds_read_b64_tr_b16 v[180:181], v3 offset:14336
    v_mul_f32 v64, v48, v64
    v_mfma_f32_16x16x32_bf16 v[164:167], v[188:191], a[4:7], 0
    v_add_f32 v200, 1.0, v200
    v_add_f32 v201, 1.0, v201
    v_mfma_f32_16x16x32_bf16 v[168:171], v[188:191], a[8:11], 0
    ds_read_b64_tr_b16 v[182:183], v3 offset:14592
    v_mfma_f32_16x16x32_bf16 v[172:175], v[188:191], a[12:15], 0
    s_waitcnt vmcnt(6)
    s_barrier
    s_cmp_eq_u32 s68, 0
    s_cbranch_scc1 M_noy
    s_and_b32 s66, s2, 7
    s_lshl_b32 s66, s66, 7
    s_add_u32 s66, s66, 12288
    s_cmp_lg_u32 s3, 0
    s_cbranch_scc1 M_rf1
    v_mov_b32 v15, 1
    s_mov_b64 exec, 1
    buffer_atomic_add v15, off, s[36:39], s66
    s_mov_b64 exec, -1
M_rf1:
M_noy:
    s_waitcnt lgkmcnt(4)
    v_mfma_f32_16x16x32_bf16 v[112:115], v[192:195], a[16:19], v[112:115]
    ds_read_b64_tr_b16 v[184:185], v2 offset:16384
    v_mfma_f32_16x16x32_bf16 v[116:119], v[192:195], a[20:23], v[116:119]
    s_add_u32 m0, s40, 57344
    s_add_u32 s48, s42, 3539008
    buffer_load_dwordx4 v6, s[12:15], s48 offen lds
    v_mfma_f32_16x16x32_bf16 v[120:123], v[192:195], a[24:27], v[120:123]
    ds_read_b64_tr_b16 v[186:187], v2 offset:16640
    v_mfma_f32_16x16x32_bf16 v[124:127], v[192:195], a[28:31], v[124:127]
    v_rcp_f32 v200, v200
    v_mfma_f32_16x16x32_bf16 v[128:131], v[196:199], a[16:19], v[128:131]
    ds_read_b64_tr_b16 v[188:189], v2 offset:18432
    v_mfma_f32_16x16x32_bf16 v[132:135], v[196:199], a[20:23], v[132:135]
    v_rcp_f32 v201, v201
    v_mfma_f32_16x16x32_bf16 v[136:139], v[196:199], a[24:27], v[136:139]
    ds_read_b64_tr_b16 v[190:191], v2 offset:18688
    v_mul_f32 v65, v49, v65
    v_mfma_f32_16x16x32_bf16 v[140:143], v[196:199], a[28:31], v[140:143]
    v_mul_f32 v64, v64, v200
    s_waitcnt lgkmcnt(4)
    v_mfma_f32_16x16x32_bf16 v[144:147], v[176:179], a[16:19], v[144:147]
    ds_read_b64_tr_b16 v[192:193], v3 offset:16384
    v_mul_f32 v65, v65, v201
    v_mfma_f32_16x16x32_bf16 v[148:151], v[176:179], a[20:23], v[148:151]
    v_cvt_pk_bf16_f32 v208, v64, v65
    v_mul_f32 v202, s47, v50
    v_mfma_f32_16x16x32_bf16 v[152:155], v[176:179], a[24:27], v[152:155]
    ds_read_b64_tr_b16 v[194:195], v3 offset:16640
    v_mul_f32 v203, s47, v51
    v_mfma_f32_16x16x32_bf16 v[156:159], v[176:179], a[28:31], v[156:159]
    v_exp_f32 v202, v202
    v_mfma_f32_16x16x32_bf16 v[160:163], v[180:183], a[16:19], v[160:163]
    ds_read_b64_tr_b16 v[196:197], v3 offset:18432
    v_mfma_f32_16x16x32_bf16 v[164:167], v[180:183], a[20:23], v[164:167]
    v_exp_f32 v203, v203
    v_mfma_f32_16x16x32_bf16 v[168:171], v[180:183], a[24:27], v[168:171]
    ds_read_b64_tr_b16 v[198:199], v3 offset:18688
    v_mul_f32 v66, v50, v66
    v_mfma_f32_16x16x32_bf16 v[172:175], v[180:183], a[28:31], v[172:175]
    v_add_f32 v202, 1.0, v202
    s_waitcnt lgkmcnt(4)
    v_mfma_f32_16x16x32_bf16 v[112:115], v[184:187], a[32:35], v[112:115]
    ds_read_b64_tr_b16 v[176:177], v2 offset:20480
    v_add_f32 v203, 1.0, v203
    v_mfma_f32_16x16x32_bf16 v[116:119], v[184:187], a[36:39], v[116:119]
    s_add_u32 m0, s40, 58368
    s_add_u32 s48, s42, 3686464
    buffer_load_dwordx4 v6, s[12:15], s48 offen lds
    v_mfma_f32_16x16x32_bf16 v[120:123], v[184:187], a[40:43], v[120:123]
    ds_read_b64_tr_b16 v[178:179], v2 offset:20736
    v_mfma_f32_16x16x32_bf16 v[124:127], v[184:187], a[44:47], v[124:127]
    v_rcp_f32 v202, v202
    v_mfma_f32_16x16x32_bf16 v[128:131], v[188:191], a[32:35], v[128:131]
    ds_read_b64_tr_b16 v[180:181], v2 offset:22528
    v_mfma_f32_16x16x32_bf16 v[132:135], v[188:191], a[36:39], v[132:135]
    s_mov_b32 s59, 0
    s_cmp_lt_u32 s3, 2
    s_cselect_b32 s59, s59, 36864
    s_add_u32 s59, s59, s46
    v_mfma_f32_16x16x32_bf16 v[136:139], v[188:191], a[40:43], v[136:139]
    ds_read_b64_tr_b16 v[182:183], v2 offset:22784
    v_mfma_f32_16x16x32_bf16 v[140:143], v[188:191], a[44:47], v[140:143]
    s_waitcnt lgkmcnt(4)
    v_mfma_f32_16x16x32_bf16 v[144:147], v[192:195], a[32:35], v[144:147]
    ds_read_b64_tr_b16 v[184:185], v3 offset:20480
    v_mfma_f32_16x16x32_bf16 v[148:151], v[192:195], a[36:39], v[148:151]
    v_rcp_f32 v203, v203
    v_mfma_f32_16x16x32_bf16 v[152:155], v[192:195], a[40:43], v[152:155]
    ds_read_b64_tr_b16 v[186:187], v3 offset:20736
    v_mul_f32 v67, v51, v67
    v_mfma_f32_16x16x32_bf16 v[156:159], v[192:195], a[44:47], v[156:159]
    v_mul_f32 v66, v66, v202
    v_mul_f32 v67, v67, v203
    v_mfma_f32_16x16x32_bf16 v[160:163], v[196:199], a[32:35], v[160:163]
    ds_read_b64_tr_b16 v[188:189], v3 offset:22528
    v_cvt_pk_bf16_f32 v209, v66, v67
    v_mfma_f32_16x16x32_bf16 v[164:167], v[196:199], a[36:39], v[164:167]
    s_add_u32 m0, s40, 0
    s_add_u32 s48, s42, 4128832
    buffer_load_dwordx4 v6, s[12:15], s48 offen lds
    v_mfma_f32_16x16x32_bf16 v[168:171], v[196:199], a[40:43], v[168:171]
    ds_read_b64_tr_b16 v[190:191], v3 offset:22784
    v_mul_f32 v204, s47, v80
    v_mfma_f32_16x16x32_bf16 v[172:175], v[196:199], a[44:47], v[172:175]
    v_mul_f32 v205, s47, v81
    s_waitcnt lgkmcnt(4)
    v_mfma_f32_16x16x32_bf16 v[112:115], v[176:179], a[48:51], v[112:115]
    ds_read_b64_tr_b16 v[192:193], v2 offset:24576
    v_mfma_f32_16x16x32_bf16 v[116:119], v[176:179], a[52:55], v[116:119]
    v_exp_f32 v204, v204
    v_mfma_f32_16x16x32_bf16 v[120:123], v[176:179], a[56:59], v[120:123]
    ds_read_b64_tr_b16 v[194:195], v2 offset:24832
    v_mfma_f32_16x16x32_bf16 v[124:127], v[176:179], a[60:63], v[124:127]
    v_exp_f32 v205, v205
    v_mfma_f32_16x16x32_bf16 v[128:131], v[180:183], a[48:51], v[128:131]
    ds_read_b64_tr_b16 v[196:197], v2 offset:26624
    v_mul_f32 v96, v80, v96
    v_mfma_f32_16x16x32_bf16 v[132:135], v[180:183], a[52:55], v[132:135]
    v_add_f32 v204, 1.0, v204
    v_add_f32 v205, 1.0, v205
    v_mfma_f32_16x16x32_bf16 v[136:139], v[180:183], a[56:59], v[136:139]
    ds_read_b64_tr_b16 v[198:199], v2 offset:26880
    v_mfma_f32_16x16x32_bf16 v[140:143], v[180:183], a[60:63], v[140:143]
    s_waitcnt lgkmcnt(4)
    v_mfma_f32_16x16x32_bf16 v[144:147], v[184:187], a[48:51], v[144:147]
    ds_read_b64_tr_b16 v[176:177], v3 offset:24576
    v_mfma_f32_16x16x32_bf16 v[148:151], v[184:187], a[52:55], v[148:151]
    s_add_u32 m0, s54, 0
    s_nop 0
    buffer_load_dwordx4 v216, s[24:27], s59 offen lds
    v_mfma_f32_16x16x32_bf16 v[152:155], v[184:187], a[56:59], v[152:155]
    ds_read_b64_tr_b16 v[178:179], v3 offset:24832
    v_mfma_f32_16x16x32_bf16 v[156:159], v[184:187], a[60:63], v[156:159]
    s_add_u32 m0, s40, 1024
    s_add_u32 s48, s42, 4276288
    buffer_load_dwordx4 v6, s[12:15], s48 offen lds
    v_mfma_f32_16x16x32_bf16 v[160:163], v[188:191], a[48:51], v[160:163]
    ds_read_b64_tr_b16 v[180:181], v3 offset:26624
    v_mfma_f32_16x16x32_bf16 v[164:167], v[188:191], a[52:55], v[164:167]
    v_rcp_f32 v204, v204
    v_mfma_f32_16x16x32_bf16 v[168:171], v[188:191], a[56:59], v[168:171]
    ds_read_b64_tr_b16 v[182:183], v3 offset:26880
    v_mfma_f32_16x16x32_bf16 v[172:175], v[188:191], a[60:63], v[172:175]
    s_waitcnt lgkmcnt(4)
    v_mfma_f32_16x16x32_bf16 v[112:115], v[192:195], a[64:67], v[112:115]
    ds_read_b64_tr_b16 v[184:185], v2 offset:28672
    v_mfma_f32_16x16x32_bf16 v[116:119], v[192:195], a[68:71], v[116:119]
    v_rcp_f32 v205, v205
    v_mfma_f32_16x16x32_bf16 v[120:123], v[192:195], a[72:75], v[120:123]
    ds_read_b64_tr_b16 v[186:187], v2 offset:28928
    v_mul_f32 v97, v81, v97
    v_mfma_f32_16x16x32_bf16 v[124:127], v[192:195], a[76:79], v[124:127]
    v_mul_f32 v96, v96, v204
    v_mul_f32 v97, v97, v205
    v_mfma_f32_16x16x32_bf16 v[128:131], v[196:199], a[64:67], v[128:131]
    ds_read_b64_tr_b16 v[188:189], v2 offset:30720
    v_cvt_pk_bf16_f32 v210, v96, v97
    v_mfma_f32_16x16x32_bf16 v[132:135], v[196:199], a[68:71], v[132:135]
    v_mul_f32 v206, s47, v82
    v_mul_f32 v207, s47, v83
    v_mfma_f32_16x16x32_bf16 v[136:139], v[196:199], a[72:75], v[136:139]
    ds_read_b64_tr_b16 v[190:191], v2 offset:30976
    v_mfma_f32_16x16x32_bf16 v[140:143], v[196:199], a[76:79], v[140:143]
    s_waitcnt lgkmcnt(4)
    v_mfma_f32_16x16x32_bf16 v[144:147], v[176:179], a[64:67], v[144:147]
    ds_read_b64_tr_b16 v[192:193], v3 offset:28672
    v_mfma_f32_16x16x32_bf16 v[148:151], v[176:179], a[68:71], v[148:151]
    v_exp_f32 v206, v206
    v_mfma_f32_16x16x32_bf16 v[152:155], v[176:179], a[72:75], v[152:155]
    ds_read_b64_tr_b16 v[194:195], v3 offset:28928
    v_mfma_f32_16x16x32_bf16 v[156:159], v[176:179], a[76:79], v[156:159]
    v_exp_f32 v207, v207
    v_mfma_f32_16x16x32_bf16 v[160:163], v[180:183], a[64:67], v[160:163]
    ds_read_b64_tr_b16 v[196:197], v3 offset:30720
    v_mul_f32 v98, v82, v98
    v_mfma_f32_16x16x32_bf16 v[164:167], v[180:183], a[68:71], v[164:167]
    v_add_f32 v206, 1.0, v206
    v_add_f32 v207, 1.0, v207
    v_mfma_f32_16x16x32_bf16 v[168:171], v[180:183], a[72:75], v[168:171]
    ds_read_b64_tr_b16 v[198:199], v3 offset:30976
    v_mfma_f32_16x16x32_bf16 v[172:175], v[180:183], a[76:79], v[172:175]
    s_waitcnt vmcnt(7)
    s_barrier
    s_waitcnt lgkmcnt(4)
    v_mfma_f32_16x16x32_bf16 v[112:115], v[184:187], a[80:83], v[112:115]
    ds_read_b64_tr_b16 v[176:177], v2 offset:32768
    v_mfma_f32_16x16x32_bf16 v[116:119], v[184:187], a[84:87], v[116:119]
    s_add_u32 m0, s40, 8192
    s_add_u32 s48, s42, 4718656
    buffer_load_dwordx4 v6, s[12:15], s48 offen lds
    v_mfma_f32_16x16x32_bf16 v[120:123], v[184:187], a[88:91], v[120:123]
    ds_read_b64_tr_b16 v[178:179], v2 offset:33024
    v_mfma_f32_16x16x32_bf16 v[124:127], v[184:187], a[92:95], v[124:127]
    s_add_u32 m0, s54, 1024
    s_nop 0
    buffer_load_dwordx4 v217, s[24:27], s59 offen lds
    v_mfma_f32_16x16x32_bf16 v[128:131], v[188:191], a[80:83], v[128:131]
    ds_read_b64_tr_b16 v[180:181], v2 offset:34816
    v_mfma_f32_16x16x32_bf16 v[132:135], v[188:191], a[84:87], v[132:135]
    v_rcp_f32 v206, v206
    v_mfma_f32_16x16x32_bf16 v[136:139], v[188:191], a[88:91], v[136:139]
    ds_read_b64_tr_b16 v[182:183], v2 offset:35072
    v_mfma_f32_16x16x32_bf16 v[140:143], v[188:191], a[92:95], v[140:143]
    s_waitcnt lgkmcnt(4)
    v_mfma_f32_16x16x32_bf16 v[144:147], v[192:195], a[80:83], v[144:147]
    ds_read_b64_tr_b16 v[184:185], v3 offset:32768
    v_mfma_f32_16x16x32_bf16 v[148:151], v[192:195], a[84:87], v[148:151]
    v_rcp_f32 v207, v207
    v_mfma_f32_16x16x32_bf16 v[152:155], v[192:195], a[88:91], v[152:155]
    ds_read_b64_tr_b16 v[186:187], v3 offset:33024
    v_mul_f32 v99, v83, v99
    v_mfma_f32_16x16x32_bf16 v[156:159], v[192:195], a[92:95], v[156:159]
    v_mul_f32 v98, v98, v206
    v_mul_f32 v99, v99, v207
    v_mfma_f32_16x16x32_bf16 v[160:163], v[196:199], a[80:83], v[160:163]
    ds_read_b64_tr_b16 v[188:189], v3 offset:34816
    v_cvt_pk_bf16_f32 v211, v98, v99
    v_mfma_f32_16x16x32_bf16 v[164:167], v[196:199], a[84:87], v[164:167]
    s_add_u32 s49, s45, 0
    buffer_store_dwordx4 v[208:211], v1, s[20:23], s49 offen sc1
    v_mfma_f32_16x16x32_bf16 v[168:171], v[196:199], a[88:91], v[168:171]
    ds_read_b64_tr_b16 v[190:191], v3 offset:35072
    v_mul_f32 v200, s47, v52
    v_mfma_f32_16x16x32_bf16 v[172:175], v[196:199], a[92:95], v[172:175]
    v_mul_f32 v201, s47, v53
    s_waitcnt lgkmcnt(4)
    v_mfma_f32_16x16x32_bf16 v[112:115], v[176:179], a[96:99], v[112:115]
    ds_read_b64_tr_b16 v[192:193], v2 offset:36864
    v_mfma_f32_16x16x32_bf16 v[116:119], v[176:179], a[100:103], v[116:119]
    s_add_u32 m0, s40, 9216
    s_add_u32 s48, s42, 4866112
    buffer_load_dwordx4 v6, s[12:15], s48 offen lds
    v_mfma_f32_16x16x32_bf16 v[120:123], v[176:179], a[104:107], v[120:123]
    ds_read_b64_tr_b16 v[194:195], v2 offset:37120
    v_mfma_f32_16x16x32_bf16 v[124:127], v[176:179], a[108:111], v[124:127]
    s_add_u32 m0, s54, 2048
    s_nop 0
    buffer_load_dwordx4 v218, s[24:27], s59 offen lds
    v_mfma_f32_16x16x32_bf16 v[128:131], v[180:183], a[96:99], v[128:131]
    ds_read_b64_tr_b16 v[196:197], v2 offset:38912
    v_mfma_f32_16x16x32_bf16 v[132:135], v[180:183], a[100:103], v[132:135]
    v_exp_f32 v200, v200
    v_mfma_f32_16x16x32_bf16 v[136:139], v[180:183], a[104:107], v[136:139]
    ds_read_b64_tr_b16 v[198:199], v2 offset:39168
    v_mfma_f32_16x16x32_bf16 v[140:143], v[180:183], a[108:111], v[140:143]
    s_waitcnt lgkmcnt(4)
    v_mfma_f32_16x16x32_bf16 v[144:147], v[184:187], a[96:99], v[144:147]
    ds_read_b64_tr_b16 v[176:177], v3 offset:36864
    v_mfma_f32_16x16x32_bf16 v[148:151], v[184:187], a[100:103], v[148:151]
    v_exp_f32 v201, v201
    v_mfma_f32_16x16x32_bf16 v[152:155], v[184:187], a[104:107], v[152:155]
    ds_read_b64_tr_b16 v[178:179], v3 offset:37120
    v_mul_f32 v68, v52, v68
    v_mfma_f32_16x16x32_bf16 v[156:159], v[184:187], a[108:111], v[156:159]
    v_add_f32 v200, 1.0, v200
    v_add_f32 v201, 1.0, v201
    v_mfma_f32_16x16x32_bf16 v[160:163], v[188:191], a[96:99], v[160:163]
    ds_read_b64_tr_b16 v[180:181], v3 offset:38912
    v_mfma_f32_16x16x32_bf16 v[164:167], v[188:191], a[100:103], v[164:167]
    s_add_u32 m0, s40, 16384
    s_add_u32 s48, s42, 128
    buffer_load_dwordx4 v6, s[12:15], s48 offen lds
    v_mfma_f32_16x16x32_bf16 v[168:171], v[188:191], a[104:107], v[168:171]
    ds_read_b64_tr_b16 v[182:183], v3 offset:39168
    v_mfma_f32_16x16x32_bf16 v[172:175], v[188:191], a[108:111], v[172:175]
    s_waitcnt lgkmcnt(4)
    v_mfma_f32_16x16x32_bf16 v[112:115], v[192:195], a[112:115], v[112:115]
    ds_read_b64_tr_b16 v[184:185], v2 offset:40960
    v_mfma_f32_16x16x32_bf16 v[116:119], v[192:195], a[116:119], v[116:119]
    v_rcp_f32 v200, v200
    v_mfma_f32_16x16x32_bf16 v[120:123], v[192:195], a[120:123], v[120:123]
    ds_read_b64_tr_b16 v[186:187], v2 offset:41216
    v_mfma_f32_16x16x32_bf16 v[124:127], v[192:195], a[124:127], v[124:127]
    v_rcp_f32 v201, v201
    v_mfma_f32_16x16x32_bf16 v[128:131], v[196:199], a[112:115], v[128:131]
    ds_read_b64_tr_b16 v[188:189], v2 offset:43008
    v_mul_f32 v69, v53, v69
    v_mfma_f32_16x16x32_bf16 v[132:135], v[196:199], a[116:119], v[132:135]
    v_mul_f32 v68, v68, v200
    v_mul_f32 v69, v69, v201
    v_mfma_f32_16x16x32_bf16 v[136:139], v[196:199], a[120:123], v[136:139]
    ds_read_b64_tr_b16 v[190:191], v2 offset:43264
    v_cvt_pk_bf16_f32 v212, v68, v69
    v_mfma_f32_16x16x32_bf16 v[140:143], v[196:199], a[124:127], v[140:143]
    v_mul_f32 v202, s47, v54
    s_waitcnt lgkmcnt(4)
    v_mfma_f32_16x16x32_bf16 v[144:147], v[176:179], a[112:115], v[144:147]
    ds_read_b64_tr_b16 v[192:193], v3 offset:40960
    v_mul_f32 v203, s47, v55
    v_mfma_f32_16x16x32_bf16 v[148:151], v[176:179], a[116:119], v[148:151]
    s_add_u32 m0, s54, 3072
    s_nop 0
    buffer_load_dwordx4 v219, s[24:27], s59 offen lds
    v_mfma_f32_16x16x32_bf16 v[152:155], v[176:179], a[120:123], v[152:155]
    ds_read_b64_tr_b16 v[194:195], v3 offset:41216
    v_mfma_f32_16x16x32_bf16 v[156:159], v[176:179], a[124:127], v[156:159]
    s_add_u32 m0, s40, 17408
    s_add_u32 s48, s42, 147584
    buffer_load_dwordx4 v6, s[12:15], s48 offen lds
    v_mfma_f32_16x16x32_bf16 v[160:163], v[180:183], a[112:115], v[160:163]
    ds_read_b64_tr_b16 v[196:197], v3 offset:43008
    v_mfma_f32_16x16x32_bf16 v[164:167], v[180:183], a[116:119], v[164:167]
    v_exp_f32 v202, v202
    v_mfma_f32_16x16x32_bf16 v[168:171], v[180:183], a[120:123], v[168:171]
    ds_read_b64_tr_b16 v[198:199], v3 offset:43264
    v_mfma_f32_16x16x32_bf16 v[172:175], v[180:183], a[124:127], v[172:175]
    s_waitcnt lgkmcnt(4)
    v_mfma_f32_16x16x32_bf16 v[112:115], v[184:187], a[128:131], v[112:115]
    ds_read_b64_tr_b16 v[176:177], v2 offset:45056
    v_mfma_f32_16x16x32_bf16 v[116:119], v[184:187], a[132:135], v[116:119]
    v_exp_f32 v203, v203
    v_mfma_f32_16x16x32_bf16 v[120:123], v[184:187], a[136:139], v[120:123]
    ds_read_b64_tr_b16 v[178:179], v2 offset:45312
    v_mul_f32 v70, v54, v70
    v_mfma_f32_16x16x32_bf16 v[124:127], v[184:187], a[140:143], v[124:127]
    v_add_f32 v202, 1.0, v202
    v_add_f32 v203, 1.0, v203
    v_mfma_f32_16x16x32_bf16 v[128:131], v[188:191], a[128:131], v[128:131]
    ds_read_b64_tr_b16 v[180:181], v2 offset:47104
    v_mfma_f32_16x16x32_bf16 v[132:135], v[188:191], a[132:135], v[132:135]
    v_rcp_f32 v202, v202
    v_mfma_f32_16x16x32_bf16 v[136:139], v[188:191], a[136:139], v[136:139]
    ds_read_b64_tr_b16 v[182:183], v2 offset:47360
    v_mfma_f32_16x16x32_bf16 v[140:143], v[188:191], a[140:143], v[140:143]
    s_waitcnt lgkmcnt(4)
    v_mfma_f32_16x16x32_bf16 v[144:147], v[192:195], a[128:131], v[144:147]
    ds_read_b64_tr_b16 v[184:185], v3 offset:45056
    v_mfma_f32_16x16x32_bf16 v[148:151], v[192:195], a[132:135], v[148:151]
    v_rcp_f32 v203, v203
    v_mfma_f32_16x16x32_bf16 v[152:155], v[192:195], a[136:139], v[152:155]
    ds_read_b64_tr_b16 v[186:187], v3 offset:45312
    v_mul_f32 v71, v55, v71
    v_mfma_f32_16x16x32_bf16 v[156:159], v[192:195], a[140:143], v[156:159]
    v_mul_f32 v70, v70, v202
    v_mul_f32 v71, v71, v203
    v_mfma_f32_16x16x32_bf16 v[160:163], v[196:199], a[128:131], v[160:163]
    ds_read_b64_tr_b16 v[188:189], v3 offset:47104
    v_cvt_pk_bf16_f32 v213, v70, v71
    v_mfma_f32_16x16x32_bf16 v[164:167], v[196:199], a[132:135], v[164:167]
    v_mul_f32 v204, s47, v84
    v_mul_f32 v205, s47, v85
    v_mfma_f32_16x16x32_bf16 v[168:171], v[196:199], a[136:139], v[168:171]
    ds_read_b64_tr_b16 v[190:191], v3 offset:47360
    v_mfma_f32_16x16x32_bf16 v[172:175], v[196:199], a[140:143], v[172:175]
    s_waitcnt vmcnt(11)
    s_barrier
    s_waitcnt lgkmcnt(4)
    v_mfma_f32_16x16x32_bf16 v[112:115], v[176:179], a[144:147], v[112:115]
    ds_read_b64_tr_b16 v[192:193], v2 offset:49152
    v_mfma_f32_16x16x32_bf16 v[116:119], v[176:179], a[148:151], v[116:119]
    s_add_u32 m0, s40, 24576
    s_add_u32 s48, s42, 589952
    buffer_load_dwordx4 v6, s[12:15], s48 offen lds
    v_mfma_f32_16x16x32_bf16 v[120:123], v[176:179], a[152:155], v[120:123]
    ds_read_b64_tr_b16 v[194:195], v2 offset:49408
    v_mfma_f32_16x16x32_bf16 v[124:127], v[176:179], a[156:159], v[124:127]
    s_add_u32 m0, s54, 4096
    s_nop 0
    buffer_load_dwordx4 v220, s[24:27], s59 offen lds
    v_mfma_f32_16x16x32_bf16 v[128:131], v[180:183], a[144:147], v[128:131]
    ds_read_b64_tr_b16 v[196:197], v2 offset:51200
    v_mfma_f32_16x16x32_bf16 v[132:135], v[180:183], a[148:151], v[132:135]
    v_exp_f32 v204, v204
    v_mfma_f32_16x16x32_bf16 v[136:139], v[180:183], a[152:155], v[136:139]
    ds_read_b64_tr_b16 v[198:199], v2 offset:51456
    v_mfma_f32_16x16x32_bf16 v[140:143], v[180:183], a[156:159], v[140:143]
    s_waitcnt lgkmcnt(4)
    v_mfma_f32_16x16x32_bf16 v[144:147], v[184:187], a[144:147], v[144:147]
    ds_read_b64_tr_b16 v[176:177], v3 offset:49152
    v_mfma_f32_16x16x32_bf16 v[148:151], v[184:187], a[148:151], v[148:151]
    v_exp_f32 v205, v205
    v_mfma_f32_16x16x32_bf16 v[152:155], v[184:187], a[152:155], v[152:155]
    ds_read_b64_tr_b16 v[178:179], v3 offset:49408
    v_mul_f32 v100, v84, v100
    v_mfma_f32_16x16x32_bf16 v[156:159], v[184:187], a[156:159], v[156:159]
    v_add_f32 v204, 1.0, v204
    v_add_f32 v205, 1.0, v205
    v_mfma_f32_16x16x32_bf16 v[160:163], v[188:191], a[144:147], v[160:163]
    ds_read_b64_tr_b16 v[180:181], v3 offset:51200
    v_mfma_f32_16x16x32_bf16 v[164:167], v[188:191], a[148:151], v[164:167]
    v_rcp_f32 v204, v204
    v_mfma_f32_16x16x32_bf16 v[168:171], v[188:191], a[152:155], v[168:171]
    ds_read_b64_tr_b16 v[182:183], v3 offset:51456
    v_mfma_f32_16x16x32_bf16 v[172:175], v[188:191], a[156:159], v[172:175]
    s_waitcnt lgkmcnt(4)
    v_mfma_f32_16x16x32_bf16 v[112:115], v[192:195], a[160:163], v[112:115]
    ds_read_b64_tr_b16 v[184:185], v2 offset:53248
    v_mfma_f32_16x16x32_bf16 v[116:119], v[192:195], a[164:167], v[116:119]
    s_add_u32 m0, s40, 25600
    s_add_u32 s48, s42, 737408
    buffer_load_dwordx4 v6, s[12:15], s48 offen lds
    v_mfma_f32_16x16x32_bf16 v[120:123], v[192:195], a[168:171], v[120:123]
    ds_read_b64_tr_b16 v[186:187], v2 offset:53504
    v_mfma_f32_16x16x32_bf16 v[124:127], v[192:195], a[172:175], v[124:127]
    s_add_u32 m0, s54, 5120
    s_nop 0
    buffer_load_dwordx4 v221, s[24:27], s59 offen lds
    v_mfma_f32_16x16x32_bf16 v[128:131], v[196:199], a[160:163], v[128:131]
    ds_read_b64_tr_b16 v[188:189], v2 offset:55296
    v_mfma_f32_16x16x32_bf16 v[132:135], v[196:199], a[164:167], v[132:135]
    v_rcp_f32 v205, v205
    v_mfma_f32_16x16x32_bf16 v[136:139], v[196:199], a[168:171], v[136:139]
    ds_read_b64_tr_b16 v[190:191], v2 offset:55552
    v_mul_f32 v101, v85, v101
    v_mfma_f32_16x16x32_bf16 v[140:143], v[196:199], a[172:175], v[140:143]
    v_mul_f32 v100, v100, v204
    s_waitcnt lgkmcnt(4)
    v_mfma_f32_16x16x32_bf16 v[144:147], v[176:179], a[160:163], v[144:147]
    ds_read_b64_tr_b16 v[192:193], v3 offset:53248
    v_mul_f32 v101, v101, v205
    v_mfma_f32_16x16x32_bf16 v[148:151], v[176:179], a[164:167], v[148:151]
    v_cvt_pk_bf16_f32 v214, v100, v101
    v_mul_f32 v206, s47, v86
    v_mfma_f32_16x16x32_bf16 v[152:155], v[176:179], a[168:171], v[152:155]
    ds_read_b64_tr_b16 v[194:195], v3 offset:53504
    v_mul_f32 v207, s47, v87
    v_mfma_f32_16x16x32_bf16 v[156:159], v[176:179], a[172:175], v[156:159]
    v_exp_f32 v206, v206
    v_mfma_f32_16x16x32_bf16 v[160:163], v[180:183], a[160:163], v[160:163]
    ds_read_b64_tr_b16 v[196:197], v3 offset:55296
    v_mfma_f32_16x16x32_bf16 v[164:167], v[180:183], a[164:167], v[164:167]
    s_add_u32 m0, s40, 32768
    s_add_u32 s48, s42, 1179776
    buffer_load_dwordx4 v6, s[12:15], s48 offen lds
    v_mfma_f32_16x16x32_bf16 v[168:171], v[180:183], a[168:171], v[168:171]
    ds_read_b64_tr_b16 v[198:199], v3 offset:55552
    v_mfma_f32_16x16x32_bf16 v[172:175], v[180:183], a[172:175], v[172:175]
    s_waitcnt lgkmcnt(4)
    v_mfma_f32_16x16x32_bf16 v[112:115], v[184:187], a[176:179], v[112:115]
    ds_read_b64_tr_b16 v[176:177], v2 offset:57344
    v_mfma_f32_16x16x32_bf16 v[116:119], v[184:187], a[180:183], v[116:119]
    v_exp_f32 v207, v207
    v_mfma_f32_16x16x32_bf16 v[120:123], v[184:187], a[184:187], v[120:123]
    ds_read_b64_tr_b16 v[178:179], v2 offset:57600
    v_mul_f32 v102, v86, v102
    v_mfma_f32_16x16x32_bf16 v[124:127], v[184:187], a[188:191], v[124:127]
    v_add_f32 v206, 1.0, v206
    v_add_f32 v207, 1.0, v207
    v_mfma_f32_16x16x32_bf16 v[128:131], v[188:191], a[176:179], v[128:131]
    ds_read_b64_tr_b16 v[180:181], v2 offset:59392
    v_mfma_f32_16x16x32_bf16 v[132:135], v[188:191], a[180:183], v[132:135]
    v_rcp_f32 v206, v206
    v_mfma_f32_16x16x32_bf16 v[136:139], v[188:191], a[184:187], v[136:139]
    ds_read_b64_tr_b16 v[182:183], v2 offset:59648
    v_mfma_f32_16x16x32_bf16 v[140:143], v[188:191], a[188:191], v[140:143]
    s_waitcnt lgkmcnt(4)
    v_mfma_f32_16x16x32_bf16 v[144:147], v[192:195], a[176:179], v[144:147]
    ds_read_b64_tr_b16 v[184:185], v3 offset:57344
    v_mfma_f32_16x16x32_bf16 v[148:151], v[192:195], a[180:183], v[148:151]
    s_add_u32 m0, s54, 6144
    s_nop 0
    buffer_load_dwordx4 v222, s[24:27], s59 offen lds
    v_mfma_f32_16x16x32_bf16 v[152:155], v[192:195], a[184:187], v[152:155]
    ds_read_b64_tr_b16 v[186:187], v3 offset:57600
    v_mfma_f32_16x16x32_bf16 v[156:159], v[192:195], a[188:191], v[156:159]
    s_add_u32 m0, s40, 33792
    s_add_u32 s48, s42, 1327232
    buffer_load_dwordx4 v6, s[12:15], s48 offen lds
    v_mfma_f32_16x16x32_bf16 v[160:163], v[196:199], a[176:179], v[160:163]
    ds_read_b64_tr_b16 v[188:189], v3 offset:59392
    v_mfma_f32_16x16x32_bf16 v[164:167], v[196:199], a[180:183], v[164:167]
    v_rcp_f32 v207, v207
    v_mfma_f32_16x16x32_bf16 v[168:171], v[196:199], a[184:187], v[168:171]
    ds_read_b64_tr_b16 v[190:191], v3 offset:59648
    v_mul_f32 v103, v87, v103
    v_mfma_f32_16x16x32_bf16 v[172:175], v[196:199], a[188:191], v[172:175]
    v_mul_f32 v102, v102, v206
    s_waitcnt lgkmcnt(4)
    v_mfma_f32_16x16x32_bf16 v[112:115], v[176:179], a[192:195], v[112:115]
    ds_read_b64_tr_b16 v[192:193], v2 offset:61440
    v_mul_f32 v103, v103, v207
    v_mfma_f32_16x16x32_bf16 v[116:119], v[176:179], a[196:199], v[116:119]
    v_cvt_pk_bf16_f32 v215, v102, v103
    s_add_u32 s49, s45, 18432
    v_mfma_f32_16x16x32_bf16 v[120:123], v[176:179], a[200:203], v[120:123]
    ds_read_b64_tr_b16 v[194:195], v2 offset:61696
    buffer_store_dwordx4 v[212:215], v1, s[20:23], s49 offen sc1
    v_mfma_f32_16x16x32_bf16 v[124:127], v[176:179], a[204:207], v[124:127]
    v_mul_f32 v200, s47, v56
    v_mul_f32 v201, s47, v57
    v_mfma_f32_16x16x32_bf16 v[128:131], v[180:183], a[192:195], v[128:131]
    ds_read_b64_tr_b16 v[196:197], v2 offset:63488
    v_mfma_f32_16x16x32_bf16 v[132:135], v[180:183], a[196:199], v[132:135]
    v_exp_f32 v200, v200
    v_mfma_f32_16x16x32_bf16 v[136:139], v[180:183], a[200:203], v[136:139]
    ds_read_b64_tr_b16 v[198:199], v2 offset:63744
    v_mfma_f32_16x16x32_bf16 v[140:143], v[180:183], a[204:207], v[140:143]
    s_waitcnt lgkmcnt(4)
    v_mfma_f32_16x16x32_bf16 v[144:147], v[184:187], a[192:195], v[144:147]
    ds_read_b64_tr_b16 v[176:177], v3 offset:61440
    v_mfma_f32_16x16x32_bf16 v[148:151], v[184:187], a[196:199], v[148:151]
    v_exp_f32 v201, v201
    v_mfma_f32_16x16x32_bf16 v[152:155], v[184:187], a[200:203], v[152:155]
    ds_read_b64_tr_b16 v[178:179], v3 offset:61696
    v_mul_f32 v72, v56, v72
    v_mfma_f32_16x16x32_bf16 v[156:159], v[184:187], a[204:207], v[156:159]
    v_add_f32 v200, 1.0, v200
    v_add_f32 v201, 1.0, v201
    v_mfma_f32_16x16x32_bf16 v[160:163], v[188:191], a[192:195], v[160:163]
    ds_read_b64_tr_b16 v[180:181], v3 offset:63488
    v_mfma_f32_16x16x32_bf16 v[164:167], v[188:191], a[196:199], v[164:167]
    s_add_u32 m0, s54, 7168
    s_nop 0
    buffer_load_dwordx4 v223, s[24:27], s59 offen lds
    v_mfma_f32_16x16x32_bf16 v[168:171], v[188:191], a[200:203], v[168:171]
    ds_read_b64_tr_b16 v[182:183], v3 offset:63744
    v_mfma_f32_16x16x32_bf16 v[172:175], v[188:191], a[204:207], v[172:175]
    s_waitcnt vmcnt(13)
    s_barrier
    s_waitcnt lgkmcnt(4)
    v_mfma_f32_16x16x32_bf16 v[112:115], v[192:195], a[208:211], v[112:115]
    ds_read_b64_tr_b16 v[184:185], v2 offset:0
    v_mfma_f32_16x16x32_bf16 v[116:119], v[192:195], a[212:215], v[116:119]
    s_add_u32 m0, s40, 40960
    s_add_u32 s48, s42, 1769600
    buffer_load_dwordx4 v6, s[12:15], s48 offen lds
    v_mfma_f32_16x16x32_bf16 v[120:123], v[192:195], a[216:219], v[120:123]
    ds_read_b64_tr_b16 v[186:187], v2 offset:256
    v_mfma_f32_16x16x32_bf16 v[124:127], v[192:195], a[220:223], v[124:127]
    v_rcp_f32 v200, v200
    v_mfma_f32_16x16x32_bf16 v[128:131], v[196:199], a[208:211], v[128:131]
    ds_read_b64_tr_b16 v[188:189], v2 offset:2048
    v_mfma_f32_16x16x32_bf16 v[132:135], v[196:199], a[212:215], v[132:135]
    v_rcp_f32 v201, v201
    v_mfma_f32_16x16x32_bf16 v[136:139], v[196:199], a[216:219], v[136:139]
    ds_read_b64_tr_b16 v[190:191], v2 offset:2304
    v_mul_f32 v73, v57, v73
    v_mfma_f32_16x16x32_bf16 v[140:143], v[196:199], a[220:223], v[140:143]
    v_mul_f32 v72, v72, v200
    s_waitcnt lgkmcnt(4)
    v_mfma_f32_16x16x32_bf16 v[144:147], v[176:179], a[208:211], v[144:147]
    ds_read_b64_tr_b16 v[192:193], v3 offset:0
    v_mul_f32 v73, v73, v201
    v_mfma_f32_16x16x32_bf16 v[148:151], v[176:179], a[212:215], v[148:151]
    v_cvt_pk_bf16_f32 v208, v72, v73
    v_mul_f32 v202, s47, v58
    v_mfma_f32_16x16x32_bf16 v[152:155], v[176:179], a[216:219], v[152:155]
    ds_read_b64_tr_b16 v[194:195], v3 offset:256
    v_mul_f32 v203, s47, v59
    v_mfma_f32_16x16x32_bf16 v[156:159], v[176:179], a[220:223], v[156:159]
    v_exp_f32 v202, v202
    v_mfma_f32_16x16x32_bf16 v[160:163], v[180:183], a[208:211], v[160:163]
    ds_read_b64_tr_b16 v[196:197], v3 offset:2048
    v_mfma_f32_16x16x32_bf16 v[164:167], v[180:183], a[212:215], v[164:167]
    v_exp_f32 v203, v203
    v_mfma_f32_16x16x32_bf16 v[168:171], v[180:183], a[216:219], v[168:171]
    ds_read_b64_tr_b16 v[198:199], v3 offset:2304
    v_mul_f32 v74, v58, v74
    v_mfma_f32_16x16x32_bf16 v[172:175], v[180:183], a[220:223], v[172:175]
    v_add_f32 v202, 1.0, v202
    s_waitcnt lgkmcnt(4)
    v_mfma_f32_16x16x32_bf16 v[112:115], v[184:187], a[224:227], v[112:115]
    ds_read_b64_tr_b16 v[176:177], v2 offset:4096
    v_add_f32 v203, 1.0, v203
    v_mfma_f32_16x16x32_bf16 v[116:119], v[184:187], a[228:231], v[116:119]
    s_add_u32 m0, s40, 41984
    s_add_u32 s48, s42, 1917056
    buffer_load_dwordx4 v6, s[12:15], s48 offen lds
    v_mfma_f32_16x16x32_bf16 v[120:123], v[184:187], a[232:235], v[120:123]
    ds_read_b64_tr_b16 v[178:179], v2 offset:4352
    v_mfma_f32_16x16x32_bf16 v[124:127], v[184:187], a[236:239], v[124:127]
    s_add_u32 m0, s54, 8192
    s_nop 0
    buffer_load_dwordx4 v224, s[24:27], s59 offen lds
    v_mfma_f32_16x16x32_bf16 v[128:131], v[188:191], a[224:227], v[128:131]
    ds_read_b64_tr_b16 v[180:181], v2 offset:6144
    v_mfma_f32_16x16x32_bf16 v[132:135], v[188:191], a[228:231], v[132:135]
    v_rcp_f32 v202, v202
    v_mfma_f32_16x16x32_bf16 v[136:139], v[188:191], a[232:235], v[136:139]
    ds_read_b64_tr_b16 v[182:183], v2 offset:6400
    v_mfma_f32_16x16x32_bf16 v[140:143], v[188:191], a[236:239], v[140:143]
    s_waitcnt lgkmcnt(4)
    v_mfma_f32_16x16x32_bf16 v[144:147], v[192:195], a[224:227], v[144:147]
    ds_read_b64_tr_b16 v[184:185], v3 offset:4096
    v_mfma_f32_16x16x32_bf16 v[148:151], v[192:195], a[228:231], v[148:151]
    v_rcp_f32 v203, v203
    v_mfma_f32_16x16x32_bf16 v[152:155], v[192:195], a[232:235], v[152:155]
    ds_read_b64_tr_b16 v[186:187], v3 offset:4352
    v_mul_f32 v75, v59, v75
    v_mfma_f32_16x16x32_bf16 v[156:159], v[192:195], a[236:239], v[156:159]
    v_mul_f32 v74, v74, v202
    v_mul_f32 v75, v75, v203
    v_mfma_f32_16x16x32_bf16 v[160:163], v[196:199], a[224:227], v[160:163]
    ds_read_b64_tr_b16 v[188:189], v3 offset:6144
    v_cvt_pk_bf16_f32 v209, v74, v75
    v_mfma_f32_16x16x32_bf16 v[164:167], v[196:199], a[228:231], v[164:167]
    s_add_u32 m0, s40, 49152
    s_add_u32 s48, s42, 2359424
    buffer_load_dwordx4 v6, s[12:15], s48 offen lds
    v_mfma_f32_16x16x32_bf16 v[168:171], v[196:199], a[232:235], v[168:171]
    ds_read_b64_tr_b16 v[190:191], v3 offset:6400
    v_mul_f32 v204, s47, v88
    v_mfma_f32_16x16x32_bf16 v[172:175], v[196:199], a[236:239], v[172:175]
    v_mul_f32 v205, s47, v89
    s_waitcnt lgkmcnt(4)
    v_mfma_f32_16x16x32_bf16 v[112:115], v[176:179], a[240:243], v[112:115]
    ds_read_b64_tr_b16 v[192:193], v2 offset:8192
    v_mfma_f32_16x16x32_bf16 v[116:119], v[176:179], a[244:247], v[116:119]
    v_exp_f32 v204, v204
    v_mfma_f32_16x16x32_bf16 v[120:123], v[176:179], a[248:251], v[120:123]
    ds_read_b64_tr_b16 v[194:195], v2 offset:8448
    v_mfma_f32_16x16x32_bf16 v[124:127], v[176:179], a[252:255], v[124:127]
    v_exp_f32 v205, v205
    v_mfma_f32_16x16x32_bf16 v[128:131], v[180:183], a[240:243], v[128:131]
    ds_read_b64_tr_b16 v[196:197], v2 offset:10240
    v_mul_f32 v104, v88, v104
    v_mfma_f32_16x16x32_bf16 v[132:135], v[180:183], a[244:247], v[132:135]
    v_add_f32 v204, 1.0, v204
    v_add_f32 v205, 1.0, v205
    v_mfma_f32_16x16x32_bf16 v[136:139], v[180:183], a[248:251], v[136:139]
    ds_read_b64_tr_b16 v[198:199], v2 offset:10496
    v_mfma_f32_16x16x32_bf16 v[140:143], v[180:183], a[252:255], v[140:143]
    s_waitcnt lgkmcnt(4)
    v_mfma_f32_16x16x32_bf16 v[144:147], v[184:187], a[240:243], v[144:147]
    ds_read_b64_tr_b16 v[176:177], v3 offset:8192
    v_mfma_f32_16x16x32_bf16 v[148:151], v[184:187], a[244:247], v[148:151]
    v_rcp_f32 v204, v204
    v_mfma_f32_16x16x32_bf16 v[152:155], v[184:187], a[248:251], v[152:155]
    ds_read_b64_tr_b16 v[178:179], v3 offset:8448
    v_mfma_f32_16x16x32_bf16 v[156:159], v[184:187], a[252:255], v[156:159]
    s_add_u32 m0, s40, 50176
    s_add_u32 s48, s42, 2506880
    buffer_load_dwordx4 v6, s[12:15], s48 offen lds
    v_mfma_f32_16x16x32_bf16 v[160:163], v[188:191], a[240:243], v[160:163]
    ds_read_b64_tr_b16 v[180:181], v3 offset:10240
    v_mfma_f32_16x16x32_bf16 v[164:167], v[188:191], a[244:247], v[164:167]
    v_rcp_f32 v205, v205
    v_mfma_f32_16x16x32_bf16 v[168:171], v[188:191], a[248:251], v[168:171]
    ds_read_b64_tr_b16 v[182:183], v3 offset:10496
    v_mul_f32 v105, v89, v105
    v_mfma_f32_16x16x32_bf16 v[172:175], v[188:191], a[252:255], v[172:175]
    v_mul_f32 v104, v104, v204
    s_waitcnt lgkmcnt(4)
    v_mfma_f32_16x16x32_bf16 v[112:115], v[192:195], v[16:19], v[112:115]
    ds_read_b64_tr_b16 v[184:185], v2 offset:12288
    v_mul_f32 v105, v105, v205
    v_mfma_f32_16x16x32_bf16 v[116:119], v[192:195], v[20:23], v[116:119]
    v_cvt_pk_bf16_f32 v210, v104, v105
    v_mul_f32 v206, s47, v90
    v_mfma_f32_16x16x32_bf16 v[120:123], v[192:195], v[24:27], v[120:123]
    ds_read_b64_tr_b16 v[186:187], v2 offset:12544
    v_mul_f32 v207, s47, v91
    v_mfma_f32_16x16x32_bf16 v[124:127], v[192:195], v[28:31], v[124:127]
    v_exp_f32 v206, v206
    v_mfma_f32_16x16x32_bf16 v[128:131], v[196:199], v[16:19], v[128:131]
    ds_read_b64_tr_b16 v[188:189], v2 offset:14336
    v_mfma_f32_16x16x32_bf16 v[132:135], v[196:199], v[20:23], v[132:135]
    v_exp_f32 v207, v207
    v_mfma_f32_16x16x32_bf16 v[136:139], v[196:199], v[24:27], v[136:139]
    ds_read_b64_tr_b16 v[190:191], v2 offset:14592
    v_mul_f32 v106, v90, v106
    v_mfma_f32_16x16x32_bf16 v[140:143], v[196:199], v[28:31], v[140:143]
    v_add_f32 v206, 1.0, v206
    s_waitcnt lgkmcnt(4)
    v_mfma_f32_16x16x32_bf16 v[144:147], v[176:179], v[16:19], v[144:147]
    ds_read_b64_tr_b16 v[192:193], v3 offset:12288
    v_add_f32 v207, 1.0, v207
    v_mfma_f32_16x16x32_bf16 v[148:151], v[176:179], v[20:23], v[148:151]
    v_rcp_f32 v206, v206
    v_mfma_f32_16x16x32_bf16 v[152:155], v[176:179], v[24:27], v[152:155]
    ds_read_b64_tr_b16 v[194:195], v3 offset:12544
    v_mfma_f32_16x16x32_bf16 v[156:159], v[176:179], v[28:31], v[156:159]
    v_rcp_f32 v207, v207
    v_mfma_f32_16x16x32_bf16 v[160:163], v[180:183], v[16:19], v[160:163]
    ds_read_b64_tr_b16 v[196:197], v3 offset:14336
    v_mul_f32 v107, v91, v107
    v_mfma_f32_16x16x32_bf16 v[164:167], v[180:183], v[20:23], v[164:167]
    v_mul_f32 v106, v106, v206
    v_mul_f32 v107, v107, v207
    v_mfma_f32_16x16x32_bf16 v[168:171], v[180:183], v[24:27], v[168:171]
    ds_read_b64_tr_b16 v[198:199], v3 offset:14592
    v_cvt_pk_bf16_f32 v211, v106, v107
    v_mfma_f32_16x16x32_bf16 v[172:175], v[180:183], v[28:31], v[172:175]
    s_waitcnt vmcnt(11)
    s_barrier
    s_waitcnt lgkmcnt(4)
    v_mfma_f32_16x16x32_bf16 v[112:115], v[184:187], v[32:35], v[112:115]
    ds_read_b64_tr_b16 v[176:177], v2 offset:16384
    s_add_u32 s49, s45, 36864
    v_mfma_f32_16x16x32_bf16 v[116:119], v[184:187], v[36:39], v[116:119]
    s_add_u32 m0, s40, 57344
    s_add_u32 s48, s42, 2949248
    buffer_load_dwordx4 v6, s[12:15], s48 offen lds
    v_mfma_f32_16x16x32_bf16 v[120:123], v[184:187], v[40:43], v[120:123]
    ds_read_b64_tr_b16 v[178:179], v2 offset:16640
    buffer_store_dwordx4 v[208:211], v1, s[20:23], s49 offen sc1
    v_mfma_f32_16x16x32_bf16 v[124:127], v[184:187], v[44:47], v[124:127]
    v_mul_f32 v200, s47, v60
    v_mul_f32 v201, s47, v61
    v_mfma_f32_16x16x32_bf16 v[128:131], v[188:191], v[32:35], v[128:131]
    ds_read_b64_tr_b16 v[180:181], v2 offset:18432
    v_mfma_f32_16x16x32_bf16 v[132:135], v[188:191], v[36:39], v[132:135]
    s_add_u32 m0, s40, 58368
    s_add_u32 s48, s42, 3096704
    buffer_load_dwordx4 v6, s[12:15], s48 offen lds
    v_mfma_f32_16x16x32_bf16 v[136:139], v[188:191], v[40:43], v[136:139]
    ds_read_b64_tr_b16 v[182:183], v2 offset:18688
    v_mfma_f32_16x16x32_bf16 v[140:143], v[188:191], v[44:47], v[140:143]
    s_waitcnt lgkmcnt(4)
    v_mfma_f32_16x16x32_bf16 v[144:147], v[192:195], v[32:35], v[144:147]
    ds_read_b64_tr_b16 v[184:185], v3 offset:16384
    v_mfma_f32_16x16x32_bf16 v[148:151], v[192:195], v[36:39], v[148:151]
    s_add_u32 m0, s40, 0
    s_add_u32 s48, s42, 3539072
    buffer_load_dwordx4 v6, s[12:15], s48 offen lds
    v_mfma_f32_16x16x32_bf16 v[152:155], v[192:195], v[40:43], v[152:155]
    ds_read_b64_tr_b16 v[186:187], v3 offset:16640
    v_mfma_f32_16x16x32_bf16 v[156:159], v[192:195], v[44:47], v[156:159]
    v_exp_f32 v200, v200
    v_mfma_f32_16x16x32_bf16 v[160:163], v[196:199], v[32:35], v[160:163]
    ds_read_b64_tr_b16 v[188:189], v3 offset:18432
    v_exp_f32 v201, v201
    v_mul_f32 v76, v60, v76
    v_mfma_f32_16x16x32_bf16 v[164:167], v[196:199], v[36:39], v[164:167]
    s_add_u32 m0, s40, 1024
    s_add_u32 s48, s42, 3686528
    buffer_load_dwordx4 v6, s[12:15], s48 offen lds
    v_add_f32 v200, 1.0, v200
    v_add_f32 v201, 1.0, v201
    v_rcp_f32 v200, v200
    v_rcp_f32 v201, v201
    v_mul_f32 v77, v61, v77
    v_mul_f32 v76, v76, v200
    v_mul_f32 v77, v77, v201
    v_cvt_pk_bf16_f32 v212, v76, v77
    v_mul_f32 v202, s47, v62
    v_mul_f32 v203, s47, v63
    v_exp_f32 v202, v202
    v_exp_f32 v203, v203
    v_mul_f32 v78, v62, v78
    v_add_f32 v202, 1.0, v202
    v_add_f32 v203, 1.0, v203
    v_rcp_f32 v202, v202
    v_rcp_f32 v203, v203
    v_mul_f32 v79, v63, v79
    v_mul_f32 v78, v78, v202
    v_mul_f32 v79, v79, v203
    v_cvt_pk_bf16_f32 v213, v78, v79
    v_mul_f32 v204, s47, v92
    v_mul_f32 v205, s47, v93
    v_exp_f32 v204, v204
    v_exp_f32 v205, v205
    v_mul_f32 v108, v92, v108
    v_add_f32 v204, 1.0, v204
    v_add_f32 v205, 1.0, v205
    v_rcp_f32 v204, v204
    v_rcp_f32 v205, v205
    v_mul_f32 v109, v93, v109
    v_mul_f32 v108, v108, v204
    v_mul_f32 v109, v109, v205
    v_cvt_pk_bf16_f32 v214, v108, v109
    v_mul_f32 v206, s47, v94
    v_mul_f32 v207, s47, v95
    v_exp_f32 v206, v206
    v_exp_f32 v207, v207
    v_mul_f32 v110, v94, v110
    v_add_f32 v206, 1.0, v206
    v_add_f32 v207, 1.0, v207
    v_rcp_f32 v206, v206
    v_rcp_f32 v207, v207
    v_mul_f32 v111, v95, v111
    v_mul_f32 v110, v110, v206
    v_mul_f32 v111, v111, v207
    v_cvt_pk_bf16_f32 v215, v110, v111
    s_add_u32 s49, s45, 55296
    buffer_store_dwordx4 v[212:215], v1, s[20:23], s49 offen sc1
    v_mfma_f32_16x16x32_bf16 v[168:171], v[196:199], v[40:43], v[168:171]
    ds_read_b64_tr_b16 v[190:191], v3 offset:18688
    v_mfma_f32_16x16x32_bf16 v[172:175], v[196:199], v[44:47], v[172:175]
    s_waitcnt lgkmcnt(4)
    v_mfma_f32_16x16x32_bf16 v[48:51], v[176:179], a[0:3], 0
    ds_read_b64_tr_b16 v[192:193], v2 offset:20480
    v_mfma_f32_16x16x32_bf16 v[52:55], v[176:179], a[4:7], 0
    v_mfma_f32_16x16x32_bf16 v[56:59], v[176:179], a[8:11], 0
    ds_read_b64_tr_b16 v[194:195], v2 offset:20736
    v_mul_f32 v200, s47, v112
    v_mfma_f32_16x16x32_bf16 v[60:63], v[176:179], a[12:15], 0
    v_mul_f32 v201, s47, v113
    v_mfma_f32_16x16x32_bf16 v[64:67], v[180:183], a[0:3], 0
    ds_read_b64_tr_b16 v[196:197], v2 offset:22528
    v_mfma_f32_16x16x32_bf16 v[68:71], v[180:183], a[4:7], 0
    v_exp_f32 v200, v200
    v_mfma_f32_16x16x32_bf16 v[72:75], v[180:183], a[8:11], 0
    ds_read_b64_tr_b16 v[198:199], v2 offset:22784
    v_mfma_f32_16x16x32_bf16 v[76:79], v[180:183], a[12:15], 0
    s_waitcnt lgkmcnt(4)
    v_mfma_f32_16x16x32_bf16 v[80:83], v[184:187], a[0:3], 0
    ds_read_b64_tr_b16 v[176:177], v3 offset:20480
    v_mfma_f32_16x16x32_bf16 v[84:87], v[184:187], a[4:7], 0
    s_mov_b32 s59, 184320
    s_cmp_lt_u32 s3, 2
    s_cselect_b32 s59, s59, 221184
    s_add_u32 s59, s59, s46
    v_mfma_f32_16x16x32_bf16 v[88:91], v[184:187], a[8:11], 0
    ds_read_b64_tr_b16 v[178:179], v3 offset:20736
    v_mfma_f32_16x16x32_bf16 v[92:95], v[184:187], a[12:15], 0
    v_exp_f32 v201, v201
    v_mfma_f32_16x16x32_bf16 v[96:99], v[188:191], a[0:3], 0
    ds_read_b64_tr_b16 v[180:181], v3 offset:22528
    v_mul_f32 v128, v112, v128
    v_mfma_f32_16x16x32_bf16 v[100:103], v[188:191], a[4:7], 0
    v_add_f32 v200, 1.0, v200
    v_add_f32 v201, 1.0, v201
    v_mfma_f32_16x16x32_bf16 v[104:107], v[188:191], a[8:11], 0
    ds_read_b64_tr_b16 v[182:183], v3 offset:22784
    v_mfma_f32_16x16x32_bf16 v[108:111], v[188:191], a[12:15], 0
    s_waitcnt lgkmcnt(4)
    v_mfma_f32_16x16x32_bf16 v[48:51], v[192:195], a[16:19], v[48:51]
    ds_read_b64_tr_b16 v[184:185], v2 offset:24576
    v_mfma_f32_16x16x32_bf16 v[52:55], v[192:195], a[20:23], v[52:55]
    v_rcp_f32 v200, v200
    v_mfma_f32_16x16x32_bf16 v[56:59], v[192:195], a[24:27], v[56:59]
    ds_read_b64_tr_b16 v[186:187], v2 offset:24832
    v_mfma_f32_16x16x32_bf16 v[60:63], v[192:195], a[28:31], v[60:63]
    v_rcp_f32 v201, v201
    v_mfma_f32_16x16x32_bf16 v[64:67], v[196:199], a[16:19], v[64:67]
    ds_read_b64_tr_b16 v[188:189], v2 offset:26624
    v_mul_f32 v129, v113, v129
    v_mfma_f32_16x16x32_bf16 v[68:71], v[196:199], a[20:23], v[68:71]
    v_mul_f32 v128, v128, v200
    v_mul_f32 v129, v129, v201
    v_mfma_f32_16x16x32_bf16 v[72:75], v[196:199], a[24:27], v[72:75]
    ds_read_b64_tr_b16 v[190:191], v2 offset:26880
    v_cvt_pk_bf16_f32 v208, v128, v129
    v_mfma_f32_16x16x32_bf16 v[76:79], v[196:199], a[28:31], v[76:79]
    v_mul_f32 v202, s47, v114
    s_waitcnt lgkmcnt(4)
    v_mfma_f32_16x16x32_bf16 v[80:83], v[176:179], a[16:19], v[80:83]
    ds_read_b64_tr_b16 v[192:193], v3 offset:24576
    v_mul_f32 v203, s47, v115
    v_mfma_f32_16x16x32_bf16 v[84:87], v[176:179], a[20:23], v[84:87]
    v_exp_f32 v202, v202
    v_mfma_f32_16x16x32_bf16 v[88:91], v[176:179], a[24:27], v[88:91]
    ds_read_b64_tr_b16 v[194:195], v3 offset:24832
    v_mfma_f32_16x16x32_bf16 v[92:95], v[176:179], a[28:31], v[92:95]
    v_exp_f32 v203, v203
    v_mfma_f32_16x16x32_bf16 v[96:99], v[180:183], a[16:19], v[96:99]
    ds_read_b64_tr_b16 v[196:197], v3 offset:26624
    v_mul_f32 v130, v114, v130
    v_mfma_f32_16x16x32_bf16 v[100:103], v[180:183], a[20:23], v[100:103]
    v_add_f32 v202, 1.0, v202
    v_add_f32 v203, 1.0, v203
    v_mfma_f32_16x16x32_bf16 v[104:107], v[180:183], a[24:27], v[104:107]
    ds_read_b64_tr_b16 v[198:199], v3 offset:26880
    v_mfma_f32_16x16x32_bf16 v[108:111], v[180:183], a[28:31], v[108:111]
    s_waitcnt lgkmcnt(4)
    v_mfma_f32_16x16x32_bf16 v[48:51], v[184:187], a[32:35], v[48:51]
    ds_read_b64_tr_b16 v[176:177], v2 offset:28672
    v_mfma_f32_16x16x32_bf16 v[52:55], v[184:187], a[36:39], v[52:55]
    s_add_u32 m0, s55, 0
    s_nop 0
    buffer_load_dwordx4 v216, s[24:27], s59 offen lds
    v_mfma_f32_16x16x32_bf16 v[56:59], v[184:187], a[40:43], v[56:59]
    ds_read_b64_tr_b16 v[178:179], v2 offset:28928
    v_mfma_f32_16x16x32_bf16 v[60:63], v[184:187], a[44:47], v[60:63]
    v_rcp_f32 v202, v202
    v_mfma_f32_16x16x32_bf16 v[64:67], v[188:191], a[32:35], v[64:67]
    ds_read_b64_tr_b16 v[180:181], v2 offset:30720
    v_mfma_f32_16x16x32_bf16 v[68:71], v[188:191], a[36:39], v[68:71]
    v_rcp_f32 v203, v203
    v_mfma_f32_16x16x32_bf16 v[72:75], v[188:191], a[40:43], v[72:75]
    ds_read_b64_tr_b16 v[182:183], v2 offset:30976
    v_mul_f32 v131, v115, v131
    v_mfma_f32_16x16x32_bf16 v[76:79], v[188:191], a[44:47], v[76:79]
    v_mul_f32 v130, v130, v202
    s_waitcnt lgkmcnt(4)
    v_mfma_f32_16x16x32_bf16 v[80:83], v[192:195], a[32:35], v[80:83]
    ds_read_b64_tr_b16 v[184:185], v3 offset:28672
    v_mul_f32 v131, v131, v203
    v_mfma_f32_16x16x32_bf16 v[84:87], v[192:195], a[36:39], v[84:87]
    v_cvt_pk_bf16_f32 v209, v130, v131
    v_mul_f32 v204, s47, v144
    v_mfma_f32_16x16x32_bf16 v[88:91], v[192:195], a[40:43], v[88:91]
    ds_read_b64_tr_b16 v[186:187], v3 offset:28928
    v_mul_f32 v205, s47, v145
    v_mfma_f32_16x16x32_bf16 v[92:95], v[192:195], a[44:47], v[92:95]
    v_exp_f32 v204, v204
    v_mfma_f32_16x16x32_bf16 v[96:99], v[196:199], a[32:35], v[96:99]
    ds_read_b64_tr_b16 v[188:189], v3 offset:30720
    v_mfma_f32_16x16x32_bf16 v[100:103], v[196:199], a[36:39], v[100:103]
    v_exp_f32 v205, v205
    v_mfma_f32_16x16x32_bf16 v[104:107], v[196:199], a[40:43], v[104:107]
    ds_read_b64_tr_b16 v[190:191], v3 offset:30976
    v_mul_f32 v160, v144, v160
    v_mfma_f32_16x16x32_bf16 v[108:111], v[196:199], a[44:47], v[108:111]
    s_waitcnt vmcnt(10)
    s_barrier
    s_waitcnt lgkmcnt(4)
    v_mfma_f32_16x16x32_bf16 v[48:51], v[176:179], a[48:51], v[48:51]
    ds_read_b64_tr_b16 v[192:193], v2 offset:32768
    v_add_f32 v204, 1.0, v204
    v_mfma_f32_16x16x32_bf16 v[52:55], v[176:179], a[52:55], v[52:55]
    s_add_u32 m0, s40, 8192
    s_add_u32 s48, s42, 4128896
    buffer_load_dwordx4 v6, s[12:15], s48 offen lds
    v_mfma_f32_16x16x32_bf16 v[56:59], v[176:179], a[56:59], v[56:59]
    ds_read_b64_tr_b16 v[194:195], v2 offset:33024
    v_add_f32 v205, 1.0, v205
    v_mfma_f32_16x16x32_bf16 v[60:63], v[176:179], a[60:63], v[60:63]
    v_rcp_f32 v204, v204
    v_mfma_f32_16x16x32_bf16 v[64:67], v[180:183], a[48:51], v[64:67]
    ds_read_b64_tr_b16 v[196:197], v2 offset:34816
    v_mfma_f32_16x16x32_bf16 v[68:71], v[180:183], a[52:55], v[68:71]
    v_rcp_f32 v205, v205
    v_mfma_f32_16x16x32_bf16 v[72:75], v[180:183], a[56:59], v[72:75]
    ds_read_b64_tr_b16 v[198:199], v2 offset:35072
    v_mul_f32 v161, v145, v161
    v_mfma_f32_16x16x32_bf16 v[76:79], v[180:183], a[60:63], v[76:79]
    v_mul_f32 v160, v160, v204
    s_waitcnt lgkmcnt(4)
    v_mfma_f32_16x16x32_bf16 v[80:83], v[184:187], a[48:51], v[80:83]
    ds_read_b64_tr_b16 v[176:177], v3 offset:32768
    v_mul_f32 v161, v161, v205
    v_mfma_f32_16x16x32_bf16 v[84:87], v[184:187], a[52:55], v[84:87]
    s_add_u32 m0, s55, 1024
    s_nop 0
    buffer_load_dwordx4 v217, s[24:27], s59 offen lds
    v_mfma_f32_16x16x32_bf16 v[88:91], v[184:187], a[56:59], v[88:91]
    ds_read_b64_tr_b16 v[178:179], v3 offset:33024
    v_cvt_pk_bf16_f32 v210, v160, v161
    v_mfma_f32_16x16x32_bf16 v[92:95], v[184:187], a[60:63], v[92:95]
    v_mul_f32 v206, s47, v146
    v_mul_f32 v207, s47, v147
    v_mfma_f32_16x16x32_bf16 v[96:99], v[188:191], a[48:51], v[96:99]
    ds_read_b64_tr_b16 v[180:181], v3 offset:34816
    v_mfma_f32_16x16x32_bf16 v[100:103], v[188:191], a[52:55], v[100:103]
    v_exp_f32 v206, v206
    v_mfma_f32_16x16x32_bf16 v[104:107], v[188:191], a[56:59], v[104:107]
    ds_read_b64_tr_b16 v[182:183], v3 offset:35072
    v_mfma_f32_16x16x32_bf16 v[108:111], v[188:191], a[60:63], v[108:111]
    s_waitcnt lgkmcnt(4)
    v_mfma_f32_16x16x32_bf16 v[48:51], v[192:195], a[64:67], v[48:51]
    ds_read_b64_tr_b16 v[184:185], v2 offset:36864
    v_mfma_f32_16x16x32_bf16 v[52:55], v[192:195], a[68:71], v[52:55]
    s_add_u32 m0, s40, 9216
    s_add_u32 s48, s42, 4276352
    buffer_load_dwordx4 v6, s[12:15], s48 offen lds
    v_mfma_f32_16x16x32_bf16 v[56:59], v[192:195], a[72:75], v[56:59]
    ds_read_b64_tr_b16 v[186:187], v2 offset:37120
    v_mfma_f32_16x16x32_bf16 v[60:63], v[192:195], a[76:79], v[60:63]
    v_exp_f32 v207, v207
    v_mfma_f32_16x16x32_bf16 v[64:67], v[196:199], a[64:67], v[64:67]
    ds_read_b64_tr_b16 v[188:189], v2 offset:38912
    v_mul_f32 v162, v146, v162
    v_mfma_f32_16x16x32_bf16 v[68:71], v[196:199], a[68:71], v[68:71]
    v_add_f32 v206, 1.0, v206
    v_add_f32 v207, 1.0, v207
    v_mfma_f32_16x16x32_bf16 v[72:75], v[196:199], a[72:75], v[72:75]
    ds_read_b64_tr_b16 v[190:191], v2 offset:39168
    v_mfma_f32_16x16x32_bf16 v[76:79], v[196:199], a[76:79], v[76:79]
    s_waitcnt lgkmcnt(4)
    v_mfma_f32_16x16x32_bf16 v[80:83], v[176:179], a[64:67], v[80:83]
    ds_read_b64_tr_b16 v[192:193], v3 offset:36864
    v_mfma_f32_16x16x32_bf16 v[84:87], v[176:179], a[68:71], v[84:87]
    v_rcp_f32 v206, v206
    v_mfma_f32_16x16x32_bf16 v[88:91], v[176:179], a[72:75], v[88:91]
    ds_read_b64_tr_b16 v[194:195], v3 offset:37120
    v_mfma_f32_16x16x32_bf16 v[92:95], v[176:179], a[76:79], v[92:95]
    v_rcp_f32 v207, v207
    v_mfma_f32_16x16x32_bf16 v[96:99], v[180:183], a[64:67], v[96:99]
    ds_read_b64_tr_b16 v[196:197], v3 offset:38912
    v_mul_f32 v163, v147, v163
    v_mfma_f32_16x16x32_bf16 v[100:103], v[180:183], a[68:71], v[100:103]
    s_add_u32 m0, s40, 16384
    s_add_u32 s48, s42, 4718720
    buffer_load_dwordx4 v6, s[12:15], s48 offen lds
    v_mfma_f32_16x16x32_bf16 v[104:107], v[180:183], a[72:75], v[104:107]
    ds_read_b64_tr_b16 v[198:199], v3 offset:39168
    v_mul_f32 v162, v162, v206
    v_mfma_f32_16x16x32_bf16 v[108:111], v[180:183], a[76:79], v[108:111]
    v_mul_f32 v163, v163, v207
    s_waitcnt lgkmcnt(4)
    v_mfma_f32_16x16x32_bf16 v[48:51], v[184:187], a[80:83], v[48:51]
    ds_read_b64_tr_b16 v[176:177], v2 offset:40960
    v_cvt_pk_bf16_f32 v211, v162, v163
    v_mfma_f32_16x16x32_bf16 v[52:55], v[184:187], a[84:87], v[52:55]
    s_add_u32 m0, s55, 2048
    s_nop 0
    buffer_load_dwordx4 v218, s[24:27], s59 offen lds
    v_mfma_f32_16x16x32_bf16 v[56:59], v[184:187], a[88:91], v[56:59]
    ds_read_b64_tr_b16 v[178:179], v2 offset:41216
    s_add_u32 s49, s45, 1024
    v_mfma_f32_16x16x32_bf16 v[60:63], v[184:187], a[92:95], v[60:63]
    buffer_store_dwordx4 v[208:211], v1, s[20:23], s49 offen sc1
    v_mul_f32 v200, s47, v116
    v_mfma_f32_16x16x32_bf16 v[64:67], v[188:191], a[80:83], v[64:67]
    ds_read_b64_tr_b16 v[180:181], v2 offset:43008
    v_mul_f32 v201, s47, v117
    v_mfma_f32_16x16x32_bf16 v[68:71], v[188:191], a[84:87], v[68:71]
    v_exp_f32 v200, v200
    v_mfma_f32_16x16x32_bf16 v[72:75], v[188:191], a[88:91], v[72:75]
    ds_read_b64_tr_b16 v[182:183], v2 offset:43264
    v_mfma_f32_16x16x32_bf16 v[76:79], v[188:191], a[92:95], v[76:79]
    s_waitcnt lgkmcnt(4)
    v_mfma_f32_16x16x32_bf16 v[80:83], v[192:195], a[80:83], v[80:83]
    ds_read_b64_tr_b16 v[184:185], v3 offset:40960
    v_mfma_f32_16x16x32_bf16 v[84:87], v[192:195], a[84:87], v[84:87]
    v_exp_f32 v201, v201
    v_mfma_f32_16x16x32_bf16 v[88:91], v[192:195], a[88:91], v[88:91]
    ds_read_b64_tr_b16 v[186:187], v3 offset:41216
    v_mul_f32 v132, v116, v132
    v_mfma_f32_16x16x32_bf16 v[92:95], v[192:195], a[92:95], v[92:95]
    s_add_u32 m0, s40, 17408
    s_add_u32 s48, s42, 4866176
    buffer_load_dwordx4 v6, s[12:15], s48 offen lds
    v_mfma_f32_16x16x32_bf16 v[96:99], v[196:199], a[80:83], v[96:99]
    ds_read_b64_tr_b16 v[188:189], v3 offset:43008
    v_add_f32 v200, 1.0, v200
    v_mfma_f32_16x16x32_bf16 v[100:103], v[196:199], a[84:87], v[100:103]
    v_add_f32 v201, 1.0, v201
    v_mfma_f32_16x16x32_bf16 v[104:107], v[196:199], a[88:91], v[104:107]
    ds_read_b64_tr_b16 v[190:191], v3 offset:43264
    v_mfma_f32_16x16x32_bf16 v[108:111], v[196:199], a[92:95], v[108:111]
    s_waitcnt lgkmcnt(4)
    v_mfma_f32_16x16x32_bf16 v[48:51], v[176:179], a[96:99], v[48:51]
    ds_read_b64_tr_b16 v[192:193], v2 offset:45056
    v_mfma_f32_16x16x32_bf16 v[52:55], v[176:179], a[100:103], v[52:55]
    v_rcp_f32 v200, v200
    v_mfma_f32_16x16x32_bf16 v[56:59], v[176:179], a[104:107], v[56:59]
    ds_read_b64_tr_b16 v[194:195], v2 offset:45312
    v_mfma_f32_16x16x32_bf16 v[60:63], v[176:179], a[108:111], v[60:63]
    v_rcp_f32 v201, v201
    v_mfma_f32_16x16x32_bf16 v[64:67], v[180:183], a[96:99], v[64:67]
    ds_read_b64_tr_b16 v[196:197], v2 offset:47104
    v_mul_f32 v133, v117, v133
    v_mfma_f32_16x16x32_bf16 v[68:71], v[180:183], a[100:103], v[68:71]
    v_mul_f32 v132, v132, v200
    v_mul_f32 v133, v133, v201
    v_mfma_f32_16x16x32_bf16 v[72:75], v[180:183], a[104:107], v[72:75]
    ds_read_b64_tr_b16 v[198:199], v2 offset:47360
    v_cvt_pk_bf16_f32 v212, v132, v133
    v_mfma_f32_16x16x32_bf16 v[76:79], v[180:183], a[108:111], v[76:79]
    v_mul_f32 v202, s47, v118
    s_waitcnt lgkmcnt(4)
    v_mfma_f32_16x16x32_bf16 v[80:83], v[184:187], a[96:99], v[80:83]
    ds_read_b64_tr_b16 v[176:177], v3 offset:45056
    v_mul_f32 v203, s47, v119
    v_mfma_f32_16x16x32_bf16 v[84:87], v[184:187], a[100:103], v[84:87]
    s_add_u32 m0, s55, 3072
    s_nop 0
    buffer_load_dwordx4 v219, s[24:27], s59 offen lds
    v_mfma_f32_16x16x32_bf16 v[88:91], v[184:187], a[104:107], v[88:91]
    ds_read_b64_tr_b16 v[178:179], v3 offset:45312
    v_mfma_f32_16x16x32_bf16 v[92:95], v[184:187], a[108:111], v[92:95]
    v_exp_f32 v202, v202
    v_mfma_f32_16x16x32_bf16 v[96:99], v[188:191], a[96:99], v[96:99]
    ds_read_b64_tr_b16 v[180:181], v3 offset:47104
    v_mfma_f32_16x16x32_bf16 v[100:103], v[188:191], a[100:103], v[100:103]
    v_exp_f32 v203, v203
    v_mfma_f32_16x16x32_bf16 v[104:107], v[188:191], a[104:107], v[104:107]
    ds_read_b64_tr_b16 v[182:183], v3 offset:47360
    v_mul_f32 v134, v118, v134
    v_mfma_f32_16x16x32_bf16 v[108:111], v[188:191], a[108:111], v[108:111]
    s_waitcnt vmcnt(12)
    s_barrier
    s_waitcnt lgkmcnt(4)
    v_mfma_f32_16x16x32_bf16 v[48:51], v[192:195], a[112:115], v[48:51]
    ds_read_b64_tr_b16 v[184:185], v2 offset:49152
    v_add_f32 v202, 1.0, v202
    v_mfma_f32_16x16x32_bf16 v[52:55], v[192:195], a[116:119], v[52:55]
    s_add_u32 m0, s40, 24576
    s_add_u32 s48, s42, 192
    buffer_load_dwordx4 v6, s[12:15], s48 offen lds
    v_mfma_f32_16x16x32_bf16 v[56:59], v[192:195], a[120:123], v[56:59]
    ds_read_b64_tr_b16 v[186:187], v2 offset:49408
    v_add_f32 v203, 1.0, v203
    v_mfma_f32_16x16x32_bf16 v[60:63], v[192:195], a[124:127], v[60:63]
    v_rcp_f32 v202, v202
    v_mfma_f32_16x16x32_bf16 v[64:67], v[196:199], a[112:115], v[64:67]
    ds_read_b64_tr_b16 v[188:189], v2 offset:51200
    v_mfma_f32_16x16x32_bf16 v[68:71], v[196:199], a[116:119], v[68:71]
    v_rcp_f32 v203, v203
    v_mfma_f32_16x16x32_bf16 v[72:75], v[196:199], a[120:123], v[72:75]
    ds_read_b64_tr_b16 v[190:191], v2 offset:51456
    v_mul_f32 v135, v119, v135
    v_mfma_f32_16x16x32_bf16 v[76:79], v[196:199], a[124:127], v[76:79]
    v_mul_f32 v134, v134, v202
    s_waitcnt lgkmcnt(4)
    v_mfma_f32_16x16x32_bf16 v[80:83], v[176:179], a[112:115], v[80:83]
    ds_read_b64_tr_b16 v[192:193], v3 offset:49152
    v_mul_f32 v135, v135, v203
    v_mfma_f32_16x16x32_bf16 v[84:87], v[176:179], a[116:119], v[84:87]
    v_cvt_pk_bf16_f32 v213, v134, v135
    v_mul_f32 v204, s47, v148
    v_mfma_f32_16x16x32_bf16 v[88:91], v[176:179], a[120:123], v[88:91]
    ds_read_b64_tr_b16 v[194:195], v3 offset:49408
    v_mul_f32 v205, s47, v149
    v_mfma_f32_16x16x32_bf16 v[92:95], v[176:179], a[124:127], v[92:95]
    v_exp_f32 v204, v204
    v_mfma_f32_16x16x32_bf16 v[96:99], v[180:183], a[112:115], v[96:99]
    ds_read_b64_tr_b16 v[196:197], v3 offset:51200
    v_mfma_f32_16x16x32_bf16 v[100:103], v[180:183], a[116:119], v[100:103]
    v_exp_f32 v205, v205
    v_mfma_f32_16x16x32_bf16 v[104:107], v[180:183], a[120:123], v[104:107]
    ds_read_b64_tr_b16 v[198:199], v3 offset:51456
    v_mul_f32 v164, v148, v164
    v_mfma_f32_16x16x32_bf16 v[108:111], v[180:183], a[124:127], v[108:111]
    v_add_f32 v204, 1.0, v204
    s_waitcnt lgkmcnt(4)
    v_mfma_f32_16x16x32_bf16 v[48:51], v[184:187], a[128:131], v[48:51]
    ds_read_b64_tr_b16 v[176:177], v2 offset:53248
    v_add_f32 v205, 1.0, v205
    v_mfma_f32_16x16x32_bf16 v[52:55], v[184:187], a[132:135], v[52:55]
    s_add_u32 m0, s40, 25600
    s_add_u32 s48, s42, 147648
    buffer_load_dwordx4 v6, s[12:15], s48 offen lds
    v_mfma_f32_16x16x32_bf16 v[56:59], v[184:187], a[136:139], v[56:59]
    ds_read_b64_tr_b16 v[178:179], v2 offset:53504
    v_mfma_f32_16x16x32_bf16 v[60:63], v[184:187], a[140:143], v[60:63]
    s_add_u32 m0, s55, 4096
    s_nop 0
    buffer_load_dwordx4 v220, s[24:27], s59 offen lds
    v_mfma_f32_16x16x32_bf16 v[64:67], v[188:191], a[128:131], v[64:67]
    ds_read_b64_tr_b16 v[180:181], v2 offset:55296
    v_mfma_f32_16x16x32_bf16 v[68:71], v[188:191], a[132:135], v[68:71]
    v_rcp_f32 v204, v204
    v_mfma_f32_16x16x32_bf16 v[72:75], v[188:191], a[136:139], v[72:75]
    ds_read_b64_tr_b16 v[182:183], v2 offset:55552
    v_mfma_f32_16x16x32_bf16 v[76:79], v[188:191], a[140:143], v[76:79]
    s_waitcnt lgkmcnt(4)
    v_mfma_f32_16x16x32_bf16 v[80:83], v[192:195], a[128:131], v[80:83]
    ds_read_b64_tr_b16 v[184:185], v3 offset:53248
    v_mfma_f32_16x16x32_bf16 v[84:87], v[192:195], a[132:135], v[84:87]
    v_rcp_f32 v205, v205
    v_mfma_f32_16x16x32_bf16 v[88:91], v[192:195], a[136:139], v[88:91]
    ds_read_b64_tr_b16 v[186:187], v3 offset:53504
    v_mul_f32 v165, v149, v165
    v_mfma_f32_16x16x32_bf16 v[92:95], v[192:195], a[140:143], v[92:95]
    v_mul_f32 v164, v164, v204
    v_mul_f32 v165, v165, v205
    v_mfma_f32_16x16x32_bf16 v[96:99], v[196:199], a[128:131], v[96:99]
    ds_read_b64_tr_b16 v[188:189], v3 offset:55296
    v_cvt_pk_bf16_f32 v214, v164, v165
    v_mfma_f32_16x16x32_bf16 v[100:103], v[196:199], a[132:135], v[100:103]
    s_add_u32 m0, s40, 32768
    s_add_u32 s48, s42, 590016
    buffer_load_dwordx4 v6, s[12:15], s48 offen lds
    v_mfma_f32_16x16x32_bf16 v[104:107], v[196:199], a[136:139], v[104:107]
    ds_read_b64_tr_b16 v[190:191], v3 offset:55552
    v_mul_f32 v206, s47, v150
    v_mfma_f32_16x16x32_bf16 v[108:111], v[196:199], a[140:143], v[108:111]
    v_mul_f32 v207, s47, v151
    s_waitcnt lgkmcnt(4)
    v_mfma_f32_16x16x32_bf16 v[48:51], v[176:179], a[144:147], v[48:51]
    ds_read_b64_tr_b16 v[192:193], v2 offset:57344
    v_mfma_f32_16x16x32_bf16 v[52:55], v[176:179], a[148:151], v[52:55]
    v_exp_f32 v206, v206
    v_mfma_f32_16x16x32_bf16 v[56:59], v[176:179], a[152:155], v[56:59]
    ds_read_b64_tr_b16 v[194:195], v2 offset:57600
    v_mfma_f32_16x16x32_bf16 v[60:63], v[176:179], a[156:159], v[60:63]
    v_exp_f32 v207, v207
    v_mfma_f32_16x16x32_bf16 v[64:67], v[180:183], a[144:147], v[64:67]
    ds_read_b64_tr_b16 v[196:197], v2 offset:59392
    v_mul_f32 v166, v150, v166
    v_mfma_f32_16x16x32_bf16 v[68:71], v[180:183], a[148:151], v[68:71]
    v_add_f32 v206, 1.0, v206
    v_add_f32 v207, 1.0, v207
    v_mfma_f32_16x16x32_bf16 v[72:75], v[180:183], a[152:155], v[72:75]
    ds_read_b64_tr_b16 v[198:199], v2 offset:59648
    v_mfma_f32_16x16x32_bf16 v[76:79], v[180:183], a[156:159], v[76:79]
    s_waitcnt lgkmcnt(4)
    v_mfma_f32_16x16x32_bf16 v[80:83], v[184:187], a[144:147], v[80:83]
    ds_read_b64_tr_b16 v[176:177], v3 offset:57344
    v_mfma_f32_16x16x32_bf16 v[84:87], v[184:187], a[148:151], v[84:87]
    s_add_u32 m0, s55, 5120
    s_nop 0
    buffer_load_dwordx4 v221, s[24:27], s59 offen lds
    v_mfma_f32_16x16x32_bf16 v[88:91], v[184:187], a[152:155], v[88:91]
    ds_read_b64_tr_b16 v[178:179], v3 offset:57600
    v_mfma_f32_16x16x32_bf16 v[92:95], v[184:187], a[156:159], v[92:95]
    s_add_u32 m0, s40, 33792
    s_add_u32 s48, s42, 737472
    buffer_load_dwordx4 v6, s[12:15], s48 offen lds
    v_mfma_f32_16x16x32_bf16 v[96:99], v[188:191], a[144:147], v[96:99]
    ds_read_b64_tr_b16 v[180:181], v3 offset:59392
    v_mfma_f32_16x16x32_bf16 v[100:103], v[188:191], a[148:151], v[100:103]
    v_rcp_f32 v206, v206
    v_mfma_f32_16x16x32_bf16 v[104:107], v[188:191], a[152:155], v[104:107]
    ds_read_b64_tr_b16 v[182:183], v3 offset:59648
    v_mfma_f32_16x16x32_bf16 v[108:111], v[188:191], a[156:159], v[108:111]
    s_waitcnt lgkmcnt(4)
    v_mfma_f32_16x16x32_bf16 v[48:51], v[192:195], a[160:163], v[48:51]
    ds_read_b64_tr_b16 v[184:185], v2 offset:61440
    v_mfma_f32_16x16x32_bf16 v[52:55], v[192:195], a[164:167], v[52:55]
    v_rcp_f32 v207, v207
    v_mfma_f32_16x16x32_bf16 v[56:59], v[192:195], a[168:171], v[56:59]
    ds_read_b64_tr_b16 v[186:187], v2 offset:61696
    v_mul_f32 v167, v151, v167
    v_mfma_f32_16x16x32_bf16 v[60:63], v[192:195], a[172:175], v[60:63]
    v_mul_f32 v166, v166, v206
    v_mul_f32 v167, v167, v207
    v_mfma_f32_16x16x32_bf16 v[64:67], v[196:199], a[160:163], v[64:67]
    ds_read_b64_tr_b16 v[188:189], v2 offset:63488
    v_cvt_pk_bf16_f32 v215, v166, v167
    v_mfma_f32_16x16x32_bf16 v[68:71], v[196:199], a[164:167], v[68:71]
    s_add_u32 s49, s45, 19456
    buffer_store_dwordx4 v[212:215], v1, s[20:23], s49 offen sc1
    v_mfma_f32_16x16x32_bf16 v[72:75], v[196:199], a[168:171], v[72:75]
    ds_read_b64_tr_b16 v[190:191], v2 offset:63744
    v_mul_f32 v200, s47, v120
    v_mfma_f32_16x16x32_bf16 v[76:79], v[196:199], a[172:175], v[76:79]
    v_mul_f32 v201, s47, v121
    s_waitcnt lgkmcnt(4)
    v_mfma_f32_16x16x32_bf16 v[80:83], v[176:179], a[160:163], v[80:83]
    ds_read_b64_tr_b16 v[192:193], v3 offset:61440
    v_mfma_f32_16x16x32_bf16 v[84:87], v[176:179], a[164:167], v[84:87]
    v_exp_f32 v200, v200
    v_mfma_f32_16x16x32_bf16 v[88:91], v[176:179], a[168:171], v[88:91]
    ds_read_b64_tr_b16 v[194:195], v3 offset:61696
    v_mfma_f32_16x16x32_bf16 v[92:95], v[176:179], a[172:175], v[92:95]
    v_exp_f32 v201, v201
    v_mfma_f32_16x16x32_bf16 v[96:99], v[180:183], a[160:163], v[96:99]
    ds_read_b64_tr_b16 v[196:197], v3 offset:63488
    v_mul_f32 v136, v120, v136
    v_mfma_f32_16x16x32_bf16 v[100:103], v[180:183], a[164:167], v[100:103]
    v_add_f32 v200, 1.0, v200
    v_add_f32 v201, 1.0, v201
    v_mfma_f32_16x16x32_bf16 v[104:107], v[180:183], a[168:171], v[104:107]
    ds_read_b64_tr_b16 v[198:199], v3 offset:63744
    v_mfma_f32_16x16x32_bf16 v[108:111], v[180:183], a[172:175], v[108:111]
    s_waitcnt vmcnt(12)
    s_barrier
    s_waitcnt lgkmcnt(4)
    v_mfma_f32_16x16x32_bf16 v[48:51], v[184:187], a[176:179], v[48:51]
    ds_read_b64_tr_b16 v[176:177], v2 offset:0
    v_mfma_f32_16x16x32_bf16 v[52:55], v[184:187], a[180:183], v[52:55]
    s_add_u32 m0, s40, 40960
    s_add_u32 s48, s42, 1179840
    buffer_load_dwordx4 v6, s[12:15], s48 offen lds
    v_mfma_f32_16x16x32_bf16 v[56:59], v[184:187], a[184:187], v[56:59]
    ds_read_b64_tr_b16 v[178:179], v2 offset:256
    v_mfma_f32_16x16x32_bf16 v[60:63], v[184:187], a[188:191], v[60:63]
    s_add_u32 m0, s55, 6144
    s_nop 0
    buffer_load_dwordx4 v222, s[24:27], s59 offen lds
    v_mfma_f32_16x16x32_bf16 v[64:67], v[188:191], a[176:179], v[64:67]
    ds_read_b64_tr_b16 v[180:181], v2 offset:2048
    v_mfma_f32_16x16x32_bf16 v[68:71], v[188:191], a[180:183], v[68:71]
    v_rcp_f32 v200, v200
    v_mfma_f32_16x16x32_bf16 v[72:75], v[188:191], a[184:187], v[72:75]
    ds_read_b64_tr_b16 v[182:183], v2 offset:2304
    v_mfma_f32_16x16x32_bf16 v[76:79], v[188:191], a[188:191], v[76:79]
    s_waitcnt lgkmcnt(4)
    v_mfma_f32_16x16x32_bf16 v[80:83], v[192:195], a[176:179], v[80:83]
    ds_read_b64_tr_b16 v[184:185], v3 offset:0
    v_mfma_f32_16x16x32_bf16 v[84:87], v[192:195], a[180:183], v[84:87]
    v_rcp_f32 v201, v201
    v_mfma_f32_16x16x32_bf16 v[88:91], v[192:195], a[184:187], v[88:91]
    ds_read_b64_tr_b16 v[186:187], v3 offset:256
    v_mul_f32 v137, v121, v137
    v_mfma_f32_16x16x32_bf16 v[92:95], v[192:195], a[188:191], v[92:95]
    v_mul_f32 v136, v136, v200
    v_mul_f32 v137, v137, v201
    v_mfma_f32_16x16x32_bf16 v[96:99], v[196:199], a[176:179], v[96:99]
    ds_read_b64_tr_b16 v[188:189], v3 offset:2048
    v_cvt_pk_bf16_f32 v208, v136, v137
    v_mfma_f32_16x16x32_bf16 v[100:103], v[196:199], a[180:183], v[100:103]
    v_mul_f32 v202, s47, v122
    v_mul_f32 v203, s47, v123
    v_mfma_f32_16x16x32_bf16 v[104:107], v[196:199], a[184:187], v[104:107]
    ds_read_b64_tr_b16 v[190:191], v3 offset:2304
    v_mfma_f32_16x16x32_bf16 v[108:111], v[196:199], a[188:191], v[108:111]
    s_waitcnt lgkmcnt(4)
    v_mfma_f32_16x16x32_bf16 v[48:51], v[176:179], a[192:195], v[48:51]
    ds_read_b64_tr_b16 v[192:193], v2 offset:4096
    v_mfma_f32_16x16x32_bf16 v[52:55], v[176:179], a[196:199], v[52:55]
    s_add_u32 m0, s40, 41984
    s_add_u32 s48, s42, 1327296
    buffer_load_dwordx4 v6, s[12:15], s48 offen lds
    v_mfma_f32_16x16x32_bf16 v[56:59], v[176:179], a[200:203], v[56:59]
    ds_read_b64_tr_b16 v[194:195], v2 offset:4352
    v_mfma_f32_16x16x32_bf16 v[60:63], v[176:179], a[204:207], v[60:63]
    v_exp_f32 v202, v202
    v_mfma_f32_16x16x32_bf16 v[64:67], v[180:183], a[192:195], v[64:67]
    ds_read_b64_tr_b16 v[196:197], v2 offset:6144
    v_mfma_f32_16x16x32_bf16 v[68:71], v[180:183], a[196:199], v[68:71]
    v_exp_f32 v203, v203
    v_mfma_f32_16x16x32_bf16 v[72:75], v[180:183], a[200:203], v[72:75]
    ds_read_b64_tr_b16 v[198:199], v2 offset:6400
    v_mul_f32 v138, v122, v138
    v_mfma_f32_16x16x32_bf16 v[76:79], v[180:183], a[204:207], v[76:79]
    v_add_f32 v202, 1.0, v202
    s_waitcnt lgkmcnt(4)
    v_mfma_f32_16x16x32_bf16 v[80:83], v[184:187], a[192:195], v[80:83]
    ds_read_b64_tr_b16 v[176:177], v3 offset:4096
    v_add_f32 v203, 1.0, v203
    v_mfma_f32_16x16x32_bf16 v[84:87], v[184:187], a[196:199], v[84:87]
    s_add_u32 m0, s55, 7168
    s_nop 0
    buffer_load_dwordx4 v223, s[24:27], s59 offen lds
    v_mfma_f32_16x16x32_bf16 v[88:91], v[184:187], a[200:203], v[88:91]
    ds_read_b64_tr_b16 v[178:179], v3 offset:4352
    v_mfma_f32_16x16x32_bf16 v[92:95], v[184:187], a[204:207], v[92:95]
    v_rcp_f32 v202, v202
    v_mfma_f32_16x16x32_bf16 v[96:99], v[188:191], a[192:195], v[96:99]
    ds_read_b64_tr_b16 v[180:181], v3 offset:6144
    v_mfma_f32_16x16x32_bf16 v[100:103], v[188:191], a[196:199], v[100:103]
    s_add_u32 m0, s40, 49152
    s_add_u32 s48, s42, 1769664
    buffer_load_dwordx4 v6, s[12:15], s48 offen lds
    v_mfma_f32_16x16x32_bf16 v[104:107], v[188:191], a[200:203], v[104:107]
    ds_read_b64_tr_b16 v[182:183], v3 offset:6400
    v_mfma_f32_16x16x32_bf16 v[108:111], v[188:191], a[204:207], v[108:111]
    s_waitcnt lgkmcnt(4)
    v_mfma_f32_16x16x32_bf16 v[48:51], v[192:195], a[208:211], v[48:51]
    ds_read_b64_tr_b16 v[184:185], v2 offset:8192
    v_mfma_f32_16x16x32_bf16 v[52:55], v[192:195], a[212:215], v[52:55]
    v_rcp_f32 v203, v203
    v_mfma_f32_16x16x32_bf16 v[56:59], v[192:195], a[216:219], v[56:59]
    ds_read_b64_tr_b16 v[186:187], v2 offset:8448
    v_mul_f32 v139, v123, v139
    v_mfma_f32_16x16x32_bf16 v[60:63], v[192:195], a[220:223], v[60:63]
    v_mul_f32 v138, v138, v202
    v_mul_f32 v139, v139, v203
    v_mfma_f32_16x16x32_bf16 v[64:67], v[196:199], a[208:211], v[64:67]
    ds_read_b64_tr_b16 v[188:189], v2 offset:10240
    v_cvt_pk_bf16_f32 v209, v138, v139
    v_mfma_f32_16x16x32_bf16 v[68:71], v[196:199], a[212:215], v[68:71]
    v_mul_f32 v204, s47, v152
    v_mul_f32 v205, s47, v153
    v_mfma_f32_16x16x32_bf16 v[72:75], v[196:199], a[216:219], v[72:75]
    ds_read_b64_tr_b16 v[190:191], v2 offset:10496
    v_mfma_f32_16x16x32_bf16 v[76:79], v[196:199], a[220:223], v[76:79]
    s_waitcnt lgkmcnt(4)
    v_mfma_f32_16x16x32_bf16 v[80:83], v[176:179], a[208:211], v[80:83]
    ds_read_b64_tr_b16 v[192:193], v3 offset:8192
    v_mfma_f32_16x16x32_bf16 v[84:87], v[176:179], a[212:215], v[84:87]
    v_exp_f32 v204, v204
    v_mfma_f32_16x16x32_bf16 v[88:91], v[176:179], a[216:219], v[88:91]
    ds_read_b64_tr_b16 v[194:195], v3 offset:8448
    v_mfma_f32_16x16x32_bf16 v[92:95], v[176:179], a[220:223], v[92:95]
    s_add_u32 m0, s40, 50176
    s_add_u32 s48, s42, 1917120
    buffer_load_dwordx4 v6, s[12:15], s48 offen lds
    v_mfma_f32_16x16x32_bf16 v[96:99], v[180:183], a[208:211], v[96:99]
    ds_read_b64_tr_b16 v[196:197], v3 offset:10240
    v_mfma_f32_16x16x32_bf16 v[100:103], v[180:183], a[212:215], v[100:103]
    v_exp_f32 v205, v205
    v_mfma_f32_16x16x32_bf16 v[104:107], v[180:183], a[216:219], v[104:107]
    ds_read_b64_tr_b16 v[198:199], v3 offset:10496
    v_mul_f32 v168, v152, v168
    v_mfma_f32_16x16x32_bf16 v[108:111], v[180:183], a[220:223], v[108:111]
    v_add_f32 v204, 1.0, v204
    s_waitcnt lgkmcnt(4)
    v_mfma_f32_16x16x32_bf16 v[48:51], v[184:187], a[224:227], v[48:51]
    ds_read_b64_tr_b16 v[176:177], v2 offset:12288
    v_add_f32 v205, 1.0, v205
    v_mfma_f32_16x16x32_bf16 v[52:55], v[184:187], a[228:231], v[52:55]
    s_add_u32 m0, s55, 8192
    s_nop 0
    buffer_load_dwordx4 v224, s[24:27], s59 offen lds
    v_mfma_f32_16x16x32_bf16 v[56:59], v[184:187], a[232:235], v[56:59]
    ds_read_b64_tr_b16 v[178:179], v2 offset:12544
    v_mfma_f32_16x16x32_bf16 v[60:63], v[184:187], a[236:239], v[60:63]
    v_rcp_f32 v204, v204
    v_mfma_f32_16x16x32_bf16 v[64:67], v[188:191], a[224:227], v[64:67]
    ds_read_b64_tr_b16 v[180:181], v2 offset:14336
    v_mfma_f32_16x16x32_bf16 v[68:71], v[188:191], a[228:231], v[68:71]
    v_rcp_f32 v205, v205
    v_mfma_f32_16x16x32_bf16 v[72:75], v[188:191], a[232:235], v[72:75]
    ds_read_b64_tr_b16 v[182:183], v2 offset:14592
    v_mul_f32 v169, v153, v169
    v_mfma_f32_16x16x32_bf16 v[76:79], v[188:191], a[236:239], v[76:79]
    v_mul_f32 v168, v168, v204
    s_waitcnt lgkmcnt(4)
    v_mfma_f32_16x16x32_bf16 v[80:83], v[192:195], a[224:227], v[80:83]
    ds_read_b64_tr_b16 v[184:185], v3 offset:12288
    v_mul_f32 v169, v169, v205
    v_mfma_f32_16x16x32_bf16 v[84:87], v[192:195], a[228:231], v[84:87]
    v_cvt_pk_bf16_f32 v210, v168, v169
    v_mul_f32 v206, s47, v154
    v_mfma_f32_16x16x32_bf16 v[88:91], v[192:195], a[232:235], v[88:91]
    ds_read_b64_tr_b16 v[186:187], v3 offset:12544
    v_mul_f32 v207, s47, v155
    v_mfma_f32_16x16x32_bf16 v[92:95], v[192:195], a[236:239], v[92:95]
    v_exp_f32 v206, v206
    v_mfma_f32_16x16x32_bf16 v[96:99], v[196:199], a[224:227], v[96:99]
    ds_read_b64_tr_b16 v[188:189], v3 offset:14336
    v_mfma_f32_16x16x32_bf16 v[100:103], v[196:199], a[228:231], v[100:103]
    v_exp_f32 v207, v207
    v_mfma_f32_16x16x32_bf16 v[104:107], v[196:199], a[232:235], v[104:107]
    ds_read_b64_tr_b16 v[190:191], v3 offset:14592
    v_mul_f32 v170, v154, v170
    v_mfma_f32_16x16x32_bf16 v[108:111], v[196:199], a[236:239], v[108:111]
    s_waitcnt vmcnt(12)
    s_barrier
    s_waitcnt lgkmcnt(4)
    v_mfma_f32_16x16x32_bf16 v[48:51], v[176:179], a[240:243], v[48:51]
    ds_read_b64_tr_b16 v[192:193], v2 offset:16384
    v_add_f32 v206, 1.0, v206
    v_mfma_f32_16x16x32_bf16 v[52:55], v[176:179], a[244:247], v[52:55]
    s_add_u32 m0, s40, 57344
    s_add_u32 s48, s42, 2359488
    buffer_load_dwordx4 v6, s[12:15], s48 offen lds
    v_mfma_f32_16x16x32_bf16 v[56:59], v[176:179], a[248:251], v[56:59]
    ds_read_b64_tr_b16 v[194:195], v2 offset:16640
    v_add_f32 v207, 1.0, v207
    v_mfma_f32_16x16x32_bf16 v[60:63], v[176:179], a[252:255], v[60:63]
    v_rcp_f32 v206, v206
    v_mfma_f32_16x16x32_bf16 v[64:67], v[180:183], a[240:243], v[64:67]
    ds_read_b64_tr_b16 v[196:197], v2 offset:18432
    v_mfma_f32_16x16x32_bf16 v[68:71], v[180:183], a[244:247], v[68:71]
    v_rcp_f32 v207, v207
    v_mfma_f32_16x16x32_bf16 v[72:75], v[180:183], a[248:251], v[72:75]
    ds_read_b64_tr_b16 v[198:199], v2 offset:18688
    v_mul_f32 v171, v155, v171
    v_mfma_f32_16x16x32_bf16 v[76:79], v[180:183], a[252:255], v[76:79]
    v_mul_f32 v170, v170, v206
    s_waitcnt lgkmcnt(4)
    v_mfma_f32_16x16x32_bf16 v[80:83], v[184:187], a[240:243], v[80:83]
    ds_read_b64_tr_b16 v[176:177], v3 offset:16384
    v_mul_f32 v171, v171, v207
    v_mfma_f32_16x16x32_bf16 v[84:87], v[184:187], a[244:247], v[84:87]
    v_cvt_pk_bf16_f32 v211, v170, v171
    s_add_u32 s49, s45, 37888
    v_mfma_f32_16x16x32_bf16 v[88:91], v[184:187], a[248:251], v[88:91]
    ds_read_b64_tr_b16 v[178:179], v3 offset:16640
    buffer_store_dwordx4 v[208:211], v1, s[20:23], s49 offen sc1
    v_mfma_f32_16x16x32_bf16 v[92:95], v[184:187], a[252:255], v[92:95]
    v_mul_f32 v200, s47, v124
    v_mul_f32 v201, s47, v125
    v_mfma_f32_16x16x32_bf16 v[96:99], v[188:191], a[240:243], v[96:99]
    ds_read_b64_tr_b16 v[180:181], v3 offset:18432
    v_mfma_f32_16x16x32_bf16 v[100:103], v[188:191], a[244:247], v[100:103]
    s_add_u32 m0, s40, 58368
    s_add_u32 s48, s42, 2506944
    buffer_load_dwordx4 v6, s[12:15], s48 offen lds
    v_mfma_f32_16x16x32_bf16 v[104:107], v[188:191], a[248:251], v[104:107]
    ds_read_b64_tr_b16 v[182:183], v3 offset:18688
    v_mfma_f32_16x16x32_bf16 v[108:111], v[188:191], a[252:255], v[108:111]
    s_waitcnt lgkmcnt(4)
    v_mfma_f32_16x16x32_bf16 v[48:51], v[192:195], v[16:19], v[48:51]
    ds_read_b64_tr_b16 v[184:185], v2 offset:20480
    v_mfma_f32_16x16x32_bf16 v[52:55], v[192:195], v[20:23], v[52:55]
    v_exp_f32 v200, v200
    v_mfma_f32_16x16x32_bf16 v[56:59], v[192:195], v[24:27], v[56:59]
    ds_read_b64_tr_b16 v[186:187], v2 offset:20736
    v_mfma_f32_16x16x32_bf16 v[60:63], v[192:195], v[28:31], v[60:63]
    v_exp_f32 v201, v201
    v_mfma_f32_16x16x32_bf16 v[64:67], v[196:199], v[16:19], v[64:67]
    ds_read_b64_tr_b16 v[188:189], v2 offset:22528
    v_mul_f32 v140, v124, v140
    v_mfma_f32_16x16x32_bf16 v[68:71], v[196:199], v[20:23], v[68:71]
    v_add_f32 v200, 1.0, v200
    v_add_f32 v201, 1.0, v201
    v_mfma_f32_16x16x32_bf16 v[72:75], v[196:199], v[24:27], v[72:75]
    ds_read_b64_tr_b16 v[190:191], v2 offset:22784
    v_mfma_f32_16x16x32_bf16 v[76:79], v[196:199], v[28:31], v[76:79]
    s_waitcnt lgkmcnt(4)
    v_mfma_f32_16x16x32_bf16 v[80:83], v[176:179], v[16:19], v[80:83]
    ds_read_b64_tr_b16 v[192:193], v3 offset:20480
    v_mfma_f32_16x16x32_bf16 v[84:87], v[176:179], v[20:23], v[84:87]
    s_add_u32 m0, s40, 0
    s_add_u32 s48, s42, 2949312
    buffer_load_dwordx4 v6, s[12:15], s48 offen lds
    v_mfma_f32_16x16x32_bf16 v[88:91], v[176:179], v[24:27], v[88:91]
    ds_read_b64_tr_b16 v[194:195], v3 offset:20736
    v_mfma_f32_16x16x32_bf16 v[92:95], v[176:179], v[28:31], v[92:95]
    v_rcp_f32 v200, v200
    v_mfma_f32_16x16x32_bf16 v[96:99], v[180:183], v[16:19], v[96:99]
    ds_read_b64_tr_b16 v[196:197], v3 offset:22528
    v_mfma_f32_16x16x32_bf16 v[100:103], v[180:183], v[20:23], v[100:103]
    v_rcp_f32 v201, v201
    v_mfma_f32_16x16x32_bf16 v[104:107], v[180:183], v[24:27], v[104:107]
    ds_read_b64_tr_b16 v[198:199], v3 offset:22784
    v_mul_f32 v141, v125, v141
    v_mfma_f32_16x16x32_bf16 v[108:111], v[180:183], v[28:31], v[108:111]
    v_mul_f32 v140, v140, v200
    s_waitcnt lgkmcnt(4)
    v_mfma_f32_16x16x32_bf16 v[48:51], v[184:187], v[32:35], v[48:51]
    ds_read_b64_tr_b16 v[176:177], v2 offset:24576
    v_mul_f32 v141, v141, v201
    v_mfma_f32_16x16x32_bf16 v[52:55], v[184:187], v[36:39], v[52:55]
    v_cvt_pk_bf16_f32 v212, v140, v141
    v_mul_f32 v202, s47, v126
    v_mfma_f32_16x16x32_bf16 v[56:59], v[184:187], v[40:43], v[56:59]
    ds_read_b64_tr_b16 v[178:179], v2 offset:24832
    v_mul_f32 v203, s47, v127
    v_mfma_f32_16x16x32_bf16 v[60:63], v[184:187], v[44:47], v[60:63]
    v_exp_f32 v202, v202
    v_mfma_f32_16x16x32_bf16 v[64:67], v[188:191], v[32:35], v[64:67]
    ds_read_b64_tr_b16 v[180:181], v2 offset:26624
    v_mfma_f32_16x16x32_bf16 v[68:71], v[188:191], v[36:39], v[68:71]
    s_add_u32 m0, s40, 1024
    s_add_u32 s48, s42, 3096768
    buffer_load_dwordx4 v6, s[12:15], s48 offen lds
    v_mfma_f32_16x16x32_bf16 v[72:75], v[188:191], v[40:43], v[72:75]
    ds_read_b64_tr_b16 v[182:183], v2 offset:26880
    v_mfma_f32_16x16x32_bf16 v[76:79], v[188:191], v[44:47], v[76:79]
    s_waitcnt lgkmcnt(4)
    v_mfma_f32_16x16x32_bf16 v[80:83], v[192:195], v[32:35], v[80:83]
    ds_read_b64_tr_b16 v[184:185], v3 offset:24576
    v_mfma_f32_16x16x32_bf16 v[84:87], v[192:195], v[36:39], v[84:87]
    v_exp_f32 v203, v203
    v_mfma_f32_16x16x32_bf16 v[88:91], v[192:195], v[40:43], v[88:91]
    ds_read_b64_tr_b16 v[186:187], v3 offset:24832
    v_mul_f32 v142, v126, v142
    v_mfma_f32_16x16x32_bf16 v[92:95], v[192:195], v[44:47], v[92:95]
    v_add_f32 v202, 1.0, v202
    v_add_f32 v203, 1.0, v203
    v_mfma_f32_16x16x32_bf16 v[96:99], v[196:199], v[32:35], v[96:99]
    ds_read_b64_tr_b16 v[188:189], v3 offset:26624
    v_mfma_f32_16x16x32_bf16 v[100:103], v[196:199], v[36:39], v[100:103]
    v_rcp_f32 v202, v202
    v_rcp_f32 v203, v203
    v_mul_f32 v143, v127, v143
    v_mul_f32 v142, v142, v202
    v_mul_f32 v143, v143, v203
    v_cvt_pk_bf16_f32 v213, v142, v143
    v_mul_f32 v204, s47, v156
    v_mul_f32 v205, s47, v157
    v_exp_f32 v204, v204
    v_exp_f32 v205, v205
    v_mul_f32 v172, v156, v172
    v_add_f32 v204, 1.0, v204
    v_add_f32 v205, 1.0, v205
    v_rcp_f32 v204, v204
    v_rcp_f32 v205, v205
    v_mul_f32 v173, v157, v173
    v_mul_f32 v172, v172, v204
    v_mul_f32 v173, v173, v205
    v_cvt_pk_bf16_f32 v214, v172, v173
    v_mul_f32 v206, s47, v158
    v_mul_f32 v207, s47, v159
    v_exp_f32 v206, v206
    v_exp_f32 v207, v207
    v_mul_f32 v174, v158, v174
    v_add_f32 v206, 1.0, v206
    v_add_f32 v207, 1.0, v207
    v_rcp_f32 v206, v206
    v_rcp_f32 v207, v207
    v_mul_f32 v175, v159, v175
    v_mul_f32 v174, v174, v206
    v_mul_f32 v175, v175, v207
    v_cvt_pk_bf16_f32 v215, v174, v175
    s_add_u32 s49, s45, 56320
    buffer_store_dwordx4 v[212:215], v1, s[20:23], s49 offen sc1
    v_mfma_f32_16x16x32_bf16 v[104:107], v[196:199], v[40:43], v[104:107]
    ds_read_b64_tr_b16 v[190:191], v3 offset:26880
    v_mfma_f32_16x16x32_bf16 v[108:111], v[196:199], v[44:47], v[108:111]
    s_waitcnt lgkmcnt(4)
    v_mfma_f32_16x16x32_bf16 v[112:115], v[176:179], a[0:3], 0
    ds_read_b64_tr_b16 v[192:193], v2 offset:28672
    v_mfma_f32_16x16x32_bf16 v[116:119], v[176:179], a[4:7], 0
    v_mfma_f32_16x16x32_bf16 v[120:123], v[176:179], a[8:11], 0
    ds_read_b64_tr_b16 v[194:195], v2 offset:28928
    v_mul_f32 v200, s47, v48
    v_mfma_f32_16x16x32_bf16 v[124:127], v[176:179], a[12:15], 0
    v_mul_f32 v201, s47, v49
    v_mfma_f32_16x16x32_bf16 v[128:131], v[180:183], a[0:3], 0
    ds_read_b64_tr_b16 v[196:197], v2 offset:30720
    v_mfma_f32_16x16x32_bf16 v[132:135], v[180:183], a[4:7], 0
    v_exp_f32 v200, v200
    v_mfma_f32_16x16x32_bf16 v[136:139], v[180:183], a[8:11], 0
    ds_read_b64_tr_b16 v[198:199], v2 offset:30976
    v_mfma_f32_16x16x32_bf16 v[140:143], v[180:183], a[12:15], 0
    s_waitcnt lgkmcnt(4)
    v_mfma_f32_16x16x32_bf16 v[144:147], v[184:187], a[0:3], 0
    ds_read_b64_tr_b16 v[176:177], v3 offset:28672
    v_mfma_f32_16x16x32_bf16 v[148:151], v[184:187], a[4:7], 0
    v_exp_f32 v201, v201
    v_mfma_f32_16x16x32_bf16 v[152:155], v[184:187], a[8:11], 0
    ds_read_b64_tr_b16 v[178:179], v3 offset:28928
    v_mul_f32 v64, v48, v64
    v_mfma_f32_16x16x32_bf16 v[156:159], v[184:187], a[12:15], 0
    v_add_f32 v200, 1.0, v200
    v_add_f32 v201, 1.0, v201
    v_mfma_f32_16x16x32_bf16 v[160:163], v[188:191], a[0:3], 0
    ds_read_b64_tr_b16 v[180:181], v3 offset:30720
    v_mfma_f32_16x16x32_bf16 v[164:167], v[188:191], a[4:7], 0
    v_rcp_f32 v200, v200
    v_mfma_f32_16x16x32_bf16 v[168:171], v[188:191], a[8:11], 0
    ds_read_b64_tr_b16 v[182:183], v3 offset:30976
    v_mfma_f32_16x16x32_bf16 v[172:175], v[188:191], a[12:15], 0
    s_waitcnt vmcnt(10)
    s_barrier
    s_waitcnt lgkmcnt(4)
    v_mfma_f32_16x16x32_bf16 v[112:115], v[192:195], a[16:19], v[112:115]
    ds_read_b64_tr_b16 v[184:185], v2 offset:32768
    v_mfma_f32_16x16x32_bf16 v[116:119], v[192:195], a[20:23], v[116:119]
    s_add_u32 m0, s40, 8192
    s_add_u32 s48, s42, 3539136
    buffer_load_dwordx4 v6, s[12:15], s48 offen lds
    v_mfma_f32_16x16x32_bf16 v[120:123], v[192:195], a[24:27], v[120:123]
    ds_read_b64_tr_b16 v[186:187], v2 offset:33024
    v_mfma_f32_16x16x32_bf16 v[124:127], v[192:195], a[28:31], v[124:127]
    v_rcp_f32 v201, v201
    v_mfma_f32_16x16x32_bf16 v[128:131], v[196:199], a[16:19], v[128:131]
    ds_read_b64_tr_b16 v[188:189], v2 offset:34816
    v_mul_f32 v65, v49, v65
    v_mfma_f32_16x16x32_bf16 v[132:135], v[196:199], a[20:23], v[132:135]
    v_mul_f32 v64, v64, v200
    v_mul_f32 v65, v65, v201
    v_mfma_f32_16x16x32_bf16 v[136:139], v[196:199], a[24:27], v[136:139]
    ds_read_b64_tr_b16 v[190:191], v2 offset:35072
    v_cvt_pk_bf16_f32 v208, v64, v65
    v_mfma_f32_16x16x32_bf16 v[140:143], v[196:199], a[28:31], v[140:143]
    v_mul_f32 v202, s47, v50
    s_waitcnt lgkmcnt(4)
    v_mfma_f32_16x16x32_bf16 v[144:147], v[176:179], a[16:19], v[144:147]
    ds_read_b64_tr_b16 v[192:193], v3 offset:32768
    v_mul_f32 v203, s47, v51
    v_mfma_f32_16x16x32_bf16 v[148:151], v[176:179], a[20:23], v[148:151]
    v_exp_f32 v202, v202
    v_mfma_f32_16x16x32_bf16 v[152:155], v[176:179], a[24:27], v[152:155]
    ds_read_b64_tr_b16 v[194:195], v3 offset:33024
    v_mfma_f32_16x16x32_bf16 v[156:159], v[176:179], a[28:31], v[156:159]
    v_exp_f32 v203, v203
    v_mfma_f32_16x16x32_bf16 v[160:163], v[180:183], a[16:19], v[160:163]
    ds_read_b64_tr_b16 v[196:197], v3 offset:34816
    v_mul_f32 v66, v50, v66
    v_mfma_f32_16x16x32_bf16 v[164:167], v[180:183], a[20:23], v[164:167]
    v_add_f32 v202, 1.0, v202
    v_add_f32 v203, 1.0, v203
    v_mfma_f32_16x16x32_bf16 v[168:171], v[180:183], a[24:27], v[168:171]
    ds_read_b64_tr_b16 v[198:199], v3 offset:35072
    v_mfma_f32_16x16x32_bf16 v[172:175], v[180:183], a[28:31], v[172:175]
    s_waitcnt lgkmcnt(4)
    v_mfma_f32_16x16x32_bf16 v[112:115], v[184:187], a[32:35], v[112:115]
    ds_read_b64_tr_b16 v[176:177], v2 offset:36864
    v_mfma_f32_16x16x32_bf16 v[116:119], v[184:187], a[36:39], v[116:119]
    s_add_u32 m0, s40, 9216
    s_add_u32 s48, s42, 3686592
    buffer_load_dwordx4 v6, s[12:15], s48 offen lds
    v_mfma_f32_16x16x32_bf16 v[120:123], v[184:187], a[40:43], v[120:123]
    ds_read_b64_tr_b16 v[178:179], v2 offset:37120
    v_mfma_f32_16x16x32_bf16 v[124:127], v[184:187], a[44:47], v[124:127]
    v_rcp_f32 v202, v202
    v_mfma_f32_16x16x32_bf16 v[128:131], v[188:191], a[32:35], v[128:131]
    ds_read_b64_tr_b16 v[180:181], v2 offset:38912
    v_mfma_f32_16x16x32_bf16 v[132:135], v[188:191], a[36:39], v[132:135]
    v_rcp_f32 v203, v203
    v_mfma_f32_16x16x32_bf16 v[136:139], v[188:191], a[40:43], v[136:139]
    ds_read_b64_tr_b16 v[182:183], v2 offset:39168
    v_mul_f32 v67, v51, v67
    v_mfma_f32_16x16x32_bf16 v[140:143], v[188:191], a[44:47], v[140:143]
    v_mul_f32 v66, v66, v202
    s_waitcnt lgkmcnt(4)
    v_mfma_f32_16x16x32_bf16 v[144:147], v[192:195], a[32:35], v[144:147]
    ds_read_b64_tr_b16 v[184:185], v3 offset:36864
    v_mul_f32 v67, v67, v203
    v_mfma_f32_16x16x32_bf16 v[148:151], v[192:195], a[36:39], v[148:151]
    v_cvt_pk_bf16_f32 v209, v66, v67
    v_mul_f32 v204, s47, v80
    v_mfma_f32_16x16x32_bf16 v[152:155], v[192:195], a[40:43], v[152:155]
    ds_read_b64_tr_b16 v[186:187], v3 offset:37120
    v_mul_f32 v205, s47, v81
    v_mfma_f32_16x16x32_bf16 v[156:159], v[192:195], a[44:47], v[156:159]
    v_exp_f32 v204, v204
    v_mfma_f32_16x16x32_bf16 v[160:163], v[196:199], a[32:35], v[160:163]
    ds_read_b64_tr_b16 v[188:189], v3 offset:38912
    v_mfma_f32_16x16x32_bf16 v[164:167], v[196:199], a[36:39], v[164:167]
    s_add_u32 m0, s40, 16384
    s_add_u32 s48, s42, 4128960
    buffer_load_dwordx4 v6, s[12:15], s48 offen lds
    v_mfma_f32_16x16x32_bf16 v[168:171], v[196:199], a[40:43], v[168:171]
    ds_read_b64_tr_b16 v[190:191], v3 offset:39168
    v_mfma_f32_16x16x32_bf16 v[172:175], v[196:199], a[44:47], v[172:175]
    s_waitcnt lgkmcnt(4)
    v_mfma_f32_16x16x32_bf16 v[112:115], v[176:179], a[48:51], v[112:115]
    ds_read_b64_tr_b16 v[192:193], v2 offset:40960
    v_mfma_f32_16x16x32_bf16 v[116:119], v[176:179], a[52:55], v[116:119]
    v_exp_f32 v205, v205
    v_mfma_f32_16x16x32_bf16 v[120:123], v[176:179], a[56:59], v[120:123]
    ds_read_b64_tr_b16 v[194:195], v2 offset:41216
    v_mul_f32 v96, v80, v96
    v_mfma_f32_16x16x32_bf16 v[124:127], v[176:179], a[60:63], v[124:127]
    v_add_f32 v204, 1.0, v204
    v_add_f32 v205, 1.0, v205
    v_mfma_f32_16x16x32_bf16 v[128:131], v[180:183], a[48:51], v[128:131]
    ds_read_b64_tr_b16 v[196:197], v2 offset:43008
    v_mfma_f32_16x16x32_bf16 v[132:135], v[180:183], a[52:55], v[132:135]
    v_rcp_f32 v204, v204
    v_mfma_f32_16x16x32_bf16 v[136:139], v[180:183], a[56:59], v[136:139]
    ds_read_b64_tr_b16 v[198:199], v2 offset:43264
    v_mfma_f32_16x16x32_bf16 v[140:143], v[180:183], a[60:63], v[140:143]
    s_waitcnt lgkmcnt(4)
    v_mfma_f32_16x16x32_bf16 v[144:147], v[184:187], a[48:51], v[144:147]
    ds_read_b64_tr_b16 v[176:177], v3 offset:40960
    v_mfma_f32_16x16x32_bf16 v[148:151], v[184:187], a[52:55], v[148:151]
    v_rcp_f32 v205, v205
    v_mfma_f32_16x16x32_bf16 v[152:155], v[184:187], a[56:59], v[152:155]
    ds_read_b64_tr_b16 v[178:179], v3 offset:41216
    v_mul_f32 v97, v81, v97
    v_mfma_f32_16x16x32_bf16 v[156:159], v[184:187], a[60:63], v[156:159]
    s_add_u32 m0, s40, 17408
    s_add_u32 s48, s42, 4276416
    buffer_load_dwordx4 v6, s[12:15], s48 offen lds
    v_mfma_f32_16x16x32_bf16 v[160:163], v[188:191], a[48:51], v[160:163]
    ds_read_b64_tr_b16 v[180:181], v3 offset:43008
    v_mul_f32 v96, v96, v204
    v_mfma_f32_16x16x32_bf16 v[164:167], v[188:191], a[52:55], v[164:167]
    v_mul_f32 v97, v97, v205
    v_cvt_pk_bf16_f32 v210, v96, v97
    v_mfma_f32_16x16x32_bf16 v[168:171], v[188:191], a[56:59], v[168:171]
    ds_read_b64_tr_b16 v[182:183], v3 offset:43264
    v_mul_f32 v206, s47, v82
    v_mfma_f32_16x16x32_bf16 v[172:175], v[188:191], a[60:63], v[172:175]
    v_mul_f32 v207, s47, v83
    s_waitcnt lgkmcnt(4)
    v_mfma_f32_16x16x32_bf16 v[112:115], v[192:195], a[64:67], v[112:115]
    ds_read_b64_tr_b16 v[184:185], v2 offset:45056
    v_mfma_f32_16x16x32_bf16 v[116:119], v[192:195], a[68:71], v[116:119]
    v_exp_f32 v206, v206
    v_mfma_f32_16x16x32_bf16 v[120:123], v[192:195], a[72:75], v[120:123]
    ds_read_b64_tr_b16 v[186:187], v2 offset:45312
    v_mfma_f32_16x16x32_bf16 v[124:127], v[192:195], a[76:79], v[124:127]
    v_exp_f32 v207, v207
    v_mfma_f32_16x16x32_bf16 v[128:131], v[196:199], a[64:67], v[128:131]
    ds_read_b64_tr_b16 v[188:189], v2 offset:47104
    v_mul_f32 v98, v82, v98
    v_mfma_f32_16x16x32_bf16 v[132:135], v[196:199], a[68:71], v[132:135]
    v_add_f32 v206, 1.0, v206
    v_add_f32 v207, 1.0, v207
    v_mfma_f32_16x16x32_bf16 v[136:139], v[196:199], a[72:75], v[136:139]
    ds_read_b64_tr_b16 v[190:191], v2 offset:47360
    v_mfma_f32_16x16x32_bf16 v[140:143], v[196:199], a[76:79], v[140:143]
    s_waitcnt lgkmcnt(4)
    v_mfma_f32_16x16x32_bf16 v[144:147], v[176:179], a[64:67], v[144:147]
    ds_read_b64_tr_b16 v[192:193], v3 offset:45056
    v_mfma_f32_16x16x32_bf16 v[148:151], v[176:179], a[68:71], v[148:151]
    v_rcp_f32 v206, v206
    v_mfma_f32_16x16x32_bf16 v[152:155], v[176:179], a[72:75], v[152:155]
    ds_read_b64_tr_b16 v[194:195], v3 offset:45312
    v_mfma_f32_16x16x32_bf16 v[156:159], v[176:179], a[76:79], v[156:159]
    v_rcp_f32 v207, v207
    v_mfma_f32_16x16x32_bf16 v[160:163], v[180:183], a[64:67], v[160:163]
    ds_read_b64_tr_b16 v[196:197], v3 offset:47104
    v_mul_f32 v99, v83, v99
    v_mfma_f32_16x16x32_bf16 v[164:167], v[180:183], a[68:71], v[164:167]
    v_mul_f32 v98, v98, v206
    v_mul_f32 v99, v99, v207
    v_mfma_f32_16x16x32_bf16 v[168:171], v[180:183], a[72:75], v[168:171]
    ds_read_b64_tr_b16 v[198:199], v3 offset:47360
    v_cvt_pk_bf16_f32 v211, v98, v99
    v_mfma_f32_16x16x32_bf16 v[172:175], v[180:183], a[76:79], v[172:175]
    s_waitcnt vmcnt(7)
    s_barrier
    s_waitcnt lgkmcnt(4)
    v_mfma_f32_16x16x32_bf16 v[112:115], v[184:187], a[80:83], v[112:115]
    ds_read_b64_tr_b16 v[176:177], v2 offset:49152
    s_add_u32 s49, s79, 0
    v_mfma_f32_16x16x32_bf16 v[116:119], v[184:187], a[84:87], v[116:119]
    s_add_u32 m0, s40, 24576
    s_add_u32 s48, s42, 4718784
    buffer_load_dwordx4 v6, s[12:15], s48 offen lds
    v_mfma_f32_16x16x32_bf16 v[120:123], v[184:187], a[88:91], v[120:123]
    ds_read_b64_tr_b16 v[178:179], v2 offset:49408
    buffer_store_dwordx4 v[208:211], v1, s[20:23], s49 offen sc1
    v_mfma_f32_16x16x32_bf16 v[124:127], v[184:187], a[92:95], v[124:127]
    v_mul_f32 v200, s47, v52
    v_mul_f32 v201, s47, v53
    v_mfma_f32_16x16x32_bf16 v[128:131], v[188:191], a[80:83], v[128:131]
    ds_read_b64_tr_b16 v[180:181], v2 offset:51200
    v_mfma_f32_16x16x32_bf16 v[132:135], v[188:191], a[84:87], v[132:135]
    v_exp_f32 v200, v200
    v_mfma_f32_16x16x32_bf16 v[136:139], v[188:191], a[88:91], v[136:139]
    ds_read_b64_tr_b16 v[182:183], v2 offset:51456
    v_mfma_f32_16x16x32_bf16 v[140:143], v[188:191], a[92:95], v[140:143]
    s_waitcnt lgkmcnt(4)
    v_mfma_f32_16x16x32_bf16 v[144:147], v[192:195], a[80:83], v[144:147]
    ds_read_b64_tr_b16 v[184:185], v3 offset:49152
    v_mfma_f32_16x16x32_bf16 v[148:151], v[192:195], a[84:87], v[148:151]
    v_exp_f32 v201, v201
    v_mfma_f32_16x16x32_bf16 v[152:155], v[192:195], a[88:91], v[152:155]
    ds_read_b64_tr_b16 v[186:187], v3 offset:49408
    v_mul_f32 v68, v52, v68
    v_mfma_f32_16x16x32_bf16 v[156:159], v[192:195], a[92:95], v[156:159]
    v_add_f32 v200, 1.0, v200
    v_add_f32 v201, 1.0, v201
    v_mfma_f32_16x16x32_bf16 v[160:163], v[196:199], a[80:83], v[160:163]
    ds_read_b64_tr_b16 v[188:189], v3 offset:51200
    v_mfma_f32_16x16x32_bf16 v[164:167], v[196:199], a[84:87], v[164:167]
    v_rcp_f32 v200, v200
    v_mfma_f32_16x16x32_bf16 v[168:171], v[196:199], a[88:91], v[168:171]
    ds_read_b64_tr_b16 v[190:191], v3 offset:51456
    v_mfma_f32_16x16x32_bf16 v[172:175], v[196:199], a[92:95], v[172:175]
    s_waitcnt lgkmcnt(4)
    v_mfma_f32_16x16x32_bf16 v[112:115], v[176:179], a[96:99], v[112:115]
    ds_read_b64_tr_b16 v[192:193], v2 offset:53248
    v_mfma_f32_16x16x32_bf16 v[116:119], v[176:179], a[100:103], v[116:119]
    s_add_u32 m0, s40, 25600
    s_add_u32 s48, s42, 4866240
    buffer_load_dwordx4 v6, s[12:15], s48 offen lds
    v_mfma_f32_16x16x32_bf16 v[120:123], v[176:179], a[104:107], v[120:123]
    ds_read_b64_tr_b16 v[194:195], v2 offset:53504
    v_mfma_f32_16x16x32_bf16 v[124:127], v[176:179], a[108:111], v[124:127]
    v_rcp_f32 v201, v201
    v_mfma_f32_16x16x32_bf16 v[128:131], v[180:183], a[96:99], v[128:131]
    ds_read_b64_tr_b16 v[196:197], v2 offset:55296
    v_mul_f32 v69, v53, v69
    v_mfma_f32_16x16x32_bf16 v[132:135], v[180:183], a[100:103], v[132:135]
    v_mul_f32 v68, v68, v200
    v_mul_f32 v69, v69, v201
    v_mfma_f32_16x16x32_bf16 v[136:139], v[180:183], a[104:107], v[136:139]
    ds_read_b64_tr_b16 v[198:199], v2 offset:55552
    v_cvt_pk_bf16_f32 v212, v68, v69
    v_mfma_f32_16x16x32_bf16 v[140:143], v[180:183], a[108:111], v[140:143]
    v_mul_f32 v202, s47, v54
    s_waitcnt lgkmcnt(4)
    v_mfma_f32_16x16x32_bf16 v[144:147], v[184:187], a[96:99], v[144:147]
    ds_read_b64_tr_b16 v[176:177], v3 offset:53248
    v_mul_f32 v203, s47, v55
    v_mfma_f32_16x16x32_bf16 v[148:151], v[184:187], a[100:103], v[148:151]
    v_exp_f32 v202, v202
    v_mfma_f32_16x16x32_bf16 v[152:155], v[184:187], a[104:107], v[152:155]
    ds_read_b64_tr_b16 v[178:179], v3 offset:53504
    v_mfma_f32_16x16x32_bf16 v[156:159], v[184:187], a[108:111], v[156:159]
    v_exp_f32 v203, v203
    v_mfma_f32_16x16x32_bf16 v[160:163], v[188:191], a[96:99], v[160:163]
    ds_read_b64_tr_b16 v[180:181], v3 offset:55296
    v_mul_f32 v70, v54, v70
    v_mfma_f32_16x16x32_bf16 v[164:167], v[188:191], a[100:103], v[164:167]
    s_add_u32 m0, s41, 32768
    s_add_u32 s48, s43, 0
    buffer_load_dwordx4 v7, s[12:15], s48 offen lds
    v_mfma_f32_16x16x32_bf16 v[168:171], v[188:191], a[104:107], v[168:171]
    ds_read_b64_tr_b16 v[182:183], v3 offset:55552
    v_add_f32 v202, 1.0, v202
    v_mfma_f32_16x16x32_bf16 v[172:175], v[188:191], a[108:111], v[172:175]
    v_add_f32 v203, 1.0, v203
    s_waitcnt lgkmcnt(4)
    v_mfma_f32_16x16x32_bf16 v[112:115], v[192:195], a[112:115], v[112:115]
    ds_read_b64_tr_b16 v[184:185], v2 offset:57344
    v_mfma_f32_16x16x32_bf16 v[116:119], v[192:195], a[116:119], v[116:119]
    v_rcp_f32 v202, v202
    v_mfma_f32_16x16x32_bf16 v[120:123], v[192:195], a[120:123], v[120:123]
    ds_read_b64_tr_b16 v[186:187], v2 offset:57600
    v_mfma_f32_16x16x32_bf16 v[124:127], v[192:195], a[124:127], v[124:127]
    v_rcp_f32 v203, v203
    v_mfma_f32_16x16x32_bf16 v[128:131], v[196:199], a[112:115], v[128:131]
    ds_read_b64_tr_b16 v[188:189], v2 offset:59392
    v_mul_f32 v71, v55, v71
    v_mfma_f32_16x16x32_bf16 v[132:135], v[196:199], a[116:119], v[132:135]
    v_mul_f32 v70, v70, v202
    v_mul_f32 v71, v71, v203
    v_mfma_f32_16x16x32_bf16 v[136:139], v[196:199], a[120:123], v[136:139]
    ds_read_b64_tr_b16 v[190:191], v2 offset:59648
    v_cvt_pk_bf16_f32 v213, v70, v71
    v_mfma_f32_16x16x32_bf16 v[140:143], v[196:199], a[124:127], v[140:143]
    v_mul_f32 v204, s47, v84
    s_waitcnt lgkmcnt(4)
    v_mfma_f32_16x16x32_bf16 v[144:147], v[176:179], a[112:115], v[144:147]
    ds_read_b64_tr_b16 v[192:193], v3 offset:57344
    v_mul_f32 v205, s47, v85
    v_mfma_f32_16x16x32_bf16 v[148:151], v[176:179], a[116:119], v[148:151]
    v_exp_f32 v204, v204
    v_mfma_f32_16x16x32_bf16 v[152:155], v[176:179], a[120:123], v[152:155]
    ds_read_b64_tr_b16 v[194:195], v3 offset:57600
    v_mfma_f32_16x16x32_bf16 v[156:159], v[176:179], a[124:127], v[156:159]
    v_exp_f32 v205, v205
    v_mfma_f32_16x16x32_bf16 v[160:163], v[180:183], a[112:115], v[160:163]
    ds_read_b64_tr_b16 v[196:197], v3 offset:59392
    v_mul_f32 v100, v84, v100
    v_mfma_f32_16x16x32_bf16 v[164:167], v[180:183], a[116:119], v[164:167]
    v_add_f32 v204, 1.0, v204
    v_add_f32 v205, 1.0, v205
    v_mfma_f32_16x16x32_bf16 v[168:171], v[180:183], a[120:123], v[168:171]
    ds_read_b64_tr_b16 v[198:199], v3 offset:59648
    v_mfma_f32_16x16x32_bf16 v[172:175], v[180:183], a[124:127], v[172:175]
    s_waitcnt lgkmcnt(4)
    v_mfma_f32_16x16x32_bf16 v[112:115], v[184:187], a[128:131], v[112:115]
    ds_read_b64_tr_b16 v[176:177], v2 offset:61440
    v_mfma_f32_16x16x32_bf16 v[116:119], v[184:187], a[132:135], v[116:119]
    v_rcp_f32 v204, v204
    v_mfma_f32_16x16x32_bf16 v[120:123], v[184:187], a[136:139], v[120:123]
    ds_read_b64_tr_b16 v[178:179], v2 offset:61696
    v_mfma_f32_16x16x32_bf16 v[124:127], v[184:187], a[140:143], v[124:127]
    v_rcp_f32 v205, v205
    v_mfma_f32_16x16x32_bf16 v[128:131], v[188:191], a[128:131], v[128:131]
    ds_read_b64_tr_b16 v[180:181], v2 offset:63488
    v_mul_f32 v101, v85, v101
    v_mfma_f32_16x16x32_bf16 v[132:135], v[188:191], a[132:135], v[132:135]
    v_mul_f32 v100, v100, v204
    v_mul_f32 v101, v101, v205
    v_mfma_f32_16x16x32_bf16 v[136:139], v[188:191], a[136:139], v[136:139]
    ds_read_b64_tr_b16 v[182:183], v2 offset:63744
    v_cvt_pk_bf16_f32 v214, v100, v101
    v_mfma_f32_16x16x32_bf16 v[140:143], v[188:191], a[140:143], v[140:143]
    v_mul_f32 v206, s47, v86
    s_waitcnt lgkmcnt(4)
    v_mfma_f32_16x16x32_bf16 v[144:147], v[192:195], a[128:131], v[144:147]
    ds_read_b64_tr_b16 v[184:185], v3 offset:61440
    v_mul_f32 v207, s47, v87
    v_mfma_f32_16x16x32_bf16 v[148:151], v[192:195], a[132:135], v[148:151]
    v_exp_f32 v206, v206
    v_mfma_f32_16x16x32_bf16 v[152:155], v[192:195], a[136:139], v[152:155]
    ds_read_b64_tr_b16 v[186:187], v3 offset:61696
    v_mfma_f32_16x16x32_bf16 v[156:159], v[192:195], a[140:143], v[156:159]
    v_exp_f32 v207, v207
    v_mfma_f32_16x16x32_bf16 v[160:163], v[196:199], a[128:131], v[160:163]
    ds_read_b64_tr_b16 v[188:189], v3 offset:63488
    v_mul_f32 v102, v86, v102
    v_mfma_f32_16x16x32_bf16 v[164:167], v[196:199], a[132:135], v[164:167]
    v_add_f32 v206, 1.0, v206
    v_add_f32 v207, 1.0, v207
    v_mfma_f32_16x16x32_bf16 v[168:171], v[196:199], a[136:139], v[168:171]
    ds_read_b64_tr_b16 v[190:191], v3 offset:63744
    v_mfma_f32_16x16x32_bf16 v[172:175], v[196:199], a[140:143], v[172:175]
    s_waitcnt vmcnt(6)
    s_waitcnt vmcnt(8)
    s_barrier
    s_cmp_lg_u32 s3, 0
    s_cbranch_scc1 M_rf2
    v_mov_b32 v15, 1
    s_mov_b64 exec, 1
    buffer_atomic_add v15, off, s[36:39], s52
    s_mov_b64 exec, -1
M_rf2:
    s_waitcnt lgkmcnt(4)
    v_mfma_f32_16x16x32_bf16 v[112:115], v[176:179], a[144:147], v[112:115]
    ds_read_b64_tr_b16 v[192:193], v2 offset:0
    v_mfma_f32_16x16x32_bf16 v[116:119], v[176:179], a[148:151], v[116:119]
    s_add_u32 m0, s41, 40960
    s_add_u32 s48, s43, 589824
    buffer_load_dwordx4 v7, s[12:15], s48 offen lds
    v_mfma_f32_16x16x32_bf16 v[120:123], v[176:179], a[152:155], v[120:123]
    ds_read_b64_tr_b16 v[194:195], v2 offset:256
    v_mfma_f32_16x16x32_bf16 v[124:127], v[176:179], a[156:159], v[124:127]
    v_rcp_f32 v206, v206
    v_mfma_f32_16x16x32_bf16 v[128:131], v[180:183], a[144:147], v[128:131]
    ds_read_b64_tr_b16 v[196:197], v2 offset:2048
    v_mfma_f32_16x16x32_bf16 v[132:135], v[180:183], a[148:151], v[132:135]
    v_rcp_f32 v207, v207
    v_mfma_f32_16x16x32_bf16 v[136:139], v[180:183], a[152:155], v[136:139]
    ds_read_b64_tr_b16 v[198:199], v2 offset:2304
    v_mul_f32 v103, v87, v103
    v_mfma_f32_16x16x32_bf16 v[140:143], v[180:183], a[156:159], v[140:143]
    v_mul_f32 v102, v102, v206
    s_waitcnt lgkmcnt(4)
    v_mfma_f32_16x16x32_bf16 v[144:147], v[184:187], a[144:147], v[144:147]
    ds_read_b64_tr_b16 v[176:177], v3 offset:0
    v_mul_f32 v103, v103, v207
    v_mfma_f32_16x16x32_bf16 v[148:151], v[184:187], a[148:151], v[148:151]
    v_cvt_pk_bf16_f32 v215, v102, v103
    s_add_u32 s49, s79, 18432
    v_mfma_f32_16x16x32_bf16 v[152:155], v[184:187], a[152:155], v[152:155]
    ds_read_b64_tr_b16 v[178:179], v3 offset:256
    buffer_store_dwordx4 v[212:215], v1, s[20:23], s49 offen sc1
    v_mfma_f32_16x16x32_bf16 v[156:159], v[184:187], a[156:159], v[156:159]
    v_mul_f32 v200, s47, v56
    v_mul_f32 v201, s47, v57
    v_mfma_f32_16x16x32_bf16 v[160:163], v[188:191], a[144:147], v[160:163]
    ds_read_b64_tr_b16 v[180:181], v3 offset:2048
    v_mfma_f32_16x16x32_bf16 v[164:167], v[188:191], a[148:151], v[164:167]
    v_exp_f32 v200, v200
    v_mfma_f32_16x16x32_bf16 v[168:171], v[188:191], a[152:155], v[168:171]
    ds_read_b64_tr_b16 v[182:183], v3 offset:2304
    v_mfma_f32_16x16x32_bf16 v[172:175], v[188:191], a[156:159], v[172:175]
    s_waitcnt lgkmcnt(4)
    v_mfma_f32_16x16x32_bf16 v[112:115], v[192:195], a[160:163], v[112:115]
    ds_read_b64_tr_b16 v[184:185], v2 offset:4096
    v_mfma_f32_16x16x32_bf16 v[116:119], v[192:195], a[164:167], v[116:119]
    s_add_u32 m0, s41, 49152
    s_add_u32 s48, s43, 1179648
    buffer_load_dwordx4 v7, s[12:15], s48 offen lds
    v_mfma_f32_16x16x32_bf16 v[120:123], v[192:195], a[168:171], v[120:123]
    ds_read_b64_tr_b16 v[186:187], v2 offset:4352
    v_mfma_f32_16x16x32_bf16 v[124:127], v[192:195], a[172:175], v[124:127]
    v_exp_f32 v201, v201
    v_mfma_f32_16x16x32_bf16 v[128:131], v[196:199], a[160:163], v[128:131]
    ds_read_b64_tr_b16 v[188:189], v2 offset:6144
    v_mul_f32 v72, v56, v72
    v_mfma_f32_16x16x32_bf16 v[132:135], v[196:199], a[164:167], v[132:135]
    v_add_f32 v200, 1.0, v200
    v_add_f32 v201, 1.0, v201
    v_mfma_f32_16x16x32_bf16 v[136:139], v[196:199], a[168:171], v[136:139]
    ds_read_b64_tr_b16 v[190:191], v2 offset:6400
    v_mfma_f32_16x16x32_bf16 v[140:143], v[196:199], a[172:175], v[140:143]
    s_waitcnt lgkmcnt(4)
    v_mfma_f32_16x16x32_bf16 v[144:147], v[176:179], a[160:163], v[144:147]
    ds_read_b64_tr_b16 v[192:193], v3 offset:4096
    v_mfma_f32_16x16x32_bf16 v[148:151], v[176:179], a[164:167], v[148:151]
    v_rcp_f32 v200, v200
    v_mfma_f32_16x16x32_bf16 v[152:155], v[176:179], a[168:171], v[152:155]
    ds_read_b64_tr_b16 v[194:195], v3 offset:4352
    v_mfma_f32_16x16x32_bf16 v[156:159], v[176:179], a[172:175], v[156:159]
    v_rcp_f32 v201, v201
    v_mfma_f32_16x16x32_bf16 v[160:163], v[180:183], a[160:163], v[160:163]
    ds_read_b64_tr_b16 v[196:197], v3 offset:6144
    v_mul_f32 v73, v57, v73
    v_mfma_f32_16x16x32_bf16 v[164:167], v[180:183], a[164:167], v[164:167]
    v_mul_f32 v72, v72, v200
    v_mul_f32 v73, v73, v201
    v_mfma_f32_16x16x32_bf16 v[168:171], v[180:183], a[168:171], v[168:171]
    ds_read_b64_tr_b16 v[198:199], v3 offset:6400
    v_cvt_pk_bf16_f32 v208, v72, v73
    v_mfma_f32_16x16x32_bf16 v[172:175], v[180:183], a[172:175], v[172:175]
    v_mul_f32 v202, s47, v58
    s_waitcnt lgkmcnt(4)
    v_mfma_f32_16x16x32_bf16 v[112:115], v[184:187], a[176:179], v[112:115]
    ds_read_b64_tr_b16 v[176:177], v2 offset:8192
    v_mul_f32 v203, s47, v59
    v_mfma_f32_16x16x32_bf16 v[116:119], v[184:187], a[180:183], v[116:119]
    v_exp_f32 v202, v202
    v_mfma_f32_16x16x32_bf16 v[120:123], v[184:187], a[184:187], v[120:123]
    ds_read_b64_tr_b16 v[178:179], v2 offset:8448
    v_mfma_f32_16x16x32_bf16 v[124:127], v[184:187], a[188:191], v[124:127]
    v_exp_f32 v203, v203
    v_mfma_f32_16x16x32_bf16 v[128:131], v[188:191], a[176:179], v[128:131]
    ds_read_b64_tr_b16 v[180:181], v2 offset:10240
    v_mul_f32 v74, v58, v74
    v_mfma_f32_16x16x32_bf16 v[132:135], v[188:191], a[180:183], v[132:135]
    v_add_f32 v202, 1.0, v202
    v_add_f32 v203, 1.0, v203
    v_mfma_f32_16x16x32_bf16 v[136:139], v[188:191], a[184:187], v[136:139]
    ds_read_b64_tr_b16 v[182:183], v2 offset:10496
    v_mfma_f32_16x16x32_bf16 v[140:143], v[188:191], a[188:191], v[140:143]
    s_waitcnt lgkmcnt(4)
    v_mfma_f32_16x16x32_bf16 v[144:147], v[192:195], a[176:179], v[144:147]
    ds_read_b64_tr_b16 v[184:185], v3 offset:8192
    v_mfma_f32_16x16x32_bf16 v[148:151], v[192:195], a[180:183], v[148:151]
    v_rcp_f32 v202, v202
    v_mfma_f32_16x16x32_bf16 v[152:155], v[192:195], a[184:187], v[152:155]
    ds_read_b64_tr_b16 v[186:187], v3 offset:8448
    v_mfma_f32_16x16x32_bf16 v[156:159], v[192:195], a[188:191], v[156:159]
    v_rcp_f32 v203, v203
    v_mfma_f32_16x16x32_bf16 v[160:163], v[196:199], a[176:179], v[160:163]
    ds_read_b64_tr_b16 v[188:189], v3 offset:10240
    v_mul_f32 v75, v59, v75
    v_mfma_f32_16x16x32_bf16 v[164:167], v[196:199], a[180:183], v[164:167]
    v_mul_f32 v74, v74, v202
    v_mul_f32 v75, v75, v203
    v_mfma_f32_16x16x32_bf16 v[168:171], v[196:199], a[184:187], v[168:171]
    ds_read_b64_tr_b16 v[190:191], v3 offset:10496
    v_cvt_pk_bf16_f32 v209, v74, v75
    v_mfma_f32_16x16x32_bf16 v[172:175], v[196:199], a[188:191], v[172:175]
    v_mul_f32 v204, s47, v88
    s_waitcnt lgkmcnt(4)
    v_mfma_f32_16x16x32_bf16 v[112:115], v[176:179], a[192:195], v[112:115]
    ds_read_b64_tr_b16 v[192:193], v2 offset:12288
    v_mul_f32 v205, s47, v89
    v_mfma_f32_16x16x32_bf16 v[116:119], v[176:179], a[196:199], v[116:119]
    v_exp_f32 v204, v204
    v_mfma_f32_16x16x32_bf16 v[120:123], v[176:179], a[200:203], v[120:123]
    ds_read_b64_tr_b16 v[194:195], v2 offset:12544
    v_mfma_f32_16x16x32_bf16 v[124:127], v[176:179], a[204:207], v[124:127]
    v_exp_f32 v205, v205
    v_mfma_f32_16x16x32_bf16 v[128:131], v[180:183], a[192:195], v[128:131]
    ds_read_b64_tr_b16 v[196:197], v2 offset:14336
    v_mul_f32 v104, v88, v104
    v_mfma_f32_16x16x32_bf16 v[132:135], v[180:183], a[196:199], v[132:135]
    v_add_f32 v204, 1.0, v204
    v_add_f32 v205, 1.0, v205
    v_mfma_f32_16x16x32_bf16 v[136:139], v[180:183], a[200:203], v[136:139]
    ds_read_b64_tr_b16 v[198:199], v2 offset:14592
    v_mfma_f32_16x16x32_bf16 v[140:143], v[180:183], a[204:207], v[140:143]
    s_waitcnt lgkmcnt(4)
    v_mfma_f32_16x16x32_bf16 v[144:147], v[184:187], a[192:195], v[144:147]
    ds_read_b64_tr_b16 v[176:177], v3 offset:12288
    v_mfma_f32_16x16x32_bf16 v[148:151], v[184:187], a[196:199], v[148:151]
    v_rcp_f32 v204, v204
    v_mfma_f32_16x16x32_bf16 v[152:155], v[184:187], a[200:203], v[152:155]
    ds_read_b64_tr_b16 v[178:179], v3 offset:12544
    v_mfma_f32_16x16x32_bf16 v[156:159], v[184:187], a[204:207], v[156:159]
    v_rcp_f32 v205, v205
    v_mfma_f32_16x16x32_bf16 v[160:163], v[188:191], a[192:195], v[160:163]
    ds_read_b64_tr_b16 v[180:181], v3 offset:14336
    v_mul_f32 v105, v89, v105
    v_mfma_f32_16x16x32_bf16 v[164:167], v[188:191], a[196:199], v[164:167]
    v_mul_f32 v104, v104, v204
    v_mul_f32 v105, v105, v205
    v_mfma_f32_16x16x32_bf16 v[168:171], v[188:191], a[200:203], v[168:171]
    ds_read_b64_tr_b16 v[182:183], v3 offset:14592
    v_cvt_pk_bf16_f32 v210, v104, v105
    v_mfma_f32_16x16x32_bf16 v[172:175], v[188:191], a[204:207], v[172:175]
    s_waitcnt vmcnt(4)
    s_barrier
    s_waitcnt lgkmcnt(4)
    v_mfma_f32_16x16x32_bf16 v[112:115], v[192:195], a[208:211], v[112:115]
    ds_read_b64_tr_b16 v[184:185], v2 offset:16384
    v_mul_f32 v206, s47, v90
    v_mfma_f32_16x16x32_bf16 v[116:119], v[192:195], a[212:215], v[116:119]
    s_add_u32 m0, s41, 57344
    s_add_u32 s48, s43, 1769472
    buffer_load_dwordx4 v7, s[12:15], s48 offen lds
    v_mfma_f32_16x16x32_bf16 v[120:123], v[192:195], a[216:219], v[120:123]
    ds_read_b64_tr_b16 v[186:187], v2 offset:16640
    v_mul_f32 v207, s47, v91
    v_mfma_f32_16x16x32_bf16 v[124:127], v[192:195], a[220:223], v[124:127]
    v_exp_f32 v206, v206
    v_mfma_f32_16x16x32_bf16 v[128:131], v[196:199], a[208:211], v[128:131]
    ds_read_b64_tr_b16 v[188:189], v2 offset:18432
    v_mfma_f32_16x16x32_bf16 v[132:135], v[196:199], a[212:215], v[132:135]
    v_exp_f32 v207, v207
    v_mfma_f32_16x16x32_bf16 v[136:139], v[196:199], a[216:219], v[136:139]
    ds_read_b64_tr_b16 v[190:191], v2 offset:18688
    v_mul_f32 v106, v90, v106
    v_mfma_f32_16x16x32_bf16 v[140:143], v[196:199], a[220:223], v[140:143]
    v_add_f32 v206, 1.0, v206
    s_waitcnt lgkmcnt(4)
    v_mfma_f32_16x16x32_bf16 v[144:147], v[176:179], a[208:211], v[144:147]
    ds_read_b64_tr_b16 v[192:193], v3 offset:16384
    v_add_f32 v207, 1.0, v207
    v_mfma_f32_16x16x32_bf16 v[148:151], v[176:179], a[212:215], v[148:151]
    v_rcp_f32 v206, v206
    v_mfma_f32_16x16x32_bf16 v[152:155], v[176:179], a[216:219], v[152:155]
    ds_read_b64_tr_b16 v[194:195], v3 offset:16640
    v_mfma_f32_16x16x32_bf16 v[156:159], v[176:179], a[220:223], v[156:159]
    v_rcp_f32 v207, v207
    v_mfma_f32_16x16x32_bf16 v[160:163], v[180:183], a[208:211], v[160:163]
    ds_read_b64_tr_b16 v[196:197], v3 offset:18432
    v_mul_f32 v107, v91, v107
    v_mfma_f32_16x16x32_bf16 v[164:167], v[180:183], a[212:215], v[164:167]
    v_mul_f32 v106, v106, v206
    v_mul_f32 v107, v107, v207
    v_mfma_f32_16x16x32_bf16 v[168:171], v[180:183], a[216:219], v[168:171]
    ds_read_b64_tr_b16 v[198:199], v3 offset:18688
    v_cvt_pk_bf16_f32 v211, v106, v107
    v_mfma_f32_16x16x32_bf16 v[172:175], v[180:183], a[220:223], v[172:175]
    s_add_u32 s49, s79, 36864
    s_waitcnt lgkmcnt(4)
    v_mfma_f32_16x16x32_bf16 v[112:115], v[184:187], a[224:227], v[112:115]
    ds_read_b64_tr_b16 v[176:177], v2 offset:20480
    buffer_store_dwordx4 v[208:211], v1, s[20:23], s49 offen sc1
    v_mfma_f32_16x16x32_bf16 v[116:119], v[184:187], a[228:231], v[116:119]
    s_add_u32 m0, s41, 0
    s_add_u32 s48, s43, 2359296
    buffer_load_dwordx4 v7, s[12:15], s48 offen lds
    v_mfma_f32_16x16x32_bf16 v[120:123], v[184:187], a[232:235], v[120:123]
    ds_read_b64_tr_b16 v[178:179], v2 offset:20736
    v_mul_f32 v200, s47, v60
    v_mfma_f32_16x16x32_bf16 v[124:127], v[184:187], a[236:239], v[124:127]
    v_mul_f32 v201, s47, v61
    v_mfma_f32_16x16x32_bf16 v[128:131], v[188:191], a[224:227], v[128:131]
    ds_read_b64_tr_b16 v[180:181], v2 offset:22528
    v_mfma_f32_16x16x32_bf16 v[132:135], v[188:191], a[228:231], v[132:135]
    v_exp_f32 v200, v200
    v_mfma_f32_16x16x32_bf16 v[136:139], v[188:191], a[232:235], v[136:139]
    ds_read_b64_tr_b16 v[182:183], v2 offset:22784
    v_mfma_f32_16x16x32_bf16 v[140:143], v[188:191], a[236:239], v[140:143]
    s_waitcnt lgkmcnt(4)
    v_mfma_f32_16x16x32_bf16 v[144:147], v[192:195], a[224:227], v[144:147]
    ds_read_b64_tr_b16 v[184:185], v3 offset:20480
    v_mfma_f32_16x16x32_bf16 v[148:151], v[192:195], a[228:231], v[148:151]
    v_exp_f32 v201, v201
    v_mfma_f32_16x16x32_bf16 v[152:155], v[192:195], a[232:235], v[152:155]
    ds_read_b64_tr_b16 v[186:187], v3 offset:20736
    v_mul_f32 v76, v60, v76
    v_mfma_f32_16x16x32_bf16 v[156:159], v[192:195], a[236:239], v[156:159]
    v_add_f32 v200, 1.0, v200
    v_add_f32 v201, 1.0, v201
    v_mfma_f32_16x16x32_bf16 v[160:163], v[196:199], a[224:227], v[160:163]
    ds_read_b64_tr_b16 v[188:189], v3 offset:22528
    v_mfma_f32_16x16x32_bf16 v[164:167], v[196:199], a[228:231], v[164:167]
    v_rcp_f32 v200, v200
    v_mfma_f32_16x16x32_bf16 v[168:171], v[196:199], a[232:235], v[168:171]
    ds_read_b64_tr_b16 v[190:191], v3 offset:22784
    v_mfma_f32_16x16x32_bf16 v[172:175], v[196:199], a[236:239], v[172:175]
    s_waitcnt lgkmcnt(4)
    buffer_load_dword v14, off, s[36:39], s52 sc1
    v_mfma_f32_16x16x32_bf16 v[112:115], v[176:179], a[240:243], v[112:115]
    ds_read_b64_tr_b16 v[192:193], v2 offset:24576
    v_mfma_f32_16x16x32_bf16 v[116:119], v[176:179], a[244:247], v[116:119]
    v_rcp_f32 v201, v201
    v_mfma_f32_16x16x32_bf16 v[120:123], v[176:179], a[248:251], v[120:123]
    ds_read_b64_tr_b16 v[194:195], v2 offset:24832
    v_mul_f32 v77, v61, v77
    v_mfma_f32_16x16x32_bf16 v[124:127], v[176:179], a[252:255], v[124:127]
    v_mul_f32 v76, v76, v200
    v_mul_f32 v77, v77, v201
    v_mfma_f32_16x16x32_bf16 v[128:131], v[180:183], a[240:243], v[128:131]
    ds_read_b64_tr_b16 v[196:197], v2 offset:26624
    v_cvt_pk_bf16_f32 v212, v76, v77
    v_mfma_f32_16x16x32_bf16 v[132:135], v[180:183], a[244:247], v[132:135]
    v_mul_f32 v202, s47, v62
    v_mul_f32 v203, s47, v63
    v_mfma_f32_16x16x32_bf16 v[136:139], v[180:183], a[248:251], v[136:139]
    ds_read_b64_tr_b16 v[198:199], v2 offset:26880
    v_mfma_f32_16x16x32_bf16 v[140:143], v[180:183], a[252:255], v[140:143]
    s_waitcnt lgkmcnt(4)
    v_mfma_f32_16x16x32_bf16 v[144:147], v[184:187], a[240:243], v[144:147]
    ds_read_b64_tr_b16 v[176:177], v3 offset:24576
    v_mfma_f32_16x16x32_bf16 v[148:151], v[184:187], a[244:247], v[148:151]
    v_exp_f32 v202, v202
    v_mfma_f32_16x16x32_bf16 v[152:155], v[184:187], a[248:251], v[152:155]
    ds_read_b64_tr_b16 v[178:179], v3 offset:24832
    v_mfma_f32_16x16x32_bf16 v[156:159], v[184:187], a[252:255], v[156:159]
    v_exp_f32 v203, v203
    v_mfma_f32_16x16x32_bf16 v[160:163], v[188:191], a[240:243], v[160:163]
    ds_read_b64_tr_b16 v[180:181], v3 offset:26624
    v_mul_f32 v78, v62, v78
    v_mfma_f32_16x16x32_bf16 v[164:167], v[188:191], a[244:247], v[164:167]
    v_add_f32 v202, 1.0, v202
    v_add_f32 v203, 1.0, v203
    v_mfma_f32_16x16x32_bf16 v[168:171], v[188:191], a[248:251], v[168:171]
    ds_read_b64_tr_b16 v[182:183], v3 offset:26880
    v_mfma_f32_16x16x32_bf16 v[172:175], v[188:191], a[252:255], v[172:175]
    s_waitcnt lgkmcnt(4)
    v_mfma_f32_16x16x32_bf16 v[112:115], v[192:195], v[16:19], v[112:115]
    ds_read_b64_tr_b16 v[184:185], v2 offset:28672
    v_mfma_f32_16x16x32_bf16 v[116:119], v[192:195], v[20:23], v[116:119]
    v_rcp_f32 v202, v202
    v_mfma_f32_16x16x32_bf16 v[120:123], v[192:195], v[24:27], v[120:123]
    ds_read_b64_tr_b16 v[186:187], v2 offset:28928
    v_mfma_f32_16x16x32_bf16 v[124:127], v[192:195], v[28:31], v[124:127]
    v_rcp_f32 v203, v203
    v_mfma_f32_16x16x32_bf16 v[128:131], v[196:199], v[16:19], v[128:131]
    ds_read_b64_tr_b16 v[188:189], v2 offset:30720
    v_mul_f32 v79, v63, v79
    v_mfma_f32_16x16x32_bf16 v[132:135], v[196:199], v[20:23], v[132:135]
    v_mul_f32 v78, v78, v202
    v_mul_f32 v79, v79, v203
    v_mfma_f32_16x16x32_bf16 v[136:139], v[196:199], v[24:27], v[136:139]
    ds_read_b64_tr_b16 v[190:191], v2 offset:30976
    v_cvt_pk_bf16_f32 v213, v78, v79
    v_mfma_f32_16x16x32_bf16 v[140:143], v[196:199], v[28:31], v[140:143]
    v_mul_f32 v204, s47, v92
    s_waitcnt lgkmcnt(4)
    v_mfma_f32_16x16x32_bf16 v[144:147], v[176:179], v[16:19], v[144:147]
    ds_read_b64_tr_b16 v[192:193], v3 offset:28672
    v_mul_f32 v205, s47, v93
    v_mfma_f32_16x16x32_bf16 v[148:151], v[176:179], v[20:23], v[148:151]
    v_exp_f32 v204, v204
    v_mfma_f32_16x16x32_bf16 v[152:155], v[176:179], v[24:27], v[152:155]
    ds_read_b64_tr_b16 v[194:195], v3 offset:28928
    v_mfma_f32_16x16x32_bf16 v[156:159], v[176:179], v[28:31], v[156:159]
    v_exp_f32 v205, v205
    v_mfma_f32_16x16x32_bf16 v[160:163], v[180:183], v[16:19], v[160:163]
    ds_read_b64_tr_b16 v[196:197], v3 offset:30720
    v_mul_f32 v108, v92, v108
    v_mfma_f32_16x16x32_bf16 v[164:167], v[180:183], v[20:23], v[164:167]
    v_add_f32 v204, 1.0, v204
    v_add_f32 v205, 1.0, v205
    v_mfma_f32_16x16x32_bf16 v[168:171], v[180:183], v[24:27], v[168:171]
    ds_read_b64_tr_b16 v[198:199], v3 offset:30976
    v_mfma_f32_16x16x32_bf16 v[172:175], v[180:183], v[28:31], v[172:175]
    s_waitcnt vmcnt(7)
    s_barrier
    s_waitcnt lgkmcnt(4)
    v_mfma_f32_16x16x32_bf16 v[112:115], v[184:187], v[32:35], v[112:115]
    ds_read_b64_tr_b16 v[176:177], v4 offset:32768
    v_mfma_f32_16x16x32_bf16 v[116:119], v[184:187], v[36:39], v[116:119]
    s_add_u32 m0, s41, 8192
    s_add_u32 s48, s43, 2949120
    buffer_load_dwordx4 v7, s[12:15], s48 offen lds
    v_mfma_f32_16x16x32_bf16 v[120:123], v[184:187], v[40:43], v[120:123]
    ds_read_b64_tr_b16 v[178:179], v5 offset:32768
    v_mfma_f32_16x16x32_bf16 v[124:127], v[184:187], v[44:47], v[124:127]
    v_rcp_f32 v204, v204
    v_mfma_f32_16x16x32_bf16 v[128:131], v[188:191], v[32:35], v[128:131]
    ds_read_b64_tr_b16 v[180:181], v4 offset:33792
    v_mfma_f32_16x16x32_bf16 v[132:135], v[188:191], v[36:39], v[132:135]
    v_rcp_f32 v205, v205
    v_mfma_f32_16x16x32_bf16 v[136:139], v[188:191], v[40:43], v[136:139]
    ds_read_b64_tr_b16 v[182:183], v5 offset:33792
    v_mul_f32 v109, v93, v109
    v_mfma_f32_16x16x32_bf16 v[140:143], v[188:191], v[44:47], v[140:143]
    v_mul_f32 v108, v108, v204
    s_waitcnt lgkmcnt(4)
    v_mfma_f32_16x16x32_bf16 v[144:147], v[192:195], v[32:35], v[144:147]
    ds_read_b64_tr_b16 v[184:185], v4 offset:34816
    v_mul_f32 v109, v109, v205
    v_mfma_f32_16x16x32_bf16 v[148:151], v[192:195], v[36:39], v[148:151]
    s_add_u32 m0, s41, 16384
    s_add_u32 s48, s43, 3538944
    buffer_load_dwordx4 v7, s[12:15], s48 offen lds
    v_mfma_f32_16x16x32_bf16 v[152:155], v[192:195], v[40:43], v[152:155]
    ds_read_b64_tr_b16 v[186:187], v5 offset:34816
    v_cvt_pk_bf16_f32 v214, v108, v109
    v_mfma_f32_16x16x32_bf16 v[156:159], v[192:195], v[44:47], v[156:159]
    v_mul_f32 v206, s47, v94
    v_mul_f32 v207, s47, v95
    v_mfma_f32_16x16x32_bf16 v[160:163], v[196:199], v[32:35], v[160:163]
    ds_read_b64_tr_b16 v[188:189], v4 offset:35840
    v_mfma_f32_16x16x32_bf16 v[164:167], v[196:199], v[36:39], v[164:167]
    v_exp_f32 v206, v206
    v_exp_f32 v207, v207
    v_mul_f32 v110, v94, v110
    v_add_f32 v206, 1.0, v206
    v_add_f32 v207, 1.0, v207
    v_rcp_f32 v206, v206
    v_rcp_f32 v207, v207
    v_mul_f32 v111, v95, v111
    v_mul_f32 v110, v110, v206
    v_mul_f32 v111, v111, v207
    v_cvt_pk_bf16_f32 v215, v110, v111
    s_add_u32 s49, s79, 55296
    buffer_store_dwordx4 v[212:215], v1, s[20:23], s49 offen sc1
    v_mfma_f32_16x16x32_bf16 v[168:171], v[196:199], v[40:43], v[168:171]
    ds_read_b64_tr_b16 v[190:191], v5 offset:35840
    v_mfma_f32_16x16x32_bf16 v[172:175], v[196:199], v[44:47], v[172:175]
    s_waitcnt vmcnt(9)
    s_barrier
    s_waitcnt lgkmcnt(4)
    v_mfma_f32_16x16x32_bf16 v[48:51], v[176:179], a[0:3], 0
    ds_read_b64_tr_b16 v[192:193], v4 offset:40960
    v_mfma_f32_16x16x32_bf16 v[52:55], v[176:179], a[4:7], 0
    s_add_u32 m0, s41, 24576
    s_add_u32 s48, s43, 4128768
    buffer_load_dwordx4 v7, s[12:15], s48 offen lds
    v_mfma_f32_16x16x32_bf16 v[56:59], v[176:179], a[8:11], 0
    ds_read_b64_tr_b16 v[194:195], v5 offset:40960
    v_mul_f32 v200, s47, v112
    v_mfma_f32_16x16x32_bf16 v[60:63], v[176:179], a[12:15], 0
    v_mul_f32 v201, s47, v113
    v_mfma_f32_16x16x32_bf16 v[64:67], v[180:183], a[0:3], 0
    ds_read_b64_tr_b16 v[196:197], v4 offset:41984
    v_mfma_f32_16x16x32_bf16 v[68:71], v[180:183], a[4:7], 0
    v_exp_f32 v200, v200
    v_mfma_f32_16x16x32_bf16 v[72:75], v[180:183], a[8:11], 0
    ds_read_b64_tr_b16 v[198:199], v5 offset:41984
    v_mfma_f32_16x16x32_bf16 v[76:79], v[180:183], a[12:15], 0
    s_waitcnt lgkmcnt(4)
    s_waitcnt vmcnt(4)
M_pc3:
    v_readfirstlane_b32 s65, v14
    s_nop 0
    s_bfe_u32 s65, s65, 524288
    s_cmp_ge_u32 s65, 8
    s_cbranch_scc1 M_po3
    s_add_u32 s100, s100, 1
    s_cmp_ge_u32 s100, 262144
    s_cbranch_scc1 M_po3
    buffer_load_dword v14, off, s[36:39], s52 sc1
    s_waitcnt vmcnt(0)
    s_branch M_pc3
M_po3:
    v_mfma_f32_16x16x32_bf16 v[48:51], v[184:187], a[16:19], v[48:51]
    ds_read_b64_tr_b16 v[176:177], v4 offset:43008
    buffer_load_dwordx4 a[0:3], v1, s[20:23], s75 offen offset:0 sc1
    v_mfma_f32_16x16x32_bf16 v[52:55], v[184:187], a[20:23], v[52:55]
    v_exp_f32 v201, v201
    v_mfma_f32_16x16x32_bf16 v[56:59], v[184:187], a[24:27], v[56:59]
    ds_read_b64_tr_b16 v[178:179], v5 offset:43008
    v_mul_f32 v128, v112, v128
    v_mfma_f32_16x16x32_bf16 v[60:63], v[184:187], a[28:31], v[60:63]
    v_add_f32 v200, 1.0, v200
    v_add_f32 v201, 1.0, v201
    v_mfma_f32_16x16x32_bf16 v[64:67], v[188:191], a[16:19], v[64:67]
    ds_read_b64_tr_b16 v[180:181], v4 offset:44032
    buffer_load_dwordx4 a[4:7], v1, s[20:23], s76 offen offset:0 sc1
    v_mfma_f32_16x16x32_bf16 v[68:71], v[188:191], a[20:23], v[68:71]
    v_rcp_f32 v200, v200
    v_mfma_f32_16x16x32_bf16 v[72:75], v[188:191], a[24:27], v[72:75]
    ds_read_b64_tr_b16 v[182:183], v5 offset:44032
    v_mfma_f32_16x16x32_bf16 v[76:79], v[188:191], a[28:31], v[76:79]
    s_waitcnt vmcnt(10)
    s_barrier
    s_waitcnt lgkmcnt(4)
    v_mfma_f32_16x16x32_bf16 v[48:51], v[192:195], a[32:35], v[48:51]
    ds_read_b64_tr_b16 v[184:185], v4 offset:49152
    buffer_load_dwordx4 a[8:11], v1, s[20:23], s77 offen offset:0 sc1
    v_mfma_f32_16x16x32_bf16 v[52:55], v[192:195], a[36:39], v[52:55]
    s_add_u32 m0, s41, 32768
    s_add_u32 s48, s43, 4718592
    buffer_load_dwordx4 v7, s[12:15], s48 offen lds
    v_mfma_f32_16x16x32_bf16 v[56:59], v[192:195], a[40:43], v[56:59]
    ds_read_b64_tr_b16 v[186:187], v5 offset:49152
    v_mfma_f32_16x16x32_bf16 v[60:63], v[192:195], a[44:47], v[60:63]
    v_rcp_f32 v201, v201
    v_mfma_f32_16x16x32_bf16 v[64:67], v[196:199], a[32:35], v[64:67]
    ds_read_b64_tr_b16 v[188:189], v4 offset:50176
    v_mul_f32 v129, v113, v129
    v_mfma_f32_16x16x32_bf16 v[68:71], v[196:199], a[36:39], v[68:71]
    v_mul_f32 v128, v128, v200
    v_mul_f32 v129, v129, v201
    v_mfma_f32_16x16x32_bf16 v[72:75], v[196:199], a[40:43], v[72:75]
    ds_read_b64_tr_b16 v[190:191], v5 offset:50176
    v_cvt_pk_bf16_f32 v208, v128, v129
    v_mfma_f32_16x16x32_bf16 v[76:79], v[196:199], a[44:47], v[76:79]
    v_mul_f32 v202, s47, v114
    s_waitcnt lgkmcnt(4)
    v_mfma_f32_16x16x32_bf16 v[48:51], v[176:179], a[48:51], v[48:51]
    ds_read_b64_tr_b16 v[192:193], v4 offset:51200
    v_mul_f32 v203, s47, v115
    v_mfma_f32_16x16x32_bf16 v[52:55], v[176:179], a[52:55], v[52:55]
    v_exp_f32 v202, v202
    v_mfma_f32_16x16x32_bf16 v[56:59], v[176:179], a[56:59], v[56:59]
    ds_read_b64_tr_b16 v[194:195], v5 offset:51200
    v_mfma_f32_16x16x32_bf16 v[60:63], v[176:179], a[60:63], v[60:63]
    v_exp_f32 v203, v203
    v_mfma_f32_16x16x32_bf16 v[64:67], v[180:183], a[48:51], v[64:67]
    ds_read_b64_tr_b16 v[196:197], v4 offset:52224
    buffer_load_dwordx4 a[12:15], v1, s[20:23], s78 offen offset:0 sc1
    v_mfma_f32_16x16x32_bf16 v[68:71], v[180:183], a[52:55], v[68:71]
    v_mul_f32 v130, v114, v130
    v_add_f32 v202, 1.0, v202
    v_mfma_f32_16x16x32_bf16 v[72:75], v[180:183], a[56:59], v[72:75]
    ds_read_b64_tr_b16 v[198:199], v5 offset:52224
    v_add_f32 v203, 1.0, v203
    v_mfma_f32_16x16x32_bf16 v[76:79], v[180:183], a[60:63], v[76:79]
    s_waitcnt vmcnt(12)
    s_barrier
    s_waitcnt lgkmcnt(4)
    v_mfma_f32_16x16x32_bf16 v[48:51], v[184:187], a[64:67], v[48:51]
    ds_read_b64_tr_b16 v[176:177], v4 offset:57344
    buffer_load_dwordx4 a[16:19], v1, s[20:23], s75 offen offset:1024 sc1
    v_mfma_f32_16x16x32_bf16 v[52:55], v[184:187], a[68:71], v[52:55]
    v_rcp_f32 v202, v202
    v_mfma_f32_16x16x32_bf16 v[56:59], v[184:187], a[72:75], v[56:59]
    ds_read_b64_tr_b16 v[178:179], v5 offset:57344
    v_mfma_f32_16x16x32_bf16 v[60:63], v[184:187], a[76:79], v[60:63]
    v_rcp_f32 v203, v203
    v_mfma_f32_16x16x32_bf16 v[64:67], v[188:191], a[64:67], v[64:67]
    ds_read_b64_tr_b16 v[180:181], v4 offset:58368
    v_mul_f32 v131, v115, v131
    v_mfma_f32_16x16x32_bf16 v[68:71], v[188:191], a[68:71], v[68:71]
    v_mul_f32 v130, v130, v202
    v_mul_f32 v131, v131, v203
    v_mfma_f32_16x16x32_bf16 v[72:75], v[188:191], a[72:75], v[72:75]
    ds_read_b64_tr_b16 v[182:183], v5 offset:58368
    v_cvt_pk_bf16_f32 v209, v130, v131
    v_mfma_f32_16x16x32_bf16 v[76:79], v[188:191], a[76:79], v[76:79]
    v_mul_f32 v204, s47, v144
    s_waitcnt lgkmcnt(4)
    v_mfma_f32_16x16x32_bf16 v[48:51], v[192:195], a[80:83], v[48:51]
    ds_read_b64_tr_b16 v[184:185], v4 offset:59392
    v_mul_f32 v205, s47, v145
    v_mfma_f32_16x16x32_bf16 v[52:55], v[192:195], a[84:87], v[52:55]
    v_exp_f32 v204, v204
    v_mfma_f32_16x16x32_bf16 v[56:59], v[192:195], a[88:91], v[56:59]
    ds_read_b64_tr_b16 v[186:187], v5 offset:59392
    v_mfma_f32_16x16x32_bf16 v[60:63], v[192:195], a[92:95], v[60:63]
    v_exp_f32 v205, v205
    v_mfma_f32_16x16x32_bf16 v[64:67], v[196:199], a[80:83], v[64:67]
    ds_read_b64_tr_b16 v[188:189], v4 offset:60416
    buffer_load_dwordx4 a[20:23], v1, s[20:23], s76 offen offset:1024 sc1
    v_mfma_f32_16x16x32_bf16 v[68:71], v[196:199], a[84:87], v[68:71]
    v_mul_f32 v160, v144, v160
    v_add_f32 v204, 1.0, v204
    v_mfma_f32_16x16x32_bf16 v[72:75], v[196:199], a[88:91], v[72:75]
    ds_read_b64_tr_b16 v[190:191], v5 offset:60416
    v_add_f32 v205, 1.0, v205
    v_mfma_f32_16x16x32_bf16 v[76:79], v[196:199], a[92:95], v[76:79]
    s_waitcnt vmcnt(12)
    s_barrier
    s_waitcnt lgkmcnt(4)
    v_mfma_f32_16x16x32_bf16 v[48:51], v[176:179], a[96:99], v[48:51]
    ds_read_b64_tr_b16 v[192:193], v4 offset:0
    buffer_load_dwordx4 a[24:27], v1, s[20:23], s77 offen offset:1024 sc1
    v_mfma_f32_16x16x32_bf16 v[52:55], v[176:179], a[100:103], v[52:55]
    v_rcp_f32 v204, v204
    v_mfma_f32_16x16x32_bf16 v[56:59], v[176:179], a[104:107], v[56:59]
    ds_read_b64_tr_b16 v[194:195], v5 offset:0
    v_mfma_f32_16x16x32_bf16 v[60:63], v[176:179], a[108:111], v[60:63]
    v_rcp_f32 v205, v205
    v_mfma_f32_16x16x32_bf16 v[64:67], v[180:183], a[96:99], v[64:67]
    ds_read_b64_tr_b16 v[196:197], v4 offset:1024
    buffer_load_dwordx4 a[28:31], v1, s[20:23], s78 offen offset:1024 sc1
    v_mfma_f32_16x16x32_bf16 v[68:71], v[180:183], a[100:103], v[68:71]
    v_mul_f32 v161, v145, v161
    v_mul_f32 v160, v160, v204
    v_mfma_f32_16x16x32_bf16 v[72:75], v[180:183], a[104:107], v[72:75]
    ds_read_b64_tr_b16 v[198:199], v5 offset:1024
    v_mul_f32 v161, v161, v205
    v_mfma_f32_16x16x32_bf16 v[76:79], v[180:183], a[108:111], v[76:79]
    v_cvt_pk_bf16_f32 v210, v160, v161
    s_waitcnt lgkmcnt(4)
    v_mfma_f32_16x16x32_bf16 v[48:51], v[184:187], a[112:115], v[48:51]
    ds_read_b64_tr_b16 v[176:177], v4 offset:2048
    buffer_load_dwordx4 a[32:35], v1, s[20:23], s75 offen offset:2048 sc1
    v_mfma_f32_16x16x32_bf16 v[52:55], v[184:187], a[116:119], v[52:55]
    v_mul_f32 v206, s47, v146
    v_mul_f32 v207, s47, v147
    v_mfma_f32_16x16x32_bf16 v[56:59], v[184:187], a[120:123], v[56:59]
    ds_read_b64_tr_b16 v[178:179], v5 offset:2048
    v_mfma_f32_16x16x32_bf16 v[60:63], v[184:187], a[124:127], v[60:63]
    v_exp_f32 v206, v206
    v_mfma_f32_16x16x32_bf16 v[64:67], v[188:191], a[112:115], v[64:67]
    ds_read_b64_tr_b16 v[180:181], v4 offset:3072
    v_mfma_f32_16x16x32_bf16 v[68:71], v[188:191], a[116:119], v[68:71]
    v_exp_f32 v207, v207
    v_mfma_f32_16x16x32_bf16 v[72:75], v[188:191], a[120:123], v[72:75]
    ds_read_b64_tr_b16 v[182:183], v5 offset:3072
    v_mul_f32 v162, v146, v162
    v_mfma_f32_16x16x32_bf16 v[76:79], v[188:191], a[124:127], v[76:79]
    s_waitcnt vmcnt(13)
    s_barrier
    s_waitcnt lgkmcnt(4)
    v_mfma_f32_16x16x32_bf16 v[48:51], v[192:195], a[128:131], v[48:51]
    ds_read_b64_tr_b16 v[184:185], v4 offset:8192
    v_add_f32 v206, 1.0, v206
    v_mfma_f32_16x16x32_bf16 v[52:55], v[192:195], a[132:135], v[52:55]
    v_add_f32 v207, 1.0, v207
    v_mfma_f32_16x16x32_bf16 v[56:59], v[192:195], a[136:139], v[56:59]
    ds_read_b64_tr_b16 v[186:187], v5 offset:8192
    v_mfma_f32_16x16x32_bf16 v[60:63], v[192:195], a[140:143], v[60:63]
    v_rcp_f32 v206, v206
    v_mfma_f32_16x16x32_bf16 v[64:67], v[196:199], a[128:131], v[64:67]
    ds_read_b64_tr_b16 v[188:189], v4 offset:9216
    buffer_load_dwordx4 a[36:39], v1, s[20:23], s76 offen offset:2048 sc1
    v_mfma_f32_16x16x32_bf16 v[68:71], v[196:199], a[132:135], v[68:71]
    v_rcp_f32 v207, v207
    v_mfma_f32_16x16x32_bf16 v[72:75], v[196:199], a[136:139], v[72:75]
    ds_read_b64_tr_b16 v[190:191], v5 offset:9216
    v_mul_f32 v163, v147, v163
    v_mfma_f32_16x16x32_bf16 v[76:79], v[196:199], a[140:143], v[76:79]
    v_mul_f32 v162, v162, v206
    s_waitcnt lgkmcnt(4)
    v_mfma_f32_16x16x32_bf16 v[48:51], v[176:179], a[144:147], v[48:51]
    ds_read_b64_tr_b16 v[192:193], v4 offset:10240
    buffer_load_dwordx4 a[40:43], v1, s[20:23], s77 offen offset:2048 sc1
    v_mfma_f32_16x16x32_bf16 v[52:55], v[176:179], a[148:151], v[52:55]
    v_mul_f32 v163, v163, v207
    v_cvt_pk_bf16_f32 v211, v162, v163
    v_mfma_f32_16x16x32_bf16 v[56:59], v[176:179], a[152:155], v[56:59]
    ds_read_b64_tr_b16 v[194:195], v5 offset:10240
    s_add_u32 s49, s79, 4096
    v_mfma_f32_16x16x32_bf16 v[60:63], v[176:179], a[156:159], v[60:63]
    buffer_store_dwordx4 v[208:211], v1, s[20:23], s49 offen sc1
    v_mul_f32 v200, s47, v116
    v_mfma_f32_16x16x32_bf16 v[64:67], v[180:183], a[144:147], v[64:67]
    ds_read_b64_tr_b16 v[196:197], v4 offset:11264
    v_mul_f32 v201, s47, v117
    v_mfma_f32_16x16x32_bf16 v[68:71], v[180:183], a[148:151], v[68:71]
    v_exp_f32 v200, v200
    v_mfma_f32_16x16x32_bf16 v[72:75], v[180:183], a[152:155], v[72:75]
    ds_read_b64_tr_b16 v[198:199], v5 offset:11264
    v_mfma_f32_16x16x32_bf16 v[76:79], v[180:183], a[156:159], v[76:79]
    s_waitcnt vmcnt(15)
    s_waitcnt vmcnt(14)
    s_barrier
    s_cmp_lg_u32 s3, 0
    s_cbranch_scc1 M_rf4
    v_mov_b32 v15, 256
    s_mov_b64 exec, 1
    buffer_atomic_add v15, off, s[36:39], s52
    s_mov_b64 exec, -1
M_rf4:
    s_waitcnt lgkmcnt(4)
    v_mfma_f32_16x16x32_bf16 v[48:51], v[184:187], a[160:163], v[48:51]
    ds_read_b64_tr_b16 v[176:177], v4 offset:16384
    v_mfma_f32_16x16x32_bf16 v[52:55], v[184:187], a[164:167], v[52:55]
    v_exp_f32 v201, v201
    v_mfma_f32_16x16x32_bf16 v[56:59], v[184:187], a[168:171], v[56:59]
    ds_read_b64_tr_b16 v[178:179], v5 offset:16384
    v_mul_f32 v132, v116, v132
    v_mfma_f32_16x16x32_bf16 v[60:63], v[184:187], a[172:175], v[60:63]
    v_add_f32 v200, 1.0, v200
    v_add_f32 v201, 1.0, v201
    v_mfma_f32_16x16x32_bf16 v[64:67], v[188:191], a[160:163], v[64:67]
    ds_read_b64_tr_b16 v[180:181], v4 offset:17408
    buffer_load_dwordx4 a[44:47], v1, s[20:23], s78 offen offset:2048 sc1
    v_mfma_f32_16x16x32_bf16 v[68:71], v[188:191], a[164:167], v[68:71]
    v_rcp_f32 v200, v200
    v_mfma_f32_16x16x32_bf16 v[72:75], v[188:191], a[168:171], v[72:75]
    ds_read_b64_tr_b16 v[182:183], v5 offset:17408
    v_mfma_f32_16x16x32_bf16 v[76:79], v[188:191], a[172:175], v[76:79]
    s_waitcnt lgkmcnt(4)
    v_mfma_f32_16x16x32_bf16 v[48:51], v[192:195], a[176:179], v[48:51]
    ds_read_b64_tr_b16 v[184:185], v4 offset:18432
    buffer_load_dwordx4 a[48:51], v1, s[20:23], s75 offen offset:3072 sc1
    v_mfma_f32_16x16x32_bf16 v[52:55], v[192:195], a[180:183], v[52:55]
    v_rcp_f32 v201, v201
    v_mfma_f32_16x16x32_bf16 v[56:59], v[192:195], a[184:187], v[56:59]
    ds_read_b64_tr_b16 v[186:187], v5 offset:18432
    v_mul_f32 v133, v117, v133
    v_mfma_f32_16x16x32_bf16 v[60:63], v[192:195], a[188:191], v[60:63]
    v_mul_f32 v132, v132, v200
    v_mul_f32 v133, v133, v201
    v_mfma_f32_16x16x32_bf16 v[64:67], v[196:199], a[176:179], v[64:67]
    ds_read_b64_tr_b16 v[188:189], v4 offset:19456
    buffer_load_dwordx4 a[52:55], v1, s[20:23], s76 offen offset:3072 sc1
    v_mfma_f32_16x16x32_bf16 v[68:71], v[196:199], a[180:183], v[68:71]
    v_cvt_pk_bf16_f32 v212, v132, v133
    v_mul_f32 v202, s47, v118
    v_mfma_f32_16x16x32_bf16 v[72:75], v[196:199], a[184:187], v[72:75]
    ds_read_b64_tr_b16 v[190:191], v5 offset:19456
    v_mul_f32 v203, s47, v119
    v_mfma_f32_16x16x32_bf16 v[76:79], v[196:199], a[188:191], v[76:79]
    s_waitcnt vmcnt(16)
    s_barrier
    s_waitcnt lgkmcnt(4)
    v_mfma_f32_16x16x32_bf16 v[48:51], v[176:179], a[192:195], v[48:51]
    ds_read_b64_tr_b16 v[192:193], v4 offset:24576
    buffer_load_dwordx4 a[56:59], v1, s[20:23], s77 offen offset:3072 sc1
    v_mfma_f32_16x16x32_bf16 v[52:55], v[176:179], a[196:199], v[52:55]
    v_exp_f32 v202, v202
    v_mfma_f32_16x16x32_bf16 v[56:59], v[176:179], a[200:203], v[56:59]
    ds_read_b64_tr_b16 v[194:195], v5 offset:24576
    v_mfma_f32_16x16x32_bf16 v[60:63], v[176:179], a[204:207], v[60:63]
    v_exp_f32 v203, v203
    v_mfma_f32_16x16x32_bf16 v[64:67], v[180:183], a[192:195], v[64:67]
    ds_read_b64_tr_b16 v[196:197], v4 offset:25600
    v_mul_f32 v134, v118, v134
    v_mfma_f32_16x16x32_bf16 v[68:71], v[180:183], a[196:199], v[68:71]
    v_add_f32 v202, 1.0, v202
    v_add_f32 v203, 1.0, v203
    v_mfma_f32_16x16x32_bf16 v[72:75], v[180:183], a[200:203], v[72:75]
    ds_read_b64_tr_b16 v[198:199], v5 offset:25600
    v_mfma_f32_16x16x32_bf16 v[76:79], v[180:183], a[204:207], v[76:79]
    s_waitcnt lgkmcnt(4)
    v_mfma_f32_16x16x32_bf16 v[48:51], v[184:187], a[208:211], v[48:51]
    ds_read_b64_tr_b16 v[176:177], v4 offset:26624
    v_mfma_f32_16x16x32_bf16 v[52:55], v[184:187], a[212:215], v[52:55]
    v_rcp_f32 v202, v202
    v_mfma_f32_16x16x32_bf16 v[56:59], v[184:187], a[216:219], v[56:59]
    ds_read_b64_tr_b16 v[178:179], v5 offset:26624
    v_mfma_f32_16x16x32_bf16 v[60:63], v[184:187], a[220:223], v[60:63]
    v_rcp_f32 v203, v203
    v_mfma_f32_16x16x32_bf16 v[64:67], v[188:191], a[208:211], v[64:67]
    ds_read_b64_tr_b16 v[180:181], v4 offset:27648
    buffer_load_dwordx4 a[60:63], v1, s[20:23], s78 offen offset:3072 sc1
    v_mfma_f32_16x16x32_bf16 v[68:71], v[188:191], a[212:215], v[68:71]
    v_mul_f32 v135, v119, v135
    v_mul_f32 v134, v134, v202
    v_mfma_f32_16x16x32_bf16 v[72:75], v[188:191], a[216:219], v[72:75]
    ds_read_b64_tr_b16 v[182:183], v5 offset:27648
    v_mul_f32 v135, v135, v203
    v_mfma_f32_16x16x32_bf16 v[76:79], v[188:191], a[220:223], v[76:79]
    s_waitcnt vmcnt(14)
    s_barrier
    s_waitcnt lgkmcnt(4)
    v_mfma_f32_16x16x32_bf16 v[48:51], v[192:195], a[224:227], v[48:51]
    ds_read_b64_tr_b16 v[184:185], v4 offset:32768
    v_cvt_pk_bf16_f32 v213, v134, v135
    v_mfma_f32_16x16x32_bf16 v[52:55], v[192:195], a[228:231], v[52:55]
    s_add_u32 s75, s75, 4096
    s_add_u32 s76, s76, 4096
    v_mfma_f32_16x16x32_bf16 v[56:59], v[192:195], a[232:235], v[56:59]
    ds_read_b64_tr_b16 v[186:187], v5 offset:32768
    v_mul_f32 v204, s47, v148
    v_mfma_f32_16x16x32_bf16 v[60:63], v[192:195], a[236:239], v[60:63]
    v_mul_f32 v205, s47, v149
    v_mfma_f32_16x16x32_bf16 v[64:67], v[196:199], a[224:227], v[64:67]
    ds_read_b64_tr_b16 v[188:189], v4 offset:33792
    v_mfma_f32_16x16x32_bf16 v[68:71], v[196:199], a[228:231], v[68:71]
    v_exp_f32 v204, v204
    v_mfma_f32_16x16x32_bf16 v[72:75], v[196:199], a[232:235], v[72:75]
    ds_read_b64_tr_b16 v[190:191], v5 offset:33792
    v_mfma_f32_16x16x32_bf16 v[76:79], v[196:199], a[236:239], v[76:79]
    s_waitcnt lgkmcnt(4)
    v_mfma_f32_16x16x32_bf16 v[48:51], v[176:179], a[240:243], v[48:51]
    ds_read_b64_tr_b16 v[192:193], v4 offset:34816
    v_mfma_f32_16x16x32_bf16 v[52:55], v[176:179], a[244:247], v[52:55]
    v_exp_f32 v205, v205
    v_mfma_f32_16x16x32_bf16 v[56:59], v[176:179], a[248:251], v[56:59]
    ds_read_b64_tr_b16 v[194:195], v5 offset:34816
    v_mul_f32 v164, v148, v164
    v_mfma_f32_16x16x32_bf16 v[60:63], v[176:179], a[252:255], v[60:63]
    v_add_f32 v204, 1.0, v204
    v_add_f32 v205, 1.0, v205
    v_mfma_f32_16x16x32_bf16 v[64:67], v[180:183], a[240:243], v[64:67]
    ds_read_b64_tr_b16 v[196:197], v4 offset:35840
    v_mfma_f32_16x16x32_bf16 v[68:71], v[180:183], a[244:247], v[68:71]
    s_add_u32 s77, s77, 4096
    s_add_u32 s78, s78, 4096
    v_mfma_f32_16x16x32_bf16 v[72:75], v[180:183], a[248:251], v[72:75]
    ds_read_b64_tr_b16 v[198:199], v5 offset:35840
    v_mfma_f32_16x16x32_bf16 v[76:79], v[180:183], a[252:255], v[76:79]
    s_waitcnt lgkmcnt(4)
    v_mfma_f32_16x16x32_bf16 v[48:51], v[184:187], v[16:19], v[48:51]
    v_rcp_f32 v204, v204
    v_mfma_f32_16x16x32_bf16 v[52:55], v[184:187], v[20:23], v[52:55]
    v_rcp_f32 v205, v205
    v_mfma_f32_16x16x32_bf16 v[56:59], v[184:187], v[24:27], v[56:59]
    v_mul_f32 v165, v149, v165
    v_mul_f32 v164, v164, v204
    v_mfma_f32_16x16x32_bf16 v[60:63], v[184:187], v[28:31], v[60:63]
    v_mul_f32 v165, v165, v205
    v_cvt_pk_bf16_f32 v214, v164, v165
    v_mfma_f32_16x16x32_bf16 v[64:67], v[188:191], v[16:19], v[64:67]
    v_mul_f32 v206, s47, v150
    v_mul_f32 v207, s47, v151
    v_mfma_f32_16x16x32_bf16 v[68:71], v[188:191], v[20:23], v[68:71]
    v_exp_f32 v206, v206
    v_mfma_f32_16x16x32_bf16 v[72:75], v[188:191], v[24:27], v[72:75]
    v_exp_f32 v207, v207
    v_mfma_f32_16x16x32_bf16 v[76:79], v[188:191], v[28:31], v[76:79]
    v_mul_f32 v166, v150, v166
    s_waitcnt lgkmcnt(0)
    v_mfma_f32_16x16x32_bf16 v[48:51], v[192:195], v[32:35], v[48:51]
    v_add_f32 v206, 1.0, v206
    v_add_f32 v207, 1.0, v207
    v_mfma_f32_16x16x32_bf16 v[52:55], v[192:195], v[36:39], v[52:55]
    v_rcp_f32 v206, v206
    v_mfma_f32_16x16x32_bf16 v[56:59], v[192:195], v[40:43], v[56:59]
    v_rcp_f32 v207, v207
    v_mfma_f32_16x16x32_bf16 v[60:63], v[192:195], v[44:47], v[60:63]
    v_mul_f32 v167, v151, v167
    v_mul_f32 v166, v166, v206
    v_mfma_f32_16x16x32_bf16 v[64:67], v[196:199], v[32:35], v[64:67]
    v_mul_f32 v167, v167, v207
    v_cvt_pk_bf16_f32 v215, v166, v167
    v_mfma_f32_16x16x32_bf16 v[68:71], v[196:199], v[36:39], v[68:71]
    s_add_u32 s49, s79, 22528
    buffer_store_dwordx4 v[212:215], v1, s[20:23], s49 offen sc1
    v_mul_f32 v200, s47, v120
    v_mul_f32 v201, s47, v121
    v_exp_f32 v200, v200
    v_exp_f32 v201, v201
    v_mul_f32 v136, v120, v136
    v_add_f32 v200, 1.0, v200
    v_add_f32 v201, 1.0, v201
    v_rcp_f32 v200, v200
    v_rcp_f32 v201, v201
    v_mul_f32 v137, v121, v137
    v_mul_f32 v136, v136, v200
    v_mul_f32 v137, v137, v201
    v_cvt_pk_bf16_f32 v208, v136, v137
    v_mul_f32 v202, s47, v122
    v_mul_f32 v203, s47, v123
    v_exp_f32 v202, v202
    v_exp_f32 v203, v203
    v_mul_f32 v138, v122, v138
    v_add_f32 v202, 1.0, v202
    v_add_f32 v203, 1.0, v203
    v_rcp_f32 v202, v202
    v_rcp_f32 v203, v203
    v_mul_f32 v139, v123, v139
    v_mul_f32 v138, v138, v202
    v_mul_f32 v139, v139, v203
    v_cvt_pk_bf16_f32 v209, v138, v139
    v_mul_f32 v204, s47, v152
    v_mul_f32 v205, s47, v153
    v_exp_f32 v204, v204
    v_exp_f32 v205, v205
    v_mul_f32 v168, v152, v168
    v_add_f32 v204, 1.0, v204
    v_add_f32 v205, 1.0, v205
    v_rcp_f32 v204, v204
    v_rcp_f32 v205, v205
    v_mul_f32 v169, v153, v169
    v_mul_f32 v168, v168, v204
    v_mul_f32 v169, v169, v205
    v_cvt_pk_bf16_f32 v210, v168, v169
    v_mul_f32 v206, s47, v154
    v_mul_f32 v207, s47, v155
    v_exp_f32 v206, v206
    v_exp_f32 v207, v207
    v_mul_f32 v170, v154, v170
    v_add_f32 v206, 1.0, v206
    v_add_f32 v207, 1.0, v207
    v_rcp_f32 v206, v206
    v_rcp_f32 v207, v207
    v_mul_f32 v171, v155, v171
    v_mul_f32 v170, v170, v206
    v_mul_f32 v171, v171, v207
    v_cvt_pk_bf16_f32 v211, v170, v171
    s_add_u32 s49, s79, 40960
    buffer_store_dwordx4 v[208:211], v1, s[20:23], s49 offen sc1
    v_mul_f32 v200, s47, v124
    v_mul_f32 v201, s47, v125
    v_exp_f32 v200, v200
    v_exp_f32 v201, v201
    v_mul_f32 v140, v124, v140
    v_add_f32 v200, 1.0, v200
    v_add_f32 v201, 1.0, v201
    v_rcp_f32 v200, v200
    v_rcp_f32 v201, v201
    v_mul_f32 v141, v125, v141
    v_mul_f32 v140, v140, v200
    v_mul_f32 v141, v141, v201
    v_cvt_pk_bf16_f32 v212, v140, v141
    v_mul_f32 v202, s47, v126
    v_mul_f32 v203, s47, v127
    v_exp_f32 v202, v202
    v_exp_f32 v203, v203
    v_mul_f32 v142, v126, v142
    v_add_f32 v202, 1.0, v202
    v_add_f32 v203, 1.0, v203
    v_rcp_f32 v202, v202
    v_rcp_f32 v203, v203
    v_mul_f32 v143, v127, v143
    v_mul_f32 v142, v142, v202
    v_mul_f32 v143, v143, v203
    v_cvt_pk_bf16_f32 v213, v142, v143
    v_mul_f32 v204, s47, v156
    v_mul_f32 v205, s47, v157
    v_exp_f32 v204, v204
    v_exp_f32 v205, v205
    v_mul_f32 v172, v156, v172
    v_add_f32 v204, 1.0, v204
    v_add_f32 v205, 1.0, v205
    v_rcp_f32 v204, v204
    v_rcp_f32 v205, v205
    v_mul_f32 v173, v157, v173
    v_mul_f32 v172, v172, v204
    v_mul_f32 v173, v173, v205
    v_cvt_pk_bf16_f32 v214, v172, v173
    v_mul_f32 v206, s47, v158
    v_mul_f32 v207, s47, v159
    v_exp_f32 v206, v206
    v_exp_f32 v207, v207
    v_mul_f32 v174, v158, v174
    v_add_f32 v206, 1.0, v206
    v_add_f32 v207, 1.0, v207
    v_rcp_f32 v206, v206
    v_rcp_f32 v207, v207
    v_mul_f32 v175, v159, v175
    v_mul_f32 v174, v174, v206
    v_mul_f32 v175, v175, v207
    v_cvt_pk_bf16_f32 v215, v174, v175
    s_add_u32 s49, s79, 59392
    buffer_store_dwordx4 v[212:215], v1, s[20:23], s49 offen sc1
    v_mfma_f32_16x16x32_bf16 v[72:75], v[196:199], v[40:43], v[72:75]
    v_mfma_f32_16x16x32_bf16 v[76:79], v[196:199], v[44:47], v[76:79]
    s_barrier
    s_nop 4
    v_mul_f32 v200, s47, v48
    v_mul_f32 v201, s47, v49
    v_exp_f32 v200, v200
    v_exp_f32 v201, v201
    v_mul_f32 v64, v48, v64
    v_add_f32 v200, 1.0, v200
    v_add_f32 v201, 1.0, v201
    v_rcp_f32 v200, v200
    v_rcp_f32 v201, v201
    v_mul_f32 v65, v49, v65
    v_mul_f32 v64, v64, v200
    v_mul_f32 v65, v65, v201
    v_cvt_pk_bf16_f32 v208, v64, v65
    v_mul_f32 v202, s47, v50
    v_mul_f32 v203, s47, v51
    v_exp_f32 v202, v202
    v_exp_f32 v203, v203
    v_mul_f32 v66, v50, v66
    v_add_f32 v202, 1.0, v202
    v_add_f32 v203, 1.0, v203
    v_rcp_f32 v202, v202
    v_rcp_f32 v203, v203
    v_mul_f32 v67, v51, v67
    v_mul_f32 v66, v66, v202
    v_mul_f32 v67, v67, v203
    v_cvt_pk_bf16_f32 v209, v66, v67
    s_add_u32 s49, s101, 0
    buffer_store_dwordx2 v[208:209], v1, s[20:23], s49 offen sc1
    v_mul_f32 v204, s47, v52
    v_mul_f32 v205, s47, v53
    v_exp_f32 v204, v204
    v_exp_f32 v205, v205
    v_mul_f32 v68, v52, v68
    v_add_f32 v204, 1.0, v204
    v_add_f32 v205, 1.0, v205
    v_rcp_f32 v204, v204
    v_rcp_f32 v205, v205
    v_mul_f32 v69, v53, v69
    v_mul_f32 v68, v68, v204
    v_mul_f32 v69, v69, v205
    v_cvt_pk_bf16_f32 v212, v68, v69
    v_mul_f32 v206, s47, v54
    v_mul_f32 v207, s47, v55
    v_exp_f32 v206, v206
    v_exp_f32 v207, v207
    v_mul_f32 v70, v54, v70
    v_add_f32 v206, 1.0, v206
    v_add_f32 v207, 1.0, v207
    v_rcp_f32 v206, v206
    v_rcp_f32 v207, v207
    v_mul_f32 v71, v55, v71
    v_mul_f32 v70, v70, v206
    v_mul_f32 v71, v71, v207
    v_cvt_pk_bf16_f32 v213, v70, v71
    s_add_u32 s49, s101, 18432
    buffer_store_dwordx2 v[212:213], v1, s[20:23], s49 offen sc1
    v_mul_f32 v200, s47, v56
    v_mul_f32 v201, s47, v57
    v_exp_f32 v200, v200
    v_exp_f32 v201, v201
    v_mul_f32 v72, v56, v72
    v_add_f32 v200, 1.0, v200
    v_add_f32 v201, 1.0, v201
    v_rcp_f32 v200, v200
    v_rcp_f32 v201, v201
    v_mul_f32 v73, v57, v73
    v_mul_f32 v72, v72, v200
    v_mul_f32 v73, v73, v201
    v_cvt_pk_bf16_f32 v208, v72, v73
    v_mul_f32 v202, s47, v58
    v_mul_f32 v203, s47, v59
    v_exp_f32 v202, v202
    v_exp_f32 v203, v203
    v_mul_f32 v74, v58, v74
    v_add_f32 v202, 1.0, v202
    v_add_f32 v203, 1.0, v203
    v_rcp_f32 v202, v202
    v_rcp_f32 v203, v203
    v_mul_f32 v75, v59, v75
    v_mul_f32 v74, v74, v202
    v_mul_f32 v75, v75, v203
    v_cvt_pk_bf16_f32 v209, v74, v75
    s_add_u32 s49, s101, 36864
    buffer_store_dwordx2 v[208:209], v1, s[20:23], s49 offen sc1
    v_mul_f32 v204, s47, v60
    v_mul_f32 v205, s47, v61
    v_exp_f32 v204, v204
    v_exp_f32 v205, v205
    v_mul_f32 v76, v60, v76
    v_add_f32 v204, 1.0, v204
    v_add_f32 v205, 1.0, v205
    v_rcp_f32 v204, v204
    v_rcp_f32 v205, v205
    v_mul_f32 v77, v61, v77
    v_mul_f32 v76, v76, v204
    v_mul_f32 v77, v77, v205
    v_cvt_pk_bf16_f32 v212, v76, v77
    v_mul_f32 v206, s47, v62
    v_mul_f32 v207, s47, v63
    v_exp_f32 v206, v206
    v_exp_f32 v207, v207
    v_mul_f32 v78, v62, v78
    v_add_f32 v206, 1.0, v206
    v_add_f32 v207, 1.0, v207
    v_rcp_f32 v206, v206
    v_rcp_f32 v207, v207
    v_mul_f32 v79, v63, v79
    v_mul_f32 v78, v78, v206
    v_mul_f32 v79, v79, v207
    v_cvt_pk_bf16_f32 v213, v78, v79
    s_add_u32 s49, s101, 55296
    buffer_store_dwordx2 v[212:213], v1, s[20:23], s49 offen sc1
    s_add_u32 s28, s4, 30744576
    s_addc_u32 s29, s5, 0
    s_mov_b32 s30, 9437184
    s_mov_b32 s31, 0x00020000
    s_load_dwordx2 s[6:7], s[0:1], 0
    s_load_dwordx2 s[8:9], s[0:1], 88
    s_waitcnt vmcnt(23) lgkmcnt(0)
    s_barrier
    s_mov_b32 s12, s6
    s_mov_b32 s13, s7
    s_mov_b32 s14, 2359296
    s_mov_b32 s15, 0x00020000
    s_mov_b32 s16, s8
    s_mov_b32 s17, s9
    s_mov_b32 s18, 2359296
    s_mov_b32 s19, 0x00020000
    ds_read_b64_tr_b16 v[120:121], v226 offset:4096
    ds_read_b64_tr_b16 v[122:123], v226 offset:8704
    ds_read_b64_tr_b16 v[124:125], v226 offset:4128
    ds_read_b64_tr_b16 v[126:127], v226 offset:8736
    ds_read_b64_tr_b16 v[128:129], v226 offset:4160
    ds_read_b64_tr_b16 v[130:131], v226 offset:8768
    ds_read_b64_tr_b16 v[132:133], v226 offset:4192
    ds_read_b64_tr_b16 v[134:135], v226 offset:8800
    ds_read_b64_tr_b16 v[136:137], v226 offset:4224
    ds_read_b64_tr_b16 v[138:139], v226 offset:8832
    ds_read_b64_tr_b16 v[140:141], v226 offset:4256
    ds_read_b64_tr_b16 v[142:143], v226 offset:8864
    s_waitcnt vmcnt(23)
    s_waitcnt lgkmcnt(6)
    v_mfma_f32_16x16x32_bf16 v[48:51], v[120:123], a[0:3], 0
    ds_read_b64_tr_b16 v[144:145], v226 offset:4288
    v_mfma_f32_16x16x32_bf16 v[52:55], v[120:123], a[4:7], 0
    ds_read_b64_tr_b16 v[146:147], v226 offset:8896
    s_mov_b32 s59, 331776
    s_cmp_lt_u32 s3, 2
    s_cselect_b32 s59, s59, 368640
    s_add_u32 s59, s59, s46
    v_mfma_f32_16x16x32_bf16 v[56:59], v[124:127], a[0:3], 0
    ds_read_b64_tr_b16 v[148:149], v226 offset:4320
    buffer_load_dwordx4 a[64:67], v1, s[20:23], s75 offen offset:0 sc1
    v_mfma_f32_16x16x32_bf16 v[60:63], v[124:127], a[4:7], 0
    ds_read_b64_tr_b16 v[150:151], v226 offset:8928
    v_mfma_f32_16x16x32_bf16 v[64:67], v[128:131], a[0:3], 0
    ds_read_b64_tr_b16 v[120:121], v226 offset:4352
    v_mfma_f32_16x16x32_bf16 v[68:71], v[128:131], a[4:7], 0
    ds_read_b64_tr_b16 v[122:123], v226 offset:8960
    s_waitcnt lgkmcnt(6)
    v_mfma_f32_16x16x32_bf16 v[72:75], v[132:135], a[0:3], 0
    ds_read_b64_tr_b16 v[124:125], v226 offset:13312
    v_mfma_f32_16x16x32_bf16 v[76:79], v[132:135], a[4:7], 0
    ds_read_b64_tr_b16 v[126:127], v226 offset:17920
    v_mfma_f32_16x16x32_bf16 v[80:83], v[136:139], a[0:3], 0
    ds_read_b64_tr_b16 v[128:129], v226 offset:13344
    s_add_u32 m0, s56, 0
    v_mfma_f32_16x16x32_bf16 v[84:87], v[136:139], a[4:7], 0
    ds_read_b64_tr_b16 v[130:131], v226 offset:17952
    v_mfma_f32_16x16x32_bf16 v[88:91], v[140:143], a[0:3], 0
    ds_read_b64_tr_b16 v[132:133], v226 offset:13376
    buffer_load_dwordx4 a[68:71], v1, s[20:23], s76 offen offset:0 sc1
    v_mfma_f32_16x16x32_bf16 v[92:95], v[140:143], a[4:7], 0
    ds_read_b64_tr_b16 v[134:135], v226 offset:17984
    s_waitcnt lgkmcnt(6)
    v_mfma_f32_16x16x32_bf16 v[96:99], v[144:147], a[0:3], 0
    ds_read_b64_tr_b16 v[136:137], v226 offset:13408
    buffer_load_dwordx4 v216, s[24:27], s59 offen lds
    v_mfma_f32_16x16x32_bf16 v[100:103], v[144:147], a[4:7], 0
    ds_read_b64_tr_b16 v[138:139], v226 offset:18016
    s_add_u32 m0, s56, 1024
    v_mfma_f32_16x16x32_bf16 v[104:107], v[148:151], a[0:3], 0
    ds_read_b64_tr_b16 v[140:141], v226 offset:13440
    v_mfma_f32_16x16x32_bf16 v[108:111], v[148:151], a[4:7], 0
    ds_read_b64_tr_b16 v[142:143], v226 offset:18048
    v_mfma_f32_16x16x32_bf16 v[112:115], v[120:123], a[0:3], 0
    ds_read_b64_tr_b16 v[144:145], v226 offset:13472
    buffer_load_dwordx4 v217, s[24:27], s59 offen lds
    v_mfma_f32_16x16x32_bf16 v[116:119], v[120:123], a[4:7], 0
    ds_read_b64_tr_b16 v[146:147], v226 offset:18080
    s_waitcnt vmcnt(24)
    s_waitcnt lgkmcnt(6)
    v_mfma_f32_16x16x32_bf16 v[48:51], v[124:127], a[8:11], v[48:51]
    ds_read_b64_tr_b16 v[148:149], v226 offset:13504
    s_add_u32 m0, s56, 2048
    v_mfma_f32_16x16x32_bf16 v[52:55], v[124:127], a[12:15], v[52:55]
    ds_read_b64_tr_b16 v[150:151], v226 offset:18112
    v_mfma_f32_16x16x32_bf16 v[56:59], v[128:131], a[8:11], v[56:59]
    ds_read_b64_tr_b16 v[120:121], v226 offset:13536
    buffer_load_dwordx4 a[72:75], v1, s[20:23], s77 offen offset:0 sc1
    v_mfma_f32_16x16x32_bf16 v[60:63], v[128:131], a[12:15], v[60:63]
    ds_read_b64_tr_b16 v[122:123], v226 offset:18144
    buffer_load_dwordx4 v218, s[24:27], s59 offen lds
    v_mfma_f32_16x16x32_bf16 v[64:67], v[132:135], a[8:11], v[64:67]
    ds_read_b64_tr_b16 v[124:125], v226 offset:13568
    v_mfma_f32_16x16x32_bf16 v[68:71], v[132:135], a[12:15], v[68:71]
    ds_read_b64_tr_b16 v[126:127], v226 offset:18176
    s_waitcnt lgkmcnt(6)
    v_mfma_f32_16x16x32_bf16 v[72:75], v[136:139], a[8:11], v[72:75]
    ds_read_b64_tr_b16 v[128:129], v226 offset:22528
    s_add_u32 m0, s56, 3072
    v_mfma_f32_16x16x32_bf16 v[76:79], v[136:139], a[12:15], v[76:79]
    ds_read_b64_tr_b16 v[130:131], v226 offset:27136
    v_mfma_f32_16x16x32_bf16 v[80:83], v[140:143], a[8:11], v[80:83]
    ds_read_b64_tr_b16 v[132:133], v226 offset:22560
    buffer_load_dwordx4 v219, s[24:27], s59 offen lds
    v_mfma_f32_16x16x32_bf16 v[84:87], v[140:143], a[12:15], v[84:87]
    ds_read_b64_tr_b16 v[134:135], v226 offset:27168
    v_mfma_f32_16x16x32_bf16 v[88:91], v[144:147], a[8:11], v[88:91]
    ds_read_b64_tr_b16 v[136:137], v226 offset:22592
    s_add_u32 m0, s56, 4096
    v_mfma_f32_16x16x32_bf16 v[92:95], v[144:147], a[12:15], v[92:95]
    ds_read_b64_tr_b16 v[138:139], v226 offset:27200
    s_waitcnt lgkmcnt(6)
    v_mfma_f32_16x16x32_bf16 v[96:99], v[148:151], a[8:11], v[96:99]
    ds_read_b64_tr_b16 v[140:141], v226 offset:22624
    buffer_load_dwordx4 a[76:79], v1, s[20:23], s78 offen offset:0 sc1
    v_mfma_f32_16x16x32_bf16 v[100:103], v[148:151], a[12:15], v[100:103]
    ds_read_b64_tr_b16 v[142:143], v226 offset:27232
    buffer_load_dwordx4 v220, s[24:27], s59 offen lds
    v_mfma_f32_16x16x32_bf16 v[104:107], v[120:123], a[8:11], v[104:107]
    ds_read_b64_tr_b16 v[144:145], v226 offset:22656
    v_mfma_f32_16x16x32_bf16 v[108:111], v[120:123], a[12:15], v[108:111]
    ds_read_b64_tr_b16 v[146:147], v226 offset:27264
    s_add_u32 m0, s56, 5120
    v_mfma_f32_16x16x32_bf16 v[112:115], v[124:127], a[8:11], v[112:115]
    ds_read_b64_tr_b16 v[148:149], v226 offset:22688
    v_mfma_f32_16x16x32_bf16 v[116:119], v[124:127], a[12:15], v[116:119]
    ds_read_b64_tr_b16 v[150:151], v226 offset:27296
    s_waitcnt vmcnt(27)
    s_waitcnt lgkmcnt(6)
    v_mfma_f32_16x16x32_bf16 v[48:51], v[128:131], a[16:19], v[48:51]
    ds_read_b64_tr_b16 v[120:121], v226 offset:22720
    buffer_load_dwordx4 v221, s[24:27], s59 offen lds
    v_mfma_f32_16x16x32_bf16 v[52:55], v[128:131], a[20:23], v[52:55]
    ds_read_b64_tr_b16 v[122:123], v226 offset:27328
    v_mfma_f32_16x16x32_bf16 v[56:59], v[132:135], a[16:19], v[56:59]
    ds_read_b64_tr_b16 v[124:125], v226 offset:22752
    s_add_u32 m0, s56, 6144
    v_mfma_f32_16x16x32_bf16 v[60:63], v[132:135], a[20:23], v[60:63]
    ds_read_b64_tr_b16 v[126:127], v226 offset:27360
    buffer_load_dwordx4 a[80:83], v1, s[20:23], s75 offen offset:1024 sc1
    v_mfma_f32_16x16x32_bf16 v[64:67], v[136:139], a[16:19], v[64:67]
    ds_read_b64_tr_b16 v[128:129], v226 offset:22784
    v_mfma_f32_16x16x32_bf16 v[68:71], v[136:139], a[20:23], v[68:71]
    ds_read_b64_tr_b16 v[130:131], v226 offset:27392
    s_waitcnt lgkmcnt(6)
    v_mfma_f32_16x16x32_bf16 v[72:75], v[140:143], a[16:19], v[72:75]
    ds_read_b64_tr_b16 v[132:133], v226 offset:31744
    buffer_load_dwordx4 v222, s[24:27], s59 offen lds
    v_mfma_f32_16x16x32_bf16 v[76:79], v[140:143], a[20:23], v[76:79]
    ds_read_b64_tr_b16 v[134:135], v226 offset:36352
    s_add_u32 m0, s56, 7168
    v_mfma_f32_16x16x32_bf16 v[80:83], v[144:147], a[16:19], v[80:83]
    ds_read_b64_tr_b16 v[136:137], v226 offset:31776
    v_mfma_f32_16x16x32_bf16 v[84:87], v[144:147], a[20:23], v[84:87]
    ds_read_b64_tr_b16 v[138:139], v226 offset:36384
    v_mfma_f32_16x16x32_bf16 v[88:91], v[148:151], a[16:19], v[88:91]
    ds_read_b64_tr_b16 v[140:141], v226 offset:31808
    buffer_load_dwordx4 v223, s[24:27], s59 offen lds
    v_mfma_f32_16x16x32_bf16 v[92:95], v[148:151], a[20:23], v[92:95]
    ds_read_b64_tr_b16 v[142:143], v226 offset:36416
    s_waitcnt lgkmcnt(6)
    v_mfma_f32_16x16x32_bf16 v[96:99], v[120:123], a[16:19], v[96:99]
    ds_read_b64_tr_b16 v[144:145], v226 offset:31840
    s_add_u32 m0, s56, 8192
    v_mfma_f32_16x16x32_bf16 v[100:103], v[120:123], a[20:23], v[100:103]
    ds_read_b64_tr_b16 v[146:147], v226 offset:36448
    buffer_load_dwordx4 a[84:87], v1, s[20:23], s76 offen offset:1024 sc1
    v_mfma_f32_16x16x32_bf16 v[104:107], v[124:127], a[16:19], v[104:107]
    ds_read_b64_tr_b16 v[148:149], v226 offset:31872
    v_mfma_f32_16x16x32_bf16 v[108:111], v[124:127], a[20:23], v[108:111]
    ds_read_b64_tr_b16 v[150:151], v226 offset:36480
    buffer_load_dwordx4 v224, s[24:27], s59 offen lds
    v_mfma_f32_16x16x32_bf16 v[112:115], v[128:131], a[16:19], v[112:115]
    ds_read_b64_tr_b16 v[120:121], v226 offset:31904
    v_mfma_f32_16x16x32_bf16 v[116:119], v[128:131], a[20:23], v[116:119]
    ds_read_b64_tr_b16 v[122:123], v226 offset:36512
    s_waitcnt vmcnt(31)
    s_waitcnt lgkmcnt(6)
    buffer_load_dword v14, off, s[36:39], s52 sc1
    v_mfma_f32_16x16x32_bf16 v[48:51], v[132:135], a[24:27], v[48:51]
    ds_read_b64_tr_b16 v[124:125], v226 offset:31936
    v_mfma_f32_16x16x32_bf16 v[52:55], v[132:135], a[28:31], v[52:55]
    ds_read_b64_tr_b16 v[126:127], v226 offset:36544
    v_mfma_f32_16x16x32_bf16 v[56:59], v[136:139], a[24:27], v[56:59]
    ds_read_b64_tr_b16 v[128:129], v226 offset:31968
    buffer_load_dwordx4 a[88:91], v1, s[20:23], s77 offen offset:1024 sc1
    v_mfma_f32_16x16x32_bf16 v[60:63], v[136:139], a[28:31], v[60:63]
    ds_read_b64_tr_b16 v[130:131], v226 offset:36576
    v_mfma_f32_16x16x32_bf16 v[64:67], v[140:143], a[24:27], v[64:67]
    ds_read_b64_tr_b16 v[132:133], v226 offset:32000
    v_mfma_f32_16x16x32_bf16 v[68:71], v[140:143], a[28:31], v[68:71]
    ds_read_b64_tr_b16 v[134:135], v226 offset:36608
    s_waitcnt lgkmcnt(6)
    v_mfma_f32_16x16x32_bf16 v[72:75], v[144:147], a[24:27], v[72:75]
    ds_read_b64_tr_b16 v[136:137], v226 offset:40960
    v_mfma_f32_16x16x32_bf16 v[76:79], v[144:147], a[28:31], v[76:79]
    ds_read_b64_tr_b16 v[138:139], v226 offset:45568
    v_mfma_f32_16x16x32_bf16 v[80:83], v[148:151], a[24:27], v[80:83]
    ds_read_b64_tr_b16 v[140:141], v226 offset:40992
    v_mfma_f32_16x16x32_bf16 v[84:87], v[148:151], a[28:31], v[84:87]
    ds_read_b64_tr_b16 v[142:143], v226 offset:45600
    v_mfma_f32_16x16x32_bf16 v[88:91], v[120:123], a[24:27], v[88:91]
    ds_read_b64_tr_b16 v[144:145], v226 offset:41024
    buffer_load_dwordx4 a[92:95], v1, s[20:23], s78 offen offset:1024 sc1
    v_mfma_f32_16x16x32_bf16 v[92:95], v[120:123], a[28:31], v[92:95]
    ds_read_b64_tr_b16 v[146:147], v226 offset:45632
    s_waitcnt lgkmcnt(6)
    v_mfma_f32_16x16x32_bf16 v[96:99], v[124:127], a[24:27], v[96:99]
    ds_read_b64_tr_b16 v[148:149], v226 offset:41056
    v_mfma_f32_16x16x32_bf16 v[100:103], v[124:127], a[28:31], v[100:103]
    ds_read_b64_tr_b16 v[150:151], v226 offset:45664
    v_mfma_f32_16x16x32_bf16 v[104:107], v[128:131], a[24:27], v[104:107]
    ds_read_b64_tr_b16 v[120:121], v226 offset:41088
    v_mfma_f32_16x16x32_bf16 v[108:111], v[128:131], a[28:31], v[108:111]
    ds_read_b64_tr_b16 v[122:123], v226 offset:45696
    v_mfma_f32_16x16x32_bf16 v[112:115], v[132:135], a[24:27], v[112:115]
    ds_read_b64_tr_b16 v[124:125], v226 offset:41120
    v_mfma_f32_16x16x32_bf16 v[116:119], v[132:135], a[28:31], v[116:119]
    ds_read_b64_tr_b16 v[126:127], v226 offset:45728
    s_waitcnt vmcnt(32)
    s_waitcnt lgkmcnt(6)
    v_mfma_f32_16x16x32_bf16 v[48:51], v[136:139], a[32:35], v[48:51]
    ds_read_b64_tr_b16 v[128:129], v226 offset:41152
    v_mfma_f32_16x16x32_bf16 v[52:55], v[136:139], a[36:39], v[52:55]
    ds_read_b64_tr_b16 v[130:131], v226 offset:45760
    s_mov_b32 s59, 516096
    s_cmp_lt_u32 s3, 2
    s_cselect_b32 s59, s59, 552960
    s_add_u32 s59, s59, s46
    v_mfma_f32_16x16x32_bf16 v[56:59], v[140:143], a[32:35], v[56:59]
    ds_read_b64_tr_b16 v[132:133], v226 offset:41184
    buffer_load_dwordx4 a[96:99], v1, s[20:23], s75 offen offset:2048 sc1
    v_mfma_f32_16x16x32_bf16 v[60:63], v[140:143], a[36:39], v[60:63]
    ds_read_b64_tr_b16 v[134:135], v226 offset:45792
    v_mfma_f32_16x16x32_bf16 v[64:67], v[144:147], a[32:35], v[64:67]
    ds_read_b64_tr_b16 v[136:137], v226 offset:41216
    v_mfma_f32_16x16x32_bf16 v[68:71], v[144:147], a[36:39], v[68:71]
    ds_read_b64_tr_b16 v[138:139], v226 offset:45824
    s_waitcnt lgkmcnt(6)
    v_mfma_f32_16x16x32_bf16 v[72:75], v[148:151], a[32:35], v[72:75]
    ds_read_b64_tr_b16 v[140:141], v226 offset:50176
    v_mfma_f32_16x16x32_bf16 v[76:79], v[148:151], a[36:39], v[76:79]
    ds_read_b64_tr_b16 v[142:143], v226 offset:54784
    v_mfma_f32_16x16x32_bf16 v[80:83], v[120:123], a[32:35], v[80:83]
    ds_read_b64_tr_b16 v[144:145], v226 offset:50208
    s_add_u32 m0, s57, 0
    v_mfma_f32_16x16x32_bf16 v[84:87], v[120:123], a[36:39], v[84:87]
    ds_read_b64_tr_b16 v[146:147], v226 offset:54816
    v_mfma_f32_16x16x32_bf16 v[88:91], v[124:127], a[32:35], v[88:91]
    ds_read_b64_tr_b16 v[148:149], v226 offset:50240
    buffer_load_dwordx4 a[100:103], v1, s[20:23], s76 offen offset:2048 sc1
    v_mfma_f32_16x16x32_bf16 v[92:95], v[124:127], a[36:39], v[92:95]
    ds_read_b64_tr_b16 v[150:151], v226 offset:54848
    s_waitcnt lgkmcnt(6)
    v_mfma_f32_16x16x32_bf16 v[96:99], v[128:131], a[32:35], v[96:99]
    ds_read_b64_tr_b16 v[120:121], v226 offset:50272
    buffer_load_dwordx4 v216, s[24:27], s59 offen lds
    v_mfma_f32_16x16x32_bf16 v[100:103], v[128:131], a[36:39], v[100:103]
    ds_read_b64_tr_b16 v[122:123], v226 offset:54880
    s_add_u32 m0, s57, 1024
    v_mfma_f32_16x16x32_bf16 v[104:107], v[132:135], a[32:35], v[104:107]
    ds_read_b64_tr_b16 v[124:125], v226 offset:50304
    v_mfma_f32_16x16x32_bf16 v[108:111], v[132:135], a[36:39], v[108:111]
    ds_read_b64_tr_b16 v[126:127], v226 offset:54912
    v_mfma_f32_16x16x32_bf16 v[112:115], v[136:139], a[32:35], v[112:115]
    ds_read_b64_tr_b16 v[128:129], v226 offset:50336
    buffer_load_dwordx4 v217, s[24:27], s59 offen lds
    v_mfma_f32_16x16x32_bf16 v[116:119], v[136:139], a[36:39], v[116:119]
    ds_read_b64_tr_b16 v[130:131], v226 offset:54944
    s_waitcnt vmcnt(33)
    s_waitcnt lgkmcnt(6)
    v_mfma_f32_16x16x32_bf16 v[48:51], v[140:143], a[40:43], v[48:51]
    ds_read_b64_tr_b16 v[132:133], v226 offset:50368
    s_add_u32 m0, s57, 2048
    v_mfma_f32_16x16x32_bf16 v[52:55], v[140:143], a[44:47], v[52:55]
    ds_read_b64_tr_b16 v[134:135], v226 offset:54976
    v_mfma_f32_16x16x32_bf16 v[56:59], v[144:147], a[40:43], v[56:59]
    ds_read_b64_tr_b16 v[136:137], v226 offset:50400
    buffer_load_dwordx4 a[104:107], v1, s[20:23], s77 offen offset:2048 sc1
    v_mfma_f32_16x16x32_bf16 v[60:63], v[144:147], a[44:47], v[60:63]
    ds_read_b64_tr_b16 v[138:139], v226 offset:55008
    buffer_load_dwordx4 v218, s[24:27], s59 offen lds
    v_mfma_f32_16x16x32_bf16 v[64:67], v[148:151], a[40:43], v[64:67]
    ds_read_b64_tr_b16 v[140:141], v226 offset:50432
    v_mfma_f32_16x16x32_bf16 v[68:71], v[148:151], a[44:47], v[68:71]
    ds_read_b64_tr_b16 v[142:143], v226 offset:55040
    s_waitcnt lgkmcnt(6)
    v_mfma_f32_16x16x32_bf16 v[72:75], v[120:123], a[40:43], v[72:75]
    ds_read_b64_tr_b16 v[144:145], v226 offset:59392
    s_add_u32 m0, s57, 3072
    v_mfma_f32_16x16x32_bf16 v[76:79], v[120:123], a[44:47], v[76:79]
    ds_read_b64_tr_b16 v[146:147], v226 offset:64000
    v_mfma_f32_16x16x32_bf16 v[80:83], v[124:127], a[40:43], v[80:83]
    ds_read_b64_tr_b16 v[148:149], v226 offset:59424
    buffer_load_dwordx4 v219, s[24:27], s59 offen lds
    v_mfma_f32_16x16x32_bf16 v[84:87], v[124:127], a[44:47], v[84:87]
    ds_read_b64_tr_b16 v[150:151], v226 offset:64032
    v_mfma_f32_16x16x32_bf16 v[88:91], v[128:131], a[40:43], v[88:91]
    ds_read_b64_tr_b16 v[120:121], v226 offset:59456
    s_add_u32 m0, s57, 4096
    v_mfma_f32_16x16x32_bf16 v[92:95], v[128:131], a[44:47], v[92:95]
    ds_read_b64_tr_b16 v[122:123], v226 offset:64064
    s_waitcnt lgkmcnt(6)
    v_mfma_f32_16x16x32_bf16 v[96:99], v[132:135], a[40:43], v[96:99]
    ds_read_b64_tr_b16 v[124:125], v226 offset:59488
    buffer_load_dwordx4 a[108:111], v1, s[20:23], s78 offen offset:2048 sc1
    v_mfma_f32_16x16x32_bf16 v[100:103], v[132:135], a[44:47], v[100:103]
    ds_read_b64_tr_b16 v[126:127], v226 offset:64096
    buffer_load_dwordx4 v220, s[24:27], s59 offen lds
    v_mfma_f32_16x16x32_bf16 v[104:107], v[136:139], a[40:43], v[104:107]
    ds_read_b64_tr_b16 v[128:129], v226 offset:59520
    v_mfma_f32_16x16x32_bf16 v[108:111], v[136:139], a[44:47], v[108:111]
    ds_read_b64_tr_b16 v[130:131], v226 offset:64128
    s_add_u32 m0, s57, 5120
    v_mfma_f32_16x16x32_bf16 v[112:115], v[140:143], a[40:43], v[112:115]
    ds_read_b64_tr_b16 v[132:133], v226 offset:59552
    v_mfma_f32_16x16x32_bf16 v[116:119], v[140:143], a[44:47], v[116:119]
    ds_read_b64_tr_b16 v[134:135], v226 offset:64160
    s_waitcnt vmcnt(36)
    s_waitcnt lgkmcnt(6)
    v_mfma_f32_16x16x32_bf16 v[48:51], v[144:147], a[48:51], v[48:51]
    ds_read_b64_tr_b16 v[136:137], v226 offset:59584
    buffer_load_dwordx4 v221, s[24:27], s59 offen lds
    v_mfma_f32_16x16x32_bf16 v[52:55], v[144:147], a[52:55], v[52:55]
    ds_read_b64_tr_b16 v[138:139], v226 offset:64192
    v_mfma_f32_16x16x32_bf16 v[56:59], v[148:151], a[48:51], v[56:59]
    ds_read_b64_tr_b16 v[140:141], v226 offset:59616
    s_add_u32 m0, s57, 6144
    v_mfma_f32_16x16x32_bf16 v[60:63], v[148:151], a[52:55], v[60:63]
    ds_read_b64_tr_b16 v[142:143], v226 offset:64224
    buffer_load_dwordx4 a[112:115], v1, s[20:23], s75 offen offset:3072 sc1
    v_mfma_f32_16x16x32_bf16 v[64:67], v[120:123], a[48:51], v[64:67]
    ds_read_b64_tr_b16 v[144:145], v226 offset:59648
    v_mfma_f32_16x16x32_bf16 v[68:71], v[120:123], a[52:55], v[68:71]
    ds_read_b64_tr_b16 v[146:147], v226 offset:64256
    s_waitcnt lgkmcnt(6)
    v_mfma_f32_16x16x32_bf16 v[72:75], v[124:127], a[48:51], v[72:75]
    ds_read_b64_tr_b16 v[148:149], v227 offset:7168
    buffer_load_dwordx4 v222, s[24:27], s59 offen lds
    v_mfma_f32_16x16x32_bf16 v[76:79], v[124:127], a[52:55], v[76:79]
    ds_read_b64_tr_b16 v[150:151], v227 offset:11776
    s_add_u32 m0, s57, 7168
    v_mfma_f32_16x16x32_bf16 v[80:83], v[128:131], a[48:51], v[80:83]
    ds_read_b64_tr_b16 v[120:121], v227 offset:7200
    v_mfma_f32_16x16x32_bf16 v[84:87], v[128:131], a[52:55], v[84:87]
    ds_read_b64_tr_b16 v[122:123], v227 offset:11808
    v_mfma_f32_16x16x32_bf16 v[88:91], v[132:135], a[48:51], v[88:91]
    ds_read_b64_tr_b16 v[124:125], v227 offset:7232
    buffer_load_dwordx4 v223, s[24:27], s59 offen lds
    v_mfma_f32_16x16x32_bf16 v[92:95], v[132:135], a[52:55], v[92:95]
    ds_read_b64_tr_b16 v[126:127], v227 offset:11840
    s_waitcnt lgkmcnt(6)
    v_mfma_f32_16x16x32_bf16 v[96:99], v[136:139], a[48:51], v[96:99]
    ds_read_b64_tr_b16 v[128:129], v227 offset:7264
    s_add_u32 m0, s57, 8192
    v_mfma_f32_16x16x32_bf16 v[100:103], v[136:139], a[52:55], v[100:103]
    ds_read_b64_tr_b16 v[130:131], v227 offset:11872
    buffer_load_dwordx4 a[116:119], v1, s[20:23], s76 offen offset:3072 sc1
    v_mfma_f32_16x16x32_bf16 v[104:107], v[140:143], a[48:51], v[104:107]
    ds_read_b64_tr_b16 v[132:133], v227 offset:7296
    v_mfma_f32_16x16x32_bf16 v[108:111], v[140:143], a[52:55], v[108:111]
    ds_read_b64_tr_b16 v[134:135], v227 offset:11904
    buffer_load_dwordx4 v224, s[24:27], s59 offen lds
    v_mfma_f32_16x16x32_bf16 v[112:115], v[144:147], a[48:51], v[112:115]
    ds_read_b64_tr_b16 v[136:137], v227 offset:7328
    v_mfma_f32_16x16x32_bf16 v[116:119], v[144:147], a[52:55], v[116:119]
    ds_read_b64_tr_b16 v[138:139], v227 offset:11936
    s_waitcnt vmcnt(40)
    s_waitcnt lgkmcnt(6)
    v_mfma_f32_16x16x32_bf16 v[48:51], v[148:151], a[56:59], v[48:51]
    ds_read_b64_tr_b16 v[140:141], v227 offset:7360
    v_mfma_f32_16x16x32_bf16 v[52:55], v[148:151], a[60:63], v[52:55]
    ds_read_b64_tr_b16 v[142:143], v227 offset:11968
    v_mfma_f32_16x16x32_bf16 v[56:59], v[120:123], a[56:59], v[56:59]
    ds_read_b64_tr_b16 v[144:145], v227 offset:7392
    buffer_load_dwordx4 a[120:123], v1, s[20:23], s77 offen offset:3072 sc1
    v_mfma_f32_16x16x32_bf16 v[60:63], v[120:123], a[60:63], v[60:63]
    ds_read_b64_tr_b16 v[146:147], v227 offset:12000
    v_mfma_f32_16x16x32_bf16 v[64:67], v[124:127], a[56:59], v[64:67]
    ds_read_b64_tr_b16 v[148:149], v227 offset:7424
    buffer_load_dwordx4 a[124:127], v1, s[20:23], s78 offen offset:3072 sc1
    v_mfma_f32_16x16x32_bf16 v[68:71], v[124:127], a[60:63], v[68:71]
    ds_read_b64_tr_b16 v[150:151], v227 offset:12032
    s_waitcnt vmcnt(20)
    s_barrier
    s_cmp_lg_u32 s3, 0
    s_cbranch_scc1 M_rf5
    v_mov_b32 v15, 65536
    s_mov_b64 exec, 1
    buffer_atomic_add v15, off, s[36:39], s52
    s_mov_b64 exec, -1
M_rf5:
    s_waitcnt lgkmcnt(6)
    v_mfma_f32_16x16x32_bf16 v[72:75], v[128:131], a[56:59], v[72:75]
    ds_read_b64_tr_b16 v[120:121], v227 offset:16384
    v_mfma_f32_16x16x32_bf16 v[76:79], v[128:131], a[60:63], v[76:79]
    ds_read_b64_tr_b16 v[122:123], v227 offset:20992
    s_mov_b32 s59, 73728
    s_cmp_lt_u32 s3, 2
    s_cselect_b32 s59, s59, 258048
    s_add_u32 s59, s59, s46
    v_mfma_f32_16x16x32_bf16 v[80:83], v[132:135], a[56:59], v[80:83]
    ds_read_b64_tr_b16 v[124:125], v227 offset:16416
    s_add_u32 s75, s75, 4096
    s_add_u32 s76, s76, 4096
    v_mfma_f32_16x16x32_bf16 v[84:87], v[132:135], a[60:63], v[84:87]
    ds_read_b64_tr_b16 v[126:127], v227 offset:21024
    v_mfma_f32_16x16x32_bf16 v[88:91], v[136:139], a[56:59], v[88:91]
    ds_read_b64_tr_b16 v[128:129], v227 offset:16448
    v_mfma_f32_16x16x32_bf16 v[92:95], v[136:139], a[60:63], v[92:95]
    ds_read_b64_tr_b16 v[130:131], v227 offset:21056
    s_waitcnt lgkmcnt(6)
    v_mfma_f32_16x16x32_bf16 v[96:99], v[140:143], a[56:59], v[96:99]
    ds_read_b64_tr_b16 v[132:133], v227 offset:16480
    s_add_u32 s77, s77, 4096
    s_add_u32 s78, s78, 4096
    v_mfma_f32_16x16x32_bf16 v[100:103], v[140:143], a[60:63], v[100:103]
    ds_read_b64_tr_b16 v[134:135], v227 offset:21088
    v_mfma_f32_16x16x32_bf16 v[104:107], v[144:147], a[56:59], v[104:107]
    ds_read_b64_tr_b16 v[136:137], v227 offset:16512
    v_mfma_f32_16x16x32_bf16 v[108:111], v[144:147], a[60:63], v[108:111]
    ds_read_b64_tr_b16 v[138:139], v227 offset:21120
    v_mfma_f32_16x16x32_bf16 v[112:115], v[148:151], a[56:59], v[112:115]
    ds_read_b64_tr_b16 v[140:141], v227 offset:16544
    s_add_u32 m0, s54, 0
    v_mfma_f32_16x16x32_bf16 v[116:119], v[148:151], a[60:63], v[116:119]
    ds_read_b64_tr_b16 v[142:143], v227 offset:21152
    s_waitcnt vmcnt(33)
    s_waitcnt lgkmcnt(6)
    s_waitcnt vmcnt(19)
M_pc6:
    v_readfirstlane_b32 s65, v14
    s_nop 0
    s_bfe_u32 s65, s65, 524296
    s_cmp_ge_u32 s65, 8
    s_cbranch_scc1 M_po6
    s_add_u32 s100, s100, 1
    s_cmp_ge_u32 s100, 262144
    s_cbranch_scc1 M_po6
    buffer_load_dword v14, off, s[36:39], s52 sc1
    s_waitcnt vmcnt(0)
    s_branch M_pc6
M_po6:
    v_mfma_f32_16x16x32_bf16 v[48:51], v[120:123], a[64:67], v[48:51]
    ds_read_b64_tr_b16 v[144:145], v227 offset:16576
    v_mfma_f32_16x16x32_bf16 v[52:55], v[120:123], a[68:71], v[52:55]
    ds_read_b64_tr_b16 v[146:147], v227 offset:21184
    v_mfma_f32_16x16x32_bf16 v[56:59], v[124:127], a[64:67], v[56:59]
    ds_read_b64_tr_b16 v[148:149], v227 offset:16608
    buffer_load_dwordx4 v216, s[24:27], s59 offen lds
    v_mfma_f32_16x16x32_bf16 v[60:63], v[124:127], a[68:71], v[60:63]
    ds_read_b64_tr_b16 v[150:151], v227 offset:21216
    buffer_load_dwordx4 a[128:131], v1, s[20:23], s75 offen offset:0 sc1
    v_mfma_f32_16x16x32_bf16 v[64:67], v[128:131], a[64:67], v[64:67]
    ds_read_b64_tr_b16 v[120:121], v227 offset:16640
    v_mfma_f32_16x16x32_bf16 v[68:71], v[128:131], a[68:71], v[68:71]
    ds_read_b64_tr_b16 v[122:123], v227 offset:21248
    s_waitcnt lgkmcnt(6)
    v_mfma_f32_16x16x32_bf16 v[72:75], v[132:135], a[64:67], v[72:75]
    ds_read_b64_tr_b16 v[124:125], v227 offset:25600
    s_add_u32 m0, s54, 1024
    v_mfma_f32_16x16x32_bf16 v[76:79], v[132:135], a[68:71], v[76:79]
    ds_read_b64_tr_b16 v[126:127], v227 offset:30208
    v_mfma_f32_16x16x32_bf16 v[80:83], v[136:139], a[64:67], v[80:83]
    ds_read_b64_tr_b16 v[128:129], v227 offset:25632
    buffer_load_dwordx4 v217, s[24:27], s59 offen lds
    v_mfma_f32_16x16x32_bf16 v[84:87], v[136:139], a[68:71], v[84:87]
    ds_read_b64_tr_b16 v[130:131], v227 offset:30240
    v_mfma_f32_16x16x32_bf16 v[88:91], v[140:143], a[64:67], v[88:91]
    ds_read_b64_tr_b16 v[132:133], v227 offset:25664
    buffer_load_dwordx4 a[132:135], v1, s[20:23], s76 offen offset:0 sc1
    v_mfma_f32_16x16x32_bf16 v[92:95], v[140:143], a[68:71], v[92:95]
    ds_read_b64_tr_b16 v[134:135], v227 offset:30272
    s_waitcnt lgkmcnt(6)
    v_mfma_f32_16x16x32_bf16 v[96:99], v[144:147], a[64:67], v[96:99]
    ds_read_b64_tr_b16 v[136:137], v227 offset:25696
    s_add_u32 m0, s54, 2048
    v_mfma_f32_16x16x32_bf16 v[100:103], v[144:147], a[68:71], v[100:103]
    ds_read_b64_tr_b16 v[138:139], v227 offset:30304
    v_mfma_f32_16x16x32_bf16 v[104:107], v[148:151], a[64:67], v[104:107]
    ds_read_b64_tr_b16 v[140:141], v227 offset:25728
    v_mfma_f32_16x16x32_bf16 v[108:111], v[148:151], a[68:71], v[108:111]
    ds_read_b64_tr_b16 v[142:143], v227 offset:30336
    buffer_load_dwordx4 v218, s[24:27], s59 offen lds
    v_mfma_f32_16x16x32_bf16 v[112:115], v[120:123], a[64:67], v[112:115]
    ds_read_b64_tr_b16 v[144:145], v227 offset:25760
    v_mfma_f32_16x16x32_bf16 v[116:119], v[120:123], a[68:71], v[116:119]
    ds_read_b64_tr_b16 v[146:147], v227 offset:30368
    s_waitcnt vmcnt(32)
    s_waitcnt lgkmcnt(6)
    v_mfma_f32_16x16x32_bf16 v[48:51], v[124:127], a[72:75], v[48:51]
    ds_read_b64_tr_b16 v[148:149], v227 offset:25792
    s_add_u32 m0, s54, 3072
    v_mfma_f32_16x16x32_bf16 v[52:55], v[124:127], a[76:79], v[52:55]
    ds_read_b64_tr_b16 v[150:151], v227 offset:30400
    v_mfma_f32_16x16x32_bf16 v[56:59], v[128:131], a[72:75], v[56:59]
    ds_read_b64_tr_b16 v[120:121], v227 offset:25824
    buffer_load_dwordx4 a[136:139], v1, s[20:23], s77 offen offset:0 sc1
    v_mfma_f32_16x16x32_bf16 v[60:63], v[128:131], a[76:79], v[60:63]
    ds_read_b64_tr_b16 v[122:123], v227 offset:30432
    buffer_load_dwordx4 v219, s[24:27], s59 offen lds
    v_mfma_f32_16x16x32_bf16 v[64:67], v[132:135], a[72:75], v[64:67]
    ds_read_b64_tr_b16 v[124:125], v227 offset:25856
    v_mfma_f32_16x16x32_bf16 v[68:71], v[132:135], a[76:79], v[68:71]
    ds_read_b64_tr_b16 v[126:127], v227 offset:30464
    s_waitcnt lgkmcnt(6)
    v_mfma_f32_16x16x32_bf16 v[72:75], v[136:139], a[72:75], v[72:75]
    ds_read_b64_tr_b16 v[128:129], v225 offset:0
    v_mfma_f32_16x16x32_bf16 v[76:79], v[136:139], a[76:79], v[76:79]
    ds_read_b64_tr_b16 v[130:131], v225 offset:4608
    s_add_u32 m0, s54, 4096
    v_mfma_f32_16x16x32_bf16 v[80:83], v[140:143], a[72:75], v[80:83]
    ds_read_b64_tr_b16 v[132:133], v225 offset:32
    v_mfma_f32_16x16x32_bf16 v[84:87], v[140:143], a[76:79], v[84:87]
    ds_read_b64_tr_b16 v[134:135], v225 offset:4640
    v_mfma_f32_16x16x32_bf16 v[88:91], v[144:147], a[72:75], v[88:91]
    ds_read_b64_tr_b16 v[136:137], v225 offset:64
    buffer_load_dwordx4 v220, s[24:27], s59 offen lds
    v_mfma_f32_16x16x32_bf16 v[92:95], v[144:147], a[76:79], v[92:95]
    ds_read_b64_tr_b16 v[138:139], v225 offset:4672
    s_waitcnt lgkmcnt(6)
    v_mfma_f32_16x16x32_bf16 v[96:99], v[148:151], a[72:75], v[96:99]
    ds_read_b64_tr_b16 v[140:141], v225 offset:96
    buffer_load_dwordx4 a[140:143], v1, s[20:23], s78 offen offset:0 sc1
    v_mfma_f32_16x16x32_bf16 v[100:103], v[148:151], a[76:79], v[100:103]
    ds_read_b64_tr_b16 v[142:143], v225 offset:4704
    s_add_u32 m0, s54, 5120
    v_mfma_f32_16x16x32_bf16 v[104:107], v[120:123], a[72:75], v[104:107]
    ds_read_b64_tr_b16 v[144:145], v225 offset:128
    v_mfma_f32_16x16x32_bf16 v[108:111], v[120:123], a[76:79], v[108:111]
    ds_read_b64_tr_b16 v[146:147], v225 offset:4736
    v_mfma_f32_16x16x32_bf16 v[112:115], v[124:127], a[72:75], v[112:115]
    ds_read_b64_tr_b16 v[148:149], v225 offset:160
    v_mfma_f32_16x16x32_bf16 v[116:119], v[124:127], a[76:79], v[116:119]
    ds_read_b64_tr_b16 v[150:151], v225 offset:4768
    s_waitcnt vmcnt(30)
    s_waitcnt lgkmcnt(6)
    v_mfma_f32_16x16x32_bf16 v[48:51], v[128:131], a[80:83], v[48:51]
    ds_read_b64_tr_b16 v[120:121], v225 offset:192
    buffer_load_dwordx4 v221, s[24:27], s59 offen lds
    v_mfma_f32_16x16x32_bf16 v[52:55], v[128:131], a[84:87], v[52:55]
    ds_read_b64_tr_b16 v[122:123], v225 offset:4800
    v_mfma_f32_16x16x32_bf16 v[56:59], v[132:135], a[80:83], v[56:59]
    ds_read_b64_tr_b16 v[124:125], v225 offset:224
    s_add_u32 m0, s54, 6144
    v_mfma_f32_16x16x32_bf16 v[60:63], v[132:135], a[84:87], v[60:63]
    ds_read_b64_tr_b16 v[126:127], v225 offset:4832
    buffer_load_dwordx4 a[144:147], v1, s[20:23], s75 offen offset:1024 sc1
    v_mfma_f32_16x16x32_bf16 v[64:67], v[136:139], a[80:83], v[64:67]
    ds_read_b64_tr_b16 v[128:129], v225 offset:256
    v_mfma_f32_16x16x32_bf16 v[68:71], v[136:139], a[84:87], v[68:71]
    ds_read_b64_tr_b16 v[130:131], v225 offset:4864
    s_waitcnt lgkmcnt(6)
    v_mfma_f32_16x16x32_bf16 v[72:75], v[140:143], a[80:83], v[72:75]
    ds_read_b64_tr_b16 v[132:133], v225 offset:9216
    buffer_load_dwordx4 v222, s[24:27], s59 offen lds
    v_mfma_f32_16x16x32_bf16 v[76:79], v[140:143], a[84:87], v[76:79]
    ds_read_b64_tr_b16 v[134:135], v225 offset:13824
    v_mfma_f32_16x16x32_bf16 v[80:83], v[144:147], a[80:83], v[80:83]
    ds_read_b64_tr_b16 v[136:137], v225 offset:9248
    s_add_u32 m0, s54, 7168
    v_mfma_f32_16x16x32_bf16 v[84:87], v[144:147], a[84:87], v[84:87]
    ds_read_b64_tr_b16 v[138:139], v225 offset:13856
    v_mfma_f32_16x16x32_bf16 v[88:91], v[148:151], a[80:83], v[88:91]
    ds_read_b64_tr_b16 v[140:141], v225 offset:9280
    buffer_load_dwordx4 a[148:151], v1, s[20:23], s76 offen offset:1024 sc1
    v_mfma_f32_16x16x32_bf16 v[92:95], v[148:151], a[84:87], v[92:95]
    ds_read_b64_tr_b16 v[142:143], v225 offset:13888
    s_waitcnt lgkmcnt(6)
    v_mfma_f32_16x16x32_bf16 v[96:99], v[120:123], a[80:83], v[96:99]
    ds_read_b64_tr_b16 v[144:145], v225 offset:9312
    buffer_load_dwordx4 v223, s[24:27], s59 offen lds
    v_mfma_f32_16x16x32_bf16 v[100:103], v[120:123], a[84:87], v[100:103]
    ds_read_b64_tr_b16 v[146:147], v225 offset:13920
    v_mfma_f32_16x16x32_bf16 v[104:107], v[124:127], a[80:83], v[104:107]
    ds_read_b64_tr_b16 v[148:149], v225 offset:9344
    v_mfma_f32_16x16x32_bf16 v[108:111], v[124:127], a[84:87], v[108:111]
    ds_read_b64_tr_b16 v[150:151], v225 offset:13952
    s_add_u32 m0, s54, 8192
    v_mfma_f32_16x16x32_bf16 v[112:115], v[128:131], a[80:83], v[112:115]
    ds_read_b64_tr_b16 v[120:121], v225 offset:9376
    v_mfma_f32_16x16x32_bf16 v[116:119], v[128:131], a[84:87], v[116:119]
    ds_read_b64_tr_b16 v[122:123], v225 offset:13984
    s_waitcnt vmcnt(31)
    s_waitcnt lgkmcnt(6)
    v_mfma_f32_16x16x32_bf16 v[48:51], v[132:135], a[88:91], v[48:51]
    ds_read_b64_tr_b16 v[124:125], v225 offset:9408
    buffer_load_dwordx4 v224, s[24:27], s59 offen lds
    v_mfma_f32_16x16x32_bf16 v[52:55], v[132:135], a[92:95], v[52:55]
    ds_read_b64_tr_b16 v[126:127], v225 offset:14016
    v_mfma_f32_16x16x32_bf16 v[56:59], v[136:139], a[88:91], v[56:59]
    ds_read_b64_tr_b16 v[128:129], v225 offset:9440
    buffer_load_dwordx4 a[152:155], v1, s[20:23], s77 offen offset:1024 sc1
    v_mfma_f32_16x16x32_bf16 v[60:63], v[136:139], a[92:95], v[60:63]
    ds_read_b64_tr_b16 v[130:131], v225 offset:14048
    v_mfma_f32_16x16x32_bf16 v[64:67], v[140:143], a[88:91], v[64:67]
    ds_read_b64_tr_b16 v[132:133], v225 offset:9472
    v_mfma_f32_16x16x32_bf16 v[68:71], v[140:143], a[92:95], v[68:71]
    ds_read_b64_tr_b16 v[134:135], v225 offset:14080
    s_waitcnt vmcnt(18)
    s_barrier
    s_waitcnt lgkmcnt(6)
    v_mfma_f32_16x16x32_bf16 v[72:75], v[144:147], a[88:91], v[72:75]
    ds_read_b64_tr_b16 v[136:137], v225 offset:18432
    v_mfma_f32_16x16x32_bf16 v[76:79], v[144:147], a[92:95], v[76:79]
    ds_read_b64_tr_b16 v[138:139], v225 offset:23040
    s_mov_b32 s59, 405504
    s_cmp_lt_u32 s3, 2
    s_cselect_b32 s59, s59, 589824
    s_add_u32 s59, s59, s46
    v_mfma_f32_16x16x32_bf16 v[80:83], v[148:151], a[88:91], v[80:83]
    ds_read_b64_tr_b16 v[140:141], v225 offset:18464
    v_mfma_f32_16x16x32_bf16 v[84:87], v[148:151], a[92:95], v[84:87]
    ds_read_b64_tr_b16 v[142:143], v225 offset:23072
    v_mfma_f32_16x16x32_bf16 v[88:91], v[120:123], a[88:91], v[88:91]
    ds_read_b64_tr_b16 v[144:145], v225 offset:18496
    buffer_load_dwordx4 a[156:159], v1, s[20:23], s78 offen offset:1024 sc1
    v_mfma_f32_16x16x32_bf16 v[92:95], v[120:123], a[92:95], v[92:95]
    ds_read_b64_tr_b16 v[146:147], v225 offset:23104
    s_waitcnt lgkmcnt(6)
    v_mfma_f32_16x16x32_bf16 v[96:99], v[124:127], a[88:91], v[96:99]
    ds_read_b64_tr_b16 v[148:149], v225 offset:18528
    v_mfma_f32_16x16x32_bf16 v[100:103], v[124:127], a[92:95], v[100:103]
    ds_read_b64_tr_b16 v[150:151], v225 offset:23136
    v_mfma_f32_16x16x32_bf16 v[104:107], v[128:131], a[88:91], v[104:107]
    ds_read_b64_tr_b16 v[120:121], v225 offset:18560
    v_mfma_f32_16x16x32_bf16 v[108:111], v[128:131], a[92:95], v[108:111]
    ds_read_b64_tr_b16 v[122:123], v225 offset:23168
    v_mfma_f32_16x16x32_bf16 v[112:115], v[132:135], a[88:91], v[112:115]
    ds_read_b64_tr_b16 v[124:125], v225 offset:18592
    s_add_u32 m0, s55, 0
    v_mfma_f32_16x16x32_bf16 v[116:119], v[132:135], a[92:95], v[116:119]
    ds_read_b64_tr_b16 v[126:127], v225 offset:23200
    s_waitcnt vmcnt(32)
    s_waitcnt lgkmcnt(6)
    buffer_load_dword v14, off, s[36:39], s52 sc1
    v_mfma_f32_16x16x32_bf16 v[48:51], v[136:139], a[96:99], v[48:51]
    ds_read_b64_tr_b16 v[128:129], v225 offset:18624
    v_mfma_f32_16x16x32_bf16 v[52:55], v[136:139], a[100:103], v[52:55]
    ds_read_b64_tr_b16 v[130:131], v225 offset:23232
    v_mfma_f32_16x16x32_bf16 v[56:59], v[140:143], a[96:99], v[56:59]
    ds_read_b64_tr_b16 v[132:133], v225 offset:18656
    buffer_load_dwordx4 v216, s[24:27], s59 offen lds
    v_mfma_f32_16x16x32_bf16 v[60:63], v[140:143], a[100:103], v[60:63]
    ds_read_b64_tr_b16 v[134:135], v225 offset:23264
    buffer_load_dwordx4 a[160:163], v1, s[20:23], s75 offen offset:2048 sc1
    v_mfma_f32_16x16x32_bf16 v[64:67], v[144:147], a[96:99], v[64:67]
    ds_read_b64_tr_b16 v[136:137], v225 offset:18688
    v_mfma_f32_16x16x32_bf16 v[68:71], v[144:147], a[100:103], v[68:71]
    ds_read_b64_tr_b16 v[138:139], v225 offset:23296
    s_waitcnt lgkmcnt(6)
    v_mfma_f32_16x16x32_bf16 v[72:75], v[148:151], a[96:99], v[72:75]
    ds_read_b64_tr_b16 v[140:141], v225 offset:27648
    s_add_u32 m0, s55, 1024
    v_mfma_f32_16x16x32_bf16 v[76:79], v[148:151], a[100:103], v[76:79]
    ds_read_b64_tr_b16 v[142:143], v225 offset:32256
    v_mfma_f32_16x16x32_bf16 v[80:83], v[120:123], a[96:99], v[80:83]
    ds_read_b64_tr_b16 v[144:145], v225 offset:27680
    buffer_load_dwordx4 v217, s[24:27], s59 offen lds
    v_mfma_f32_16x16x32_bf16 v[84:87], v[120:123], a[100:103], v[84:87]
    ds_read_b64_tr_b16 v[146:147], v225 offset:32288
    v_mfma_f32_16x16x32_bf16 v[88:91], v[124:127], a[96:99], v[88:91]
    ds_read_b64_tr_b16 v[148:149], v225 offset:27712
    buffer_load_dwordx4 a[164:167], v1, s[20:23], s76 offen offset:2048 sc1
    v_mfma_f32_16x16x32_bf16 v[92:95], v[124:127], a[100:103], v[92:95]
    ds_read_b64_tr_b16 v[150:151], v225 offset:32320
    s_waitcnt lgkmcnt(6)
    v_mfma_f32_16x16x32_bf16 v[96:99], v[128:131], a[96:99], v[96:99]
    ds_read_b64_tr_b16 v[120:121], v225 offset:27744
    s_add_u32 m0, s55, 2048
    v_mfma_f32_16x16x32_bf16 v[100:103], v[128:131], a[100:103], v[100:103]
    ds_read_b64_tr_b16 v[122:123], v225 offset:32352
    v_mfma_f32_16x16x32_bf16 v[104:107], v[132:135], a[96:99], v[104:107]
    ds_read_b64_tr_b16 v[124:125], v225 offset:27776
    v_mfma_f32_16x16x32_bf16 v[108:111], v[132:135], a[100:103], v[108:111]
    ds_read_b64_tr_b16 v[126:127], v225 offset:32384
    buffer_load_dwordx4 v218, s[24:27], s59 offen lds
    v_mfma_f32_16x16x32_bf16 v[112:115], v[136:139], a[96:99], v[112:115]
    ds_read_b64_tr_b16 v[128:129], v225 offset:27808
    v_mfma_f32_16x16x32_bf16 v[116:119], v[136:139], a[100:103], v[116:119]
    ds_read_b64_tr_b16 v[130:131], v225 offset:32416
    s_waitcnt vmcnt(32)
    s_waitcnt lgkmcnt(6)
    v_mfma_f32_16x16x32_bf16 v[48:51], v[140:143], a[104:107], v[48:51]
    ds_read_b64_tr_b16 v[132:133], v225 offset:27840
    s_add_u32 m0, s55, 3072
    v_mfma_f32_16x16x32_bf16 v[52:55], v[140:143], a[108:111], v[52:55]
    ds_read_b64_tr_b16 v[134:135], v225 offset:32448
    v_mfma_f32_16x16x32_bf16 v[56:59], v[144:147], a[104:107], v[56:59]
    ds_read_b64_tr_b16 v[136:137], v225 offset:27872
    buffer_load_dwordx4 a[168:171], v1, s[20:23], s77 offen offset:2048 sc1
    v_mfma_f32_16x16x32_bf16 v[60:63], v[144:147], a[108:111], v[60:63]
    ds_read_b64_tr_b16 v[138:139], v225 offset:32480
    buffer_load_dwordx4 v219, s[24:27], s59 offen lds
    v_mfma_f32_16x16x32_bf16 v[64:67], v[148:151], a[104:107], v[64:67]
    ds_read_b64_tr_b16 v[140:141], v225 offset:27904
    v_mfma_f32_16x16x32_bf16 v[68:71], v[148:151], a[108:111], v[68:71]
    ds_read_b64_tr_b16 v[142:143], v225 offset:32512
    s_waitcnt lgkmcnt(6)
    v_mfma_f32_16x16x32_bf16 v[72:75], v[120:123], a[104:107], v[72:75]
    ds_read_b64_tr_b16 v[144:145], v225 offset:36864
    v_mfma_f32_16x16x32_bf16 v[76:79], v[120:123], a[108:111], v[76:79]
    ds_read_b64_tr_b16 v[146:147], v225 offset:41472
    s_add_u32 m0, s55, 4096
    v_mfma_f32_16x16x32_bf16 v[80:83], v[124:127], a[104:107], v[80:83]
    ds_read_b64_tr_b16 v[148:149], v225 offset:36896
    v_mfma_f32_16x16x32_bf16 v[84:87], v[124:127], a[108:111], v[84:87]
    ds_read_b64_tr_b16 v[150:151], v225 offset:41504
    v_mfma_f32_16x16x32_bf16 v[88:91], v[128:131], a[104:107], v[88:91]
    ds_read_b64_tr_b16 v[120:121], v225 offset:36928
    buffer_load_dwordx4 v220, s[24:27], s59 offen lds
    v_mfma_f32_16x16x32_bf16 v[92:95], v[128:131], a[108:111], v[92:95]
    ds_read_b64_tr_b16 v[122:123], v225 offset:41536
    s_waitcnt lgkmcnt(6)
    v_mfma_f32_16x16x32_bf16 v[96:99], v[132:135], a[104:107], v[96:99]
    ds_read_b64_tr_b16 v[124:125], v225 offset:36960
    buffer_load_dwordx4 a[172:175], v1, s[20:23], s78 offen offset:2048 sc1
    v_mfma_f32_16x16x32_bf16 v[100:103], v[132:135], a[108:111], v[100:103]
    ds_read_b64_tr_b16 v[126:127], v225 offset:41568
    s_add_u32 m0, s55, 5120
    v_mfma_f32_16x16x32_bf16 v[104:107], v[136:139], a[104:107], v[104:107]
    ds_read_b64_tr_b16 v[128:129], v225 offset:36992
    v_mfma_f32_16x16x32_bf16 v[108:111], v[136:139], a[108:111], v[108:111]
    ds_read_b64_tr_b16 v[130:131], v225 offset:41600
    v_mfma_f32_16x16x32_bf16 v[112:115], v[140:143], a[104:107], v[112:115]
    ds_read_b64_tr_b16 v[132:133], v225 offset:37024
    v_mfma_f32_16x16x32_bf16 v[116:119], v[140:143], a[108:111], v[116:119]
    ds_read_b64_tr_b16 v[134:135], v225 offset:41632
    s_waitcnt vmcnt(30)
    s_waitcnt lgkmcnt(6)
    v_mfma_f32_16x16x32_bf16 v[48:51], v[144:147], a[112:115], v[48:51]
    ds_read_b64_tr_b16 v[136:137], v225 offset:37056
    buffer_load_dwordx4 v221, s[24:27], s59 offen lds
    v_mfma_f32_16x16x32_bf16 v[52:55], v[144:147], a[116:119], v[52:55]
    ds_read_b64_tr_b16 v[138:139], v225 offset:41664
    v_mfma_f32_16x16x32_bf16 v[56:59], v[148:151], a[112:115], v[56:59]
    ds_read_b64_tr_b16 v[140:141], v225 offset:37088
    s_add_u32 m0, s55, 6144
    v_mfma_f32_16x16x32_bf16 v[60:63], v[148:151], a[116:119], v[60:63]
    ds_read_b64_tr_b16 v[142:143], v225 offset:41696
    buffer_load_dwordx4 a[176:179], v1, s[20:23], s75 offen offset:3072 sc1
    v_mfma_f32_16x16x32_bf16 v[64:67], v[120:123], a[112:115], v[64:67]
    ds_read_b64_tr_b16 v[144:145], v225 offset:37120
    v_mfma_f32_16x16x32_bf16 v[68:71], v[120:123], a[116:119], v[68:71]
    ds_read_b64_tr_b16 v[146:147], v225 offset:41728
    s_waitcnt lgkmcnt(6)
    v_mfma_f32_16x16x32_bf16 v[72:75], v[124:127], a[112:115], v[72:75]
    ds_read_b64_tr_b16 v[148:149], v225 offset:46080
    buffer_load_dwordx4 v222, s[24:27], s59 offen lds
    v_mfma_f32_16x16x32_bf16 v[76:79], v[124:127], a[116:119], v[76:79]
    ds_read_b64_tr_b16 v[150:151], v225 offset:50688
    v_mfma_f32_16x16x32_bf16 v[80:83], v[128:131], a[112:115], v[80:83]
    ds_read_b64_tr_b16 v[120:121], v225 offset:46112
    s_add_u32 m0, s55, 7168
    v_mfma_f32_16x16x32_bf16 v[84:87], v[128:131], a[116:119], v[84:87]
    ds_read_b64_tr_b16 v[122:123], v225 offset:50720
    v_mfma_f32_16x16x32_bf16 v[88:91], v[132:135], a[112:115], v[88:91]
    ds_read_b64_tr_b16 v[124:125], v225 offset:46144
    buffer_load_dwordx4 a[180:183], v1, s[20:23], s76 offen offset:3072 sc1
    v_mfma_f32_16x16x32_bf16 v[92:95], v[132:135], a[116:119], v[92:95]
    ds_read_b64_tr_b16 v[126:127], v225 offset:50752
    s_waitcnt lgkmcnt(6)
    v_mfma_f32_16x16x32_bf16 v[96:99], v[136:139], a[112:115], v[96:99]
    ds_read_b64_tr_b16 v[128:129], v225 offset:46176
    buffer_load_dwordx4 v223, s[24:27], s59 offen lds
    v_mfma_f32_16x16x32_bf16 v[100:103], v[136:139], a[116:119], v[100:103]
    ds_read_b64_tr_b16 v[130:131], v225 offset:50784
    v_mfma_f32_16x16x32_bf16 v[104:107], v[140:143], a[112:115], v[104:107]
    ds_read_b64_tr_b16 v[132:133], v225 offset:46208
    v_mfma_f32_16x16x32_bf16 v[108:111], v[140:143], a[116:119], v[108:111]
    ds_read_b64_tr_b16 v[134:135], v225 offset:50816
    s_add_u32 m0, s55, 8192
    v_mfma_f32_16x16x32_bf16 v[112:115], v[144:147], a[112:115], v[112:115]
    ds_read_b64_tr_b16 v[136:137], v225 offset:46240
    v_mfma_f32_16x16x32_bf16 v[116:119], v[144:147], a[116:119], v[116:119]
    ds_read_b64_tr_b16 v[138:139], v225 offset:50848
    s_waitcnt vmcnt(32)
    s_waitcnt lgkmcnt(6)
    v_mfma_f32_16x16x32_bf16 v[48:51], v[148:151], a[120:123], v[48:51]
    ds_read_b64_tr_b16 v[140:141], v225 offset:46272
    buffer_load_dwordx4 v224, s[24:27], s59 offen lds
    v_mfma_f32_16x16x32_bf16 v[52:55], v[148:151], a[124:127], v[52:55]
    ds_read_b64_tr_b16 v[142:143], v225 offset:50880
    v_mfma_f32_16x16x32_bf16 v[56:59], v[120:123], a[120:123], v[56:59]
    ds_read_b64_tr_b16 v[144:145], v225 offset:46304
    buffer_load_dwordx4 a[184:187], v1, s[20:23], s77 offen offset:3072 sc1
    v_mfma_f32_16x16x32_bf16 v[60:63], v[120:123], a[124:127], v[60:63]
    ds_read_b64_tr_b16 v[146:147], v225 offset:50912
    v_mfma_f32_16x16x32_bf16 v[64:67], v[124:127], a[120:123], v[64:67]
    ds_read_b64_tr_b16 v[148:149], v225 offset:46336
    buffer_load_dwordx4 a[188:191], v1, s[20:23], s78 offen offset:3072 sc1
    v_mfma_f32_16x16x32_bf16 v[68:71], v[124:127], a[124:127], v[68:71]
    ds_read_b64_tr_b16 v[150:151], v225 offset:50944
    s_waitcnt vmcnt(20)
    s_barrier
    s_waitcnt lgkmcnt(6)
    v_mfma_f32_16x16x32_bf16 v[72:75], v[128:131], a[120:123], v[72:75]
    ds_read_b64_tr_b16 v[120:121], v226 offset:4096
    v_mfma_f32_16x16x32_bf16 v[76:79], v[128:131], a[124:127], v[76:79]
    ds_read_b64_tr_b16 v[122:123], v226 offset:8704
    s_mov_b32 s59, 110592
    s_cmp_lt_u32 s3, 2
    s_cselect_b32 s59, s59, 294912
    s_add_u32 s59, s59, s46
    v_mfma_f32_16x16x32_bf16 v[80:83], v[132:135], a[120:123], v[80:83]
    ds_read_b64_tr_b16 v[124:125], v226 offset:4128
    s_add_u32 s75, s75, 4096
    s_add_u32 s76, s76, 4096
    v_mfma_f32_16x16x32_bf16 v[84:87], v[132:135], a[124:127], v[84:87]
    ds_read_b64_tr_b16 v[126:127], v226 offset:8736
    v_mfma_f32_16x16x32_bf16 v[88:91], v[136:139], a[120:123], v[88:91]
    ds_read_b64_tr_b16 v[128:129], v226 offset:4160
    v_mfma_f32_16x16x32_bf16 v[92:95], v[136:139], a[124:127], v[92:95]
    ds_read_b64_tr_b16 v[130:131], v226 offset:8768
    s_waitcnt lgkmcnt(6)
    v_mfma_f32_16x16x32_bf16 v[96:99], v[140:143], a[120:123], v[96:99]
    ds_read_b64_tr_b16 v[132:133], v226 offset:4192
    s_add_u32 s77, s77, 4096
    s_add_u32 s78, s78, 4096
    v_mfma_f32_16x16x32_bf16 v[100:103], v[140:143], a[124:127], v[100:103]
    ds_read_b64_tr_b16 v[134:135], v226 offset:8800
    v_mfma_f32_16x16x32_bf16 v[104:107], v[144:147], a[120:123], v[104:107]
    ds_read_b64_tr_b16 v[136:137], v226 offset:4224
    v_mfma_f32_16x16x32_bf16 v[108:111], v[144:147], a[124:127], v[108:111]
    ds_read_b64_tr_b16 v[138:139], v226 offset:8832
    v_mfma_f32_16x16x32_bf16 v[112:115], v[148:151], a[120:123], v[112:115]
    ds_read_b64_tr_b16 v[140:141], v226 offset:4256
    s_add_u32 m0, s56, 0
    v_mfma_f32_16x16x32_bf16 v[116:119], v[148:151], a[124:127], v[116:119]
    ds_read_b64_tr_b16 v[142:143], v226 offset:8864
    s_waitcnt vmcnt(31)
    s_waitcnt lgkmcnt(6)
    s_waitcnt vmcnt(17)
M_pc7:
    v_readfirstlane_b32 s65, v14
    s_nop 0
    s_bfe_u32 s65, s65, 524304
    s_cmp_ge_u32 s65, 8
    s_cbranch_scc1 M_po7
    s_add_u32 s100, s100, 1
    s_cmp_ge_u32 s100, 262144
    s_cbranch_scc1 M_po7
    buffer_load_dword v14, off, s[36:39], s52 sc1
    s_waitcnt vmcnt(0)
    s_branch M_pc7
M_po7:
    v_mfma_f32_16x16x32_bf16 v[48:51], v[120:123], a[128:131], v[48:51]
    ds_read_b64_tr_b16 v[144:145], v226 offset:4288
    v_mfma_f32_16x16x32_bf16 v[52:55], v[120:123], a[132:135], v[52:55]
    ds_read_b64_tr_b16 v[146:147], v226 offset:8896
    v_mfma_f32_16x16x32_bf16 v[56:59], v[124:127], a[128:131], v[56:59]
    ds_read_b64_tr_b16 v[148:149], v226 offset:4320
    buffer_load_dwordx4 v216, s[24:27], s59 offen lds
    v_mfma_f32_16x16x32_bf16 v[60:63], v[124:127], a[132:135], v[60:63]
    ds_read_b64_tr_b16 v[150:151], v226 offset:8928
    buffer_load_dwordx4 a[192:195], v1, s[20:23], s75 offen offset:0 sc1
    v_mfma_f32_16x16x32_bf16 v[64:67], v[128:131], a[128:131], v[64:67]
    ds_read_b64_tr_b16 v[120:121], v226 offset:4352
    v_mfma_f32_16x16x32_bf16 v[68:71], v[128:131], a[132:135], v[68:71]
    ds_read_b64_tr_b16 v[122:123], v226 offset:8960
    s_waitcnt lgkmcnt(6)
    v_mfma_f32_16x16x32_bf16 v[72:75], v[132:135], a[128:131], v[72:75]
    ds_read_b64_tr_b16 v[124:125], v226 offset:13312
    s_add_u32 m0, s56, 1024
    v_mfma_f32_16x16x32_bf16 v[76:79], v[132:135], a[132:135], v[76:79]
    ds_read_b64_tr_b16 v[126:127], v226 offset:17920
    v_mfma_f32_16x16x32_bf16 v[80:83], v[136:139], a[128:131], v[80:83]
    ds_read_b64_tr_b16 v[128:129], v226 offset:13344
    buffer_load_dwordx4 v217, s[24:27], s59 offen lds
    v_mfma_f32_16x16x32_bf16 v[84:87], v[136:139], a[132:135], v[84:87]
    ds_read_b64_tr_b16 v[130:131], v226 offset:17952
    v_mfma_f32_16x16x32_bf16 v[88:91], v[140:143], a[128:131], v[88:91]
    ds_read_b64_tr_b16 v[132:133], v226 offset:13376
    buffer_load_dwordx4 a[196:199], v1, s[20:23], s76 offen offset:0 sc1
    v_mfma_f32_16x16x32_bf16 v[92:95], v[140:143], a[132:135], v[92:95]
    ds_read_b64_tr_b16 v[134:135], v226 offset:17984
    s_waitcnt lgkmcnt(6)
    v_mfma_f32_16x16x32_bf16 v[96:99], v[144:147], a[128:131], v[96:99]
    ds_read_b64_tr_b16 v[136:137], v226 offset:13408
    s_add_u32 m0, s56, 2048
    v_mfma_f32_16x16x32_bf16 v[100:103], v[144:147], a[132:135], v[100:103]
    ds_read_b64_tr_b16 v[138:139], v226 offset:18016
    v_mfma_f32_16x16x32_bf16 v[104:107], v[148:151], a[128:131], v[104:107]
    ds_read_b64_tr_b16 v[140:141], v226 offset:13440
    v_mfma_f32_16x16x32_bf16 v[108:111], v[148:151], a[132:135], v[108:111]
    ds_read_b64_tr_b16 v[142:143], v226 offset:18048
    buffer_load_dwordx4 v218, s[24:27], s59 offen lds
    v_mfma_f32_16x16x32_bf16 v[112:115], v[120:123], a[128:131], v[112:115]
    ds_read_b64_tr_b16 v[144:145], v226 offset:13472
    v_mfma_f32_16x16x32_bf16 v[116:119], v[120:123], a[132:135], v[116:119]
    ds_read_b64_tr_b16 v[146:147], v226 offset:18080
    s_waitcnt vmcnt(31)
    s_waitcnt lgkmcnt(6)
    v_mfma_f32_16x16x32_bf16 v[48:51], v[124:127], a[136:139], v[48:51]
    ds_read_b64_tr_b16 v[148:149], v226 offset:13504
    s_add_u32 m0, s56, 3072
    v_mfma_f32_16x16x32_bf16 v[52:55], v[124:127], a[140:143], v[52:55]
    ds_read_b64_tr_b16 v[150:151], v226 offset:18112
    v_mfma_f32_16x16x32_bf16 v[56:59], v[128:131], a[136:139], v[56:59]
    ds_read_b64_tr_b16 v[120:121], v226 offset:13536
    buffer_load_dwordx4 a[200:203], v1, s[20:23], s77 offen offset:0 sc1
    v_mfma_f32_16x16x32_bf16 v[60:63], v[128:131], a[140:143], v[60:63]
    ds_read_b64_tr_b16 v[122:123], v226 offset:18144
    buffer_load_dwordx4 v219, s[24:27], s59 offen lds
    v_mfma_f32_16x16x32_bf16 v[64:67], v[132:135], a[136:139], v[64:67]
    ds_read_b64_tr_b16 v[124:125], v226 offset:13568
    v_mfma_f32_16x16x32_bf16 v[68:71], v[132:135], a[140:143], v[68:71]
    ds_read_b64_tr_b16 v[126:127], v226 offset:18176
    s_waitcnt lgkmcnt(6)
    v_mfma_f32_16x16x32_bf16 v[72:75], v[136:139], a[136:139], v[72:75]
    ds_read_b64_tr_b16 v[128:129], v226 offset:22528
    v_mfma_f32_16x16x32_bf16 v[76:79], v[136:139], a[140:143], v[76:79]
    ds_read_b64_tr_b16 v[130:131], v226 offset:27136
    s_add_u32 m0, s56, 4096
    v_mfma_f32_16x16x32_bf16 v[80:83], v[140:143], a[136:139], v[80:83]
    ds_read_b64_tr_b16 v[132:133], v226 offset:22560
    v_mfma_f32_16x16x32_bf16 v[84:87], v[140:143], a[140:143], v[84:87]
    ds_read_b64_tr_b16 v[134:135], v226 offset:27168
    v_mfma_f32_16x16x32_bf16 v[88:91], v[144:147], a[136:139], v[88:91]
    ds_read_b64_tr_b16 v[136:137], v226 offset:22592
    buffer_load_dwordx4 v220, s[24:27], s59 offen lds
    v_mfma_f32_16x16x32_bf16 v[92:95], v[144:147], a[140:143], v[92:95]
    ds_read_b64_tr_b16 v[138:139], v226 offset:27200
    s_waitcnt lgkmcnt(6)
    v_mfma_f32_16x16x32_bf16 v[96:99], v[148:151], a[136:139], v[96:99]
    ds_read_b64_tr_b16 v[140:141], v226 offset:22624
    buffer_load_dwordx4 a[204:207], v1, s[20:23], s78 offen offset:0 sc1
    v_mfma_f32_16x16x32_bf16 v[100:103], v[148:151], a[140:143], v[100:103]
    ds_read_b64_tr_b16 v[142:143], v226 offset:27232
    s_add_u32 m0, s56, 5120
    v_mfma_f32_16x16x32_bf16 v[104:107], v[120:123], a[136:139], v[104:107]
    ds_read_b64_tr_b16 v[144:145], v226 offset:22656
    v_mfma_f32_16x16x32_bf16 v[108:111], v[120:123], a[140:143], v[108:111]
    ds_read_b64_tr_b16 v[146:147], v226 offset:27264
    v_mfma_f32_16x16x32_bf16 v[112:115], v[124:127], a[136:139], v[112:115]
    ds_read_b64_tr_b16 v[148:149], v226 offset:22688
    v_mfma_f32_16x16x32_bf16 v[116:119], v[124:127], a[140:143], v[116:119]
    ds_read_b64_tr_b16 v[150:151], v226 offset:27296
    s_waitcnt vmcnt(31)
    s_waitcnt lgkmcnt(6)
    v_mfma_f32_16x16x32_bf16 v[48:51], v[128:131], a[144:147], v[48:51]
    ds_read_b64_tr_b16 v[120:121], v226 offset:22720
    buffer_load_dwordx4 v221, s[24:27], s59 offen lds
    v_mfma_f32_16x16x32_bf16 v[52:55], v[128:131], a[148:151], v[52:55]
    ds_read_b64_tr_b16 v[122:123], v226 offset:27328
    v_mfma_f32_16x16x32_bf16 v[56:59], v[132:135], a[144:147], v[56:59]
    ds_read_b64_tr_b16 v[124:125], v226 offset:22752
    s_add_u32 m0, s56, 6144
    v_mfma_f32_16x16x32_bf16 v[60:63], v[132:135], a[148:151], v[60:63]
    ds_read_b64_tr_b16 v[126:127], v226 offset:27360
    buffer_load_dwordx4 a[208:211], v1, s[20:23], s75 offen offset:1024 sc1
    v_mfma_f32_16x16x32_bf16 v[64:67], v[136:139], a[144:147], v[64:67]
    ds_read_b64_tr_b16 v[128:129], v226 offset:22784
    v_mfma_f32_16x16x32_bf16 v[68:71], v[136:139], a[148:151], v[68:71]
    ds_read_b64_tr_b16 v[130:131], v226 offset:27392
    s_waitcnt lgkmcnt(6)
    v_mfma_f32_16x16x32_bf16 v[72:75], v[140:143], a[144:147], v[72:75]
    ds_read_b64_tr_b16 v[132:133], v226 offset:31744
    buffer_load_dwordx4 v222, s[24:27], s59 offen lds
    v_mfma_f32_16x16x32_bf16 v[76:79], v[140:143], a[148:151], v[76:79]
    ds_read_b64_tr_b16 v[134:135], v226 offset:36352
    v_mfma_f32_16x16x32_bf16 v[80:83], v[144:147], a[144:147], v[80:83]
    ds_read_b64_tr_b16 v[136:137], v226 offset:31776
    s_add_u32 m0, s56, 7168
    v_mfma_f32_16x16x32_bf16 v[84:87], v[144:147], a[148:151], v[84:87]
    ds_read_b64_tr_b16 v[138:139], v226 offset:36384
    v_mfma_f32_16x16x32_bf16 v[88:91], v[148:151], a[144:147], v[88:91]
    ds_read_b64_tr_b16 v[140:141], v226 offset:31808
    buffer_load_dwordx4 a[212:215], v1, s[20:23], s76 offen offset:1024 sc1
    v_mfma_f32_16x16x32_bf16 v[92:95], v[148:151], a[148:151], v[92:95]
    ds_read_b64_tr_b16 v[142:143], v226 offset:36416
    s_waitcnt lgkmcnt(6)
    v_mfma_f32_16x16x32_bf16 v[96:99], v[120:123], a[144:147], v[96:99]
    ds_read_b64_tr_b16 v[144:145], v226 offset:31840
    buffer_load_dwordx4 v223, s[24:27], s59 offen lds
    v_mfma_f32_16x16x32_bf16 v[100:103], v[120:123], a[148:151], v[100:103]
    ds_read_b64_tr_b16 v[146:147], v226 offset:36448
    v_mfma_f32_16x16x32_bf16 v[104:107], v[124:127], a[144:147], v[104:107]
    ds_read_b64_tr_b16 v[148:149], v226 offset:31872
    v_mfma_f32_16x16x32_bf16 v[108:111], v[124:127], a[148:151], v[108:111]
    ds_read_b64_tr_b16 v[150:151], v226 offset:36480
    s_add_u32 m0, s56, 8192
    v_mfma_f32_16x16x32_bf16 v[112:115], v[128:131], a[144:147], v[112:115]
    ds_read_b64_tr_b16 v[120:121], v226 offset:31904
    v_mfma_f32_16x16x32_bf16 v[116:119], v[128:131], a[148:151], v[116:119]
    ds_read_b64_tr_b16 v[122:123], v226 offset:36512
    s_waitcnt vmcnt(32)
    s_waitcnt lgkmcnt(6)
    v_mfma_f32_16x16x32_bf16 v[48:51], v[132:135], a[152:155], v[48:51]
    ds_read_b64_tr_b16 v[124:125], v226 offset:31936
    buffer_load_dwordx4 v224, s[24:27], s59 offen lds
    v_mfma_f32_16x16x32_bf16 v[52:55], v[132:135], a[156:159], v[52:55]
    ds_read_b64_tr_b16 v[126:127], v226 offset:36544
    v_mfma_f32_16x16x32_bf16 v[56:59], v[136:139], a[152:155], v[56:59]
    ds_read_b64_tr_b16 v[128:129], v226 offset:31968
    buffer_load_dwordx4 a[216:219], v1, s[20:23], s77 offen offset:1024 sc1
    v_mfma_f32_16x16x32_bf16 v[60:63], v[136:139], a[156:159], v[60:63]
    ds_read_b64_tr_b16 v[130:131], v226 offset:36576
    v_mfma_f32_16x16x32_bf16 v[64:67], v[140:143], a[152:155], v[64:67]
    ds_read_b64_tr_b16 v[132:133], v226 offset:32000
    v_mfma_f32_16x16x32_bf16 v[68:71], v[140:143], a[156:159], v[68:71]
    ds_read_b64_tr_b16 v[134:135], v226 offset:36608
    s_waitcnt vmcnt(18)
    s_barrier
    s_waitcnt lgkmcnt(6)
    v_mfma_f32_16x16x32_bf16 v[72:75], v[144:147], a[152:155], v[72:75]
    ds_read_b64_tr_b16 v[136:137], v226 offset:40960
    v_mfma_f32_16x16x32_bf16 v[76:79], v[144:147], a[156:159], v[76:79]
    ds_read_b64_tr_b16 v[138:139], v226 offset:45568
    s_mov_b32 s59, 442368
    s_cmp_lt_u32 s3, 2
    s_cselect_b32 s59, s59, 626688
    s_add_u32 s59, s59, s46
    v_mfma_f32_16x16x32_bf16 v[80:83], v[148:151], a[152:155], v[80:83]
    ds_read_b64_tr_b16 v[140:141], v226 offset:40992
    v_mfma_f32_16x16x32_bf16 v[84:87], v[148:151], a[156:159], v[84:87]
    ds_read_b64_tr_b16 v[142:143], v226 offset:45600
    v_mfma_f32_16x16x32_bf16 v[88:91], v[120:123], a[152:155], v[88:91]
    ds_read_b64_tr_b16 v[144:145], v226 offset:41024
    buffer_load_dwordx4 a[220:223], v1, s[20:23], s78 offen offset:1024 sc1
    v_mfma_f32_16x16x32_bf16 v[92:95], v[120:123], a[156:159], v[92:95]
    ds_read_b64_tr_b16 v[146:147], v226 offset:45632
    s_waitcnt lgkmcnt(6)
    v_mfma_f32_16x16x32_bf16 v[96:99], v[124:127], a[152:155], v[96:99]
    ds_read_b64_tr_b16 v[148:149], v226 offset:41056
    v_mfma_f32_16x16x32_bf16 v[100:103], v[124:127], a[156:159], v[100:103]
    ds_read_b64_tr_b16 v[150:151], v226 offset:45664
    v_mfma_f32_16x16x32_bf16 v[104:107], v[128:131], a[152:155], v[104:107]
    ds_read_b64_tr_b16 v[120:121], v226 offset:41088
    v_mfma_f32_16x16x32_bf16 v[108:111], v[128:131], a[156:159], v[108:111]
    ds_read_b64_tr_b16 v[122:123], v226 offset:45696
    v_mfma_f32_16x16x32_bf16 v[112:115], v[132:135], a[152:155], v[112:115]
    ds_read_b64_tr_b16 v[124:125], v226 offset:41120
    s_add_u32 m0, s57, 0
    v_mfma_f32_16x16x32_bf16 v[116:119], v[132:135], a[156:159], v[116:119]
    ds_read_b64_tr_b16 v[126:127], v226 offset:45728
    s_waitcnt vmcnt(30)
    s_waitcnt lgkmcnt(6)
    v_mfma_f32_16x16x32_bf16 v[48:51], v[136:139], a[160:163], v[48:51]
    ds_read_b64_tr_b16 v[128:129], v226 offset:41152
    v_mfma_f32_16x16x32_bf16 v[52:55], v[136:139], a[164:167], v[52:55]
    ds_read_b64_tr_b16 v[130:131], v226 offset:45760
    v_mfma_f32_16x16x32_bf16 v[56:59], v[140:143], a[160:163], v[56:59]
    ds_read_b64_tr_b16 v[132:133], v226 offset:41184
    buffer_load_dwordx4 v216, s[24:27], s59 offen lds
    v_mfma_f32_16x16x32_bf16 v[60:63], v[140:143], a[164:167], v[60:63]
    ds_read_b64_tr_b16 v[134:135], v226 offset:45792
    buffer_load_dwordx4 a[224:227], v1, s[20:23], s75 offen offset:2048 sc1
    v_mfma_f32_16x16x32_bf16 v[64:67], v[144:147], a[160:163], v[64:67]
    ds_read_b64_tr_b16 v[136:137], v226 offset:41216
    v_mfma_f32_16x16x32_bf16 v[68:71], v[144:147], a[164:167], v[68:71]
    ds_read_b64_tr_b16 v[138:139], v226 offset:45824
    s_waitcnt lgkmcnt(6)
    v_mfma_f32_16x16x32_bf16 v[72:75], v[148:151], a[160:163], v[72:75]
    ds_read_b64_tr_b16 v[140:141], v226 offset:50176
    s_add_u32 m0, s57, 1024
    v_mfma_f32_16x16x32_bf16 v[76:79], v[148:151], a[164:167], v[76:79]
    ds_read_b64_tr_b16 v[142:143], v226 offset:54784
    v_mfma_f32_16x16x32_bf16 v[80:83], v[120:123], a[160:163], v[80:83]
    ds_read_b64_tr_b16 v[144:145], v226 offset:50208
    buffer_load_dwordx4 v217, s[24:27], s59 offen lds
    v_mfma_f32_16x16x32_bf16 v[84:87], v[120:123], a[164:167], v[84:87]
    ds_read_b64_tr_b16 v[146:147], v226 offset:54816
    v_mfma_f32_16x16x32_bf16 v[88:91], v[124:127], a[160:163], v[88:91]
    ds_read_b64_tr_b16 v[148:149], v226 offset:50240
    buffer_load_dwordx4 a[228:231], v1, s[20:23], s76 offen offset:2048 sc1
    v_mfma_f32_16x16x32_bf16 v[92:95], v[124:127], a[164:167], v[92:95]
    ds_read_b64_tr_b16 v[150:151], v226 offset:54848
    s_waitcnt lgkmcnt(6)
    v_mfma_f32_16x16x32_bf16 v[96:99], v[128:131], a[160:163], v[96:99]
    ds_read_b64_tr_b16 v[120:121], v226 offset:50272
    s_add_u32 m0, s57, 2048
    v_mfma_f32_16x16x32_bf16 v[100:103], v[128:131], a[164:167], v[100:103]
    ds_read_b64_tr_b16 v[122:123], v226 offset:54880
    v_mfma_f32_16x16x32_bf16 v[104:107], v[132:135], a[160:163], v[104:107]
    ds_read_b64_tr_b16 v[124:125], v226 offset:50304
    v_mfma_f32_16x16x32_bf16 v[108:111], v[132:135], a[164:167], v[108:111]
    ds_read_b64_tr_b16 v[126:127], v226 offset:54912
    buffer_load_dwordx4 v218, s[24:27], s59 offen lds
    v_mfma_f32_16x16x32_bf16 v[112:115], v[136:139], a[160:163], v[112:115]
    ds_read_b64_tr_b16 v[128:129], v226 offset:50336
    v_mfma_f32_16x16x32_bf16 v[116:119], v[136:139], a[164:167], v[116:119]
    ds_read_b64_tr_b16 v[130:131], v226 offset:54944
    s_waitcnt vmcnt(30)
    s_waitcnt lgkmcnt(6)
    v_mfma_f32_16x16x32_bf16 v[48:51], v[140:143], a[168:171], v[48:51]
    ds_read_b64_tr_b16 v[132:133], v226 offset:50368
    s_add_u32 m0, s57, 3072
    v_mfma_f32_16x16x32_bf16 v[52:55], v[140:143], a[172:175], v[52:55]
    ds_read_b64_tr_b16 v[134:135], v226 offset:54976
    v_mfma_f32_16x16x32_bf16 v[56:59], v[144:147], a[168:171], v[56:59]
    ds_read_b64_tr_b16 v[136:137], v226 offset:50400
    buffer_load_dwordx4 a[232:235], v1, s[20:23], s77 offen offset:2048 sc1
    v_mfma_f32_16x16x32_bf16 v[60:63], v[144:147], a[172:175], v[60:63]
    ds_read_b64_tr_b16 v[138:139], v226 offset:55008
    buffer_load_dwordx4 v219, s[24:27], s59 offen lds
    v_mfma_f32_16x16x32_bf16 v[64:67], v[148:151], a[168:171], v[64:67]
    ds_read_b64_tr_b16 v[140:141], v226 offset:50432
    v_mfma_f32_16x16x32_bf16 v[68:71], v[148:151], a[172:175], v[68:71]
    ds_read_b64_tr_b16 v[142:143], v226 offset:55040
    s_waitcnt lgkmcnt(6)
    v_mfma_f32_16x16x32_bf16 v[72:75], v[120:123], a[168:171], v[72:75]
    ds_read_b64_tr_b16 v[144:145], v226 offset:59392
    v_mfma_f32_16x16x32_bf16 v[76:79], v[120:123], a[172:175], v[76:79]
    ds_read_b64_tr_b16 v[146:147], v226 offset:64000
    s_add_u32 m0, s57, 4096
    v_mfma_f32_16x16x32_bf16 v[80:83], v[124:127], a[168:171], v[80:83]
    ds_read_b64_tr_b16 v[148:149], v226 offset:59424
    v_mfma_f32_16x16x32_bf16 v[84:87], v[124:127], a[172:175], v[84:87]
    ds_read_b64_tr_b16 v[150:151], v226 offset:64032
    v_mfma_f32_16x16x32_bf16 v[88:91], v[128:131], a[168:171], v[88:91]
    ds_read_b64_tr_b16 v[120:121], v226 offset:59456
    buffer_load_dwordx4 v220, s[24:27], s59 offen lds
    v_mfma_f32_16x16x32_bf16 v[92:95], v[128:131], a[172:175], v[92:95]
    ds_read_b64_tr_b16 v[122:123], v226 offset:64064
    s_waitcnt lgkmcnt(6)
    v_mfma_f32_16x16x32_bf16 v[96:99], v[132:135], a[168:171], v[96:99]
    ds_read_b64_tr_b16 v[124:125], v226 offset:59488
    buffer_load_dwordx4 a[236:239], v1, s[20:23], s78 offen offset:2048 sc1
    v_mfma_f32_16x16x32_bf16 v[100:103], v[132:135], a[172:175], v[100:103]
    ds_read_b64_tr_b16 v[126:127], v226 offset:64096
    s_add_u32 m0, s57, 5120
    v_mfma_f32_16x16x32_bf16 v[104:107], v[136:139], a[168:171], v[104:107]
    ds_read_b64_tr_b16 v[128:129], v226 offset:59520
    v_mfma_f32_16x16x32_bf16 v[108:111], v[136:139], a[172:175], v[108:111]
    ds_read_b64_tr_b16 v[130:131], v226 offset:64128
    v_mfma_f32_16x16x32_bf16 v[112:115], v[140:143], a[168:171], v[112:115]
    ds_read_b64_tr_b16 v[132:133], v226 offset:59552
    v_mfma_f32_16x16x32_bf16 v[116:119], v[140:143], a[172:175], v[116:119]
    ds_read_b64_tr_b16 v[134:135], v226 offset:64160
    s_waitcnt vmcnt(30)
    s_waitcnt lgkmcnt(6)
    v_mfma_f32_16x16x32_bf16 v[48:51], v[144:147], a[176:179], v[48:51]
    ds_read_b64_tr_b16 v[136:137], v226 offset:59584
    buffer_load_dwordx4 v221, s[24:27], s59 offen lds
    v_mfma_f32_16x16x32_bf16 v[52:55], v[144:147], a[180:183], v[52:55]
    ds_read_b64_tr_b16 v[138:139], v226 offset:64192
    v_mfma_f32_16x16x32_bf16 v[56:59], v[148:151], a[176:179], v[56:59]
    ds_read_b64_tr_b16 v[140:141], v226 offset:59616
    s_add_u32 m0, s57, 6144
    v_mfma_f32_16x16x32_bf16 v[60:63], v[148:151], a[180:183], v[60:63]
    ds_read_b64_tr_b16 v[142:143], v226 offset:64224
    buffer_load_dwordx4 a[240:243], v1, s[20:23], s75 offen offset:3072 sc1
    v_mfma_f32_16x16x32_bf16 v[64:67], v[120:123], a[176:179], v[64:67]
    ds_read_b64_tr_b16 v[144:145], v226 offset:59648
    v_mfma_f32_16x16x32_bf16 v[68:71], v[120:123], a[180:183], v[68:71]
    ds_read_b64_tr_b16 v[146:147], v226 offset:64256
    s_waitcnt lgkmcnt(6)
    v_mfma_f32_16x16x32_bf16 v[72:75], v[124:127], a[176:179], v[72:75]
    ds_read_b64_tr_b16 v[148:149], v227 offset:7168
    buffer_load_dwordx4 v222, s[24:27], s59 offen lds
    v_mfma_f32_16x16x32_bf16 v[76:79], v[124:127], a[180:183], v[76:79]
    ds_read_b64_tr_b16 v[150:151], v227 offset:11776
    v_mfma_f32_16x16x32_bf16 v[80:83], v[128:131], a[176:179], v[80:83]
    ds_read_b64_tr_b16 v[120:121], v227 offset:7200
    s_add_u32 m0, s57, 7168
    v_mfma_f32_16x16x32_bf16 v[84:87], v[128:131], a[180:183], v[84:87]
    ds_read_b64_tr_b16 v[122:123], v227 offset:11808
    v_mfma_f32_16x16x32_bf16 v[88:91], v[132:135], a[176:179], v[88:91]
    ds_read_b64_tr_b16 v[124:125], v227 offset:7232
    buffer_load_dwordx4 a[244:247], v1, s[20:23], s76 offen offset:3072 sc1
    v_mfma_f32_16x16x32_bf16 v[92:95], v[132:135], a[180:183], v[92:95]
    ds_read_b64_tr_b16 v[126:127], v227 offset:11840
    s_waitcnt lgkmcnt(6)
    v_mfma_f32_16x16x32_bf16 v[96:99], v[136:139], a[176:179], v[96:99]
    ds_read_b64_tr_b16 v[128:129], v227 offset:7264
    buffer_load_dwordx4 v223, s[24:27], s59 offen lds
    v_mfma_f32_16x16x32_bf16 v[100:103], v[136:139], a[180:183], v[100:103]
    ds_read_b64_tr_b16 v[130:131], v227 offset:11872
    v_mfma_f32_16x16x32_bf16 v[104:107], v[140:143], a[176:179], v[104:107]
    ds_read_b64_tr_b16 v[132:133], v227 offset:7296
    v_mfma_f32_16x16x32_bf16 v[108:111], v[140:143], a[180:183], v[108:111]
    ds_read_b64_tr_b16 v[134:135], v227 offset:11904
    s_add_u32 m0, s57, 8192
    v_mfma_f32_16x16x32_bf16 v[112:115], v[144:147], a[176:179], v[112:115]
    ds_read_b64_tr_b16 v[136:137], v227 offset:7328
    v_mfma_f32_16x16x32_bf16 v[116:119], v[144:147], a[180:183], v[116:119]
    ds_read_b64_tr_b16 v[138:139], v227 offset:11936
    s_waitcnt vmcnt(31)
    s_waitcnt lgkmcnt(6)
    v_mfma_f32_16x16x32_bf16 v[48:51], v[148:151], a[184:187], v[48:51]
    ds_read_b64_tr_b16 v[140:141], v227 offset:7360
    buffer_load_dwordx4 v224, s[24:27], s59 offen lds
    v_mfma_f32_16x16x32_bf16 v[52:55], v[148:151], a[188:191], v[52:55]
    ds_read_b64_tr_b16 v[142:143], v227 offset:11968
    v_mfma_f32_16x16x32_bf16 v[56:59], v[120:123], a[184:187], v[56:59]
    ds_read_b64_tr_b16 v[144:145], v227 offset:7392
    buffer_load_dwordx4 a[248:251], v1, s[20:23], s77 offen offset:3072 sc1
    v_mfma_f32_16x16x32_bf16 v[60:63], v[120:123], a[188:191], v[60:63]
    ds_read_b64_tr_b16 v[146:147], v227 offset:12000
    v_mfma_f32_16x16x32_bf16 v[64:67], v[124:127], a[184:187], v[64:67]
    ds_read_b64_tr_b16 v[148:149], v227 offset:7424
    buffer_load_dwordx4 a[252:255], v1, s[20:23], s78 offen offset:3072 sc1
    v_mfma_f32_16x16x32_bf16 v[68:71], v[124:127], a[188:191], v[68:71]
    ds_read_b64_tr_b16 v[150:151], v227 offset:12032
    s_waitcnt vmcnt(19)
    s_barrier
    s_waitcnt lgkmcnt(6)
    v_mfma_f32_16x16x32_bf16 v[72:75], v[128:131], a[184:187], v[72:75]
    ds_read_b64_tr_b16 v[120:121], v227 offset:16384
    v_mfma_f32_16x16x32_bf16 v[76:79], v[128:131], a[188:191], v[76:79]
    ds_read_b64_tr_b16 v[122:123], v227 offset:20992
    s_mov_b32 s59, 147456
    s_cmp_lt_u32 s3, 2
    s_cselect_b32 s59, s59, 479232
    s_add_u32 s59, s59, s46
    v_mfma_f32_16x16x32_bf16 v[80:83], v[132:135], a[184:187], v[80:83]
    ds_read_b64_tr_b16 v[124:125], v227 offset:16416
    s_add_u32 s75, s75, 4096
    s_add_u32 s76, s76, 4096
    v_mfma_f32_16x16x32_bf16 v[84:87], v[132:135], a[188:191], v[84:87]
    ds_read_b64_tr_b16 v[126:127], v227 offset:21024
    v_mfma_f32_16x16x32_bf16 v[88:91], v[136:139], a[184:187], v[88:91]
    ds_read_b64_tr_b16 v[128:129], v227 offset:16448
    v_mfma_f32_16x16x32_bf16 v[92:95], v[136:139], a[188:191], v[92:95]
    ds_read_b64_tr_b16 v[130:131], v227 offset:21056
    s_waitcnt lgkmcnt(6)
    v_mfma_f32_16x16x32_bf16 v[96:99], v[140:143], a[184:187], v[96:99]
    ds_read_b64_tr_b16 v[132:133], v227 offset:16480
    s_add_u32 s77, s77, 4096
    s_add_u32 s78, s78, 4096
    v_mfma_f32_16x16x32_bf16 v[100:103], v[140:143], a[188:191], v[100:103]
    ds_read_b64_tr_b16 v[134:135], v227 offset:21088
    v_mfma_f32_16x16x32_bf16 v[104:107], v[144:147], a[184:187], v[104:107]
    ds_read_b64_tr_b16 v[136:137], v227 offset:16512
    v_mfma_f32_16x16x32_bf16 v[108:111], v[144:147], a[188:191], v[108:111]
    ds_read_b64_tr_b16 v[138:139], v227 offset:21120
    v_mfma_f32_16x16x32_bf16 v[112:115], v[148:151], a[184:187], v[112:115]
    ds_read_b64_tr_b16 v[140:141], v227 offset:16544
    s_add_u32 m0, s54, 0
    v_mfma_f32_16x16x32_bf16 v[116:119], v[148:151], a[188:191], v[116:119]
    ds_read_b64_tr_b16 v[142:143], v227 offset:21152
    s_waitcnt vmcnt(30)
    s_waitcnt lgkmcnt(6)
    v_and_b32 v228, 15, v0
    v_mul_u32_u24 v228, 1152, v228
    v_lshrrev_b32 v11, 4, v0
    v_lshl_add_u32 v228, v11, 3, v228
    v_lshrrev_b32 v229, 2, v0
    v_lshlrev_b32 v229, 12, v229
    v_and_b32 v12, 3, v0
    v_lshl_add_u32 v229, v12, 4, v229
    s_mul_i32 s65, s3, 3072
    s_add_u32 s65, s65, 139264
    v_add_u32 v230, s65, v1
    v_bfe_u32 v12, v0, 2, 2
    v_lshl_add_u32 v12, v11, 2, v12
    v_lshlrev_b32 v12, 6, v12
    v_and_b32 v13, 3, v0
    v_lshl_add_u32 v12, v13, 3, v12
    v_add_u32 v231, s65, v12
    s_lshl_b32 s65, s58, 7
    s_lshl_b32 s66, s60, 5
    s_add_u32 s65, s65, s66
    s_mul_i32 s66, s64, 144
    s_lshl_b32 s67, s3, 4
    s_add_u32 s66, s66, s67
    s_mul_i32 s72, s65, 1152
    s_lshl_b32 s67, s66, 1
    s_add_u32 s72, s72, s67
    s_lshl_b32 s73, s66, 12
    s_lshl_b32 s67, s65, 1
    s_add_u32 s73, s73, s67
    s_lshl_b32 s65, s58, 2
    s_add_u32 s65, s65, s64
    s_lshl_b32 s65, s65, 2
    s_add_u32 s65, s65, s60
    s_mul_i32 s65, s65, 9
    s_add_u32 s65, s65, s3
    s_lshl_b32 s74, s65, 12
    v_and_b32 v11, 7, v0
    v_lshlrev_b32 v11, 7, v11
    s_mov_b32 s68, 12288
    buffer_load_dword v14, v11, s[36:39], s68 offen sc1
    v_mfma_f32_16x16x32_bf16 v[48:51], v[120:123], a[192:195], v[48:51]
    ds_read_b64_tr_b16 v[144:145], v227 offset:16576
    v_mfma_f32_16x16x32_bf16 v[52:55], v[120:123], a[196:199], v[52:55]
    ds_read_b64_tr_b16 v[146:147], v227 offset:21184
    v_mfma_f32_16x16x32_bf16 v[56:59], v[124:127], a[192:195], v[56:59]
    ds_read_b64_tr_b16 v[148:149], v227 offset:16608
    buffer_load_dwordx4 v216, s[24:27], s59 offen lds
    v_mfma_f32_16x16x32_bf16 v[60:63], v[124:127], a[196:199], v[60:63]
    ds_read_b64_tr_b16 v[150:151], v227 offset:21216
    buffer_load_dwordx4 v[16:19], v1, s[20:23], s75 offen offset:0 sc1
    v_mfma_f32_16x16x32_bf16 v[64:67], v[128:131], a[192:195], v[64:67]
    ds_read_b64_tr_b16 v[120:121], v227 offset:16640
    v_mfma_f32_16x16x32_bf16 v[68:71], v[128:131], a[196:199], v[68:71]
    ds_read_b64_tr_b16 v[122:123], v227 offset:21248
    s_waitcnt lgkmcnt(6)
    v_mfma_f32_16x16x32_bf16 v[72:75], v[132:135], a[192:195], v[72:75]
    ds_read_b64_tr_b16 v[124:125], v227 offset:25600
    s_add_u32 m0, s54, 1024
    v_mfma_f32_16x16x32_bf16 v[76:79], v[132:135], a[196:199], v[76:79]
    ds_read_b64_tr_b16 v[126:127], v227 offset:30208
    v_mfma_f32_16x16x32_bf16 v[80:83], v[136:139], a[192:195], v[80:83]
    ds_read_b64_tr_b16 v[128:129], v227 offset:25632
    buffer_load_dwordx4 v217, s[24:27], s59 offen lds
    v_mfma_f32_16x16x32_bf16 v[84:87], v[136:139], a[196:199], v[84:87]
    ds_read_b64_tr_b16 v[130:131], v227 offset:30240
    v_mfma_f32_16x16x32_bf16 v[88:91], v[140:143], a[192:195], v[88:91]
    ds_read_b64_tr_b16 v[132:133], v227 offset:25664
    buffer_load_dwordx4 v[20:23], v1, s[20:23], s76 offen offset:0 sc1
    v_mfma_f32_16x16x32_bf16 v[92:95], v[140:143], a[196:199], v[92:95]
    ds_read_b64_tr_b16 v[134:135], v227 offset:30272
    s_waitcnt lgkmcnt(6)
    v_mfma_f32_16x16x32_bf16 v[96:99], v[144:147], a[192:195], v[96:99]
    ds_read_b64_tr_b16 v[136:137], v227 offset:25696
    s_add_u32 m0, s54, 2048
    v_mfma_f32_16x16x32_bf16 v[100:103], v[144:147], a[196:199], v[100:103]
    ds_read_b64_tr_b16 v[138:139], v227 offset:30304
    v_mfma_f32_16x16x32_bf16 v[104:107], v[148:151], a[192:195], v[104:107]
    ds_read_b64_tr_b16 v[140:141], v227 offset:25728
    v_mfma_f32_16x16x32_bf16 v[108:111], v[148:151], a[196:199], v[108:111]
    ds_read_b64_tr_b16 v[142:143], v227 offset:30336
    buffer_load_dwordx4 v218, s[24:27], s59 offen lds
    v_mfma_f32_16x16x32_bf16 v[112:115], v[120:123], a[192:195], v[112:115]
    ds_read_b64_tr_b16 v[144:145], v227 offset:25760
    v_mfma_f32_16x16x32_bf16 v[116:119], v[120:123], a[196:199], v[116:119]
    ds_read_b64_tr_b16 v[146:147], v227 offset:30368
    s_waitcnt vmcnt(31)
    s_waitcnt lgkmcnt(6)
    v_mfma_f32_16x16x32_bf16 v[48:51], v[124:127], a[200:203], v[48:51]
    ds_read_b64_tr_b16 v[148:149], v227 offset:25792
    s_add_u32 m0, s54, 3072
    v_mfma_f32_16x16x32_bf16 v[52:55], v[124:127], a[204:207], v[52:55]
    ds_read_b64_tr_b16 v[150:151], v227 offset:30400
    v_mfma_f32_16x16x32_bf16 v[56:59], v[128:131], a[200:203], v[56:59]
    ds_read_b64_tr_b16 v[120:121], v227 offset:25824
    buffer_load_dwordx4 v[24:27], v1, s[20:23], s77 offen offset:0 sc1
    v_mfma_f32_16x16x32_bf16 v[60:63], v[128:131], a[204:207], v[60:63]
    ds_read_b64_tr_b16 v[122:123], v227 offset:30432
    buffer_load_dwordx4 v219, s[24:27], s59 offen lds
    v_mfma_f32_16x16x32_bf16 v[64:67], v[132:135], a[200:203], v[64:67]
    ds_read_b64_tr_b16 v[124:125], v227 offset:25856
    v_mfma_f32_16x16x32_bf16 v[68:71], v[132:135], a[204:207], v[68:71]
    ds_read_b64_tr_b16 v[126:127], v227 offset:30464
    s_waitcnt lgkmcnt(6)
    v_mfma_f32_16x16x32_bf16 v[72:75], v[136:139], a[200:203], v[72:75]
    ds_read_b64_tr_b16 v[128:129], v225 offset:0
    v_mfma_f32_16x16x32_bf16 v[76:79], v[136:139], a[204:207], v[76:79]
    ds_read_b64_tr_b16 v[130:131], v225 offset:4608
    s_add_u32 m0, s54, 4096
    v_mfma_f32_16x16x32_bf16 v[80:83], v[140:143], a[200:203], v[80:83]
    ds_read_b64_tr_b16 v[132:133], v225 offset:32
    v_mfma_f32_16x16x32_bf16 v[84:87], v[140:143], a[204:207], v[84:87]
    ds_read_b64_tr_b16 v[134:135], v225 offset:4640
    v_mfma_f32_16x16x32_bf16 v[88:91], v[144:147], a[200:203], v[88:91]
    ds_read_b64_tr_b16 v[136:137], v225 offset:64
    buffer_load_dwordx4 v220, s[24:27], s59 offen lds
    v_mfma_f32_16x16x32_bf16 v[92:95], v[144:147], a[204:207], v[92:95]
    ds_read_b64_tr_b16 v[138:139], v225 offset:4672
    s_waitcnt lgkmcnt(6)
    v_mfma_f32_16x16x32_bf16 v[96:99], v[148:151], a[200:203], v[96:99]
    ds_read_b64_tr_b16 v[140:141], v225 offset:96
    buffer_load_dwordx4 v[28:31], v1, s[20:23], s78 offen offset:0 sc1
    v_mfma_f32_16x16x32_bf16 v[100:103], v[148:151], a[204:207], v[100:103]
    ds_read_b64_tr_b16 v[142:143], v225 offset:4704
    s_add_u32 m0, s54, 5120
    v_mfma_f32_16x16x32_bf16 v[104:107], v[120:123], a[200:203], v[104:107]
    ds_read_b64_tr_b16 v[144:145], v225 offset:128
    v_mfma_f32_16x16x32_bf16 v[108:111], v[120:123], a[204:207], v[108:111]
    ds_read_b64_tr_b16 v[146:147], v225 offset:4736
    v_mfma_f32_16x16x32_bf16 v[112:115], v[124:127], a[200:203], v[112:115]
    ds_read_b64_tr_b16 v[148:149], v225 offset:160
    v_mfma_f32_16x16x32_bf16 v[116:119], v[124:127], a[204:207], v[116:119]
    ds_read_b64_tr_b16 v[150:151], v225 offset:4768
    s_waitcnt vmcnt(31)
    s_waitcnt lgkmcnt(6)
    v_mfma_f32_16x16x32_bf16 v[48:51], v[128:131], a[208:211], v[48:51]
    ds_read_b64_tr_b16 v[120:121], v225 offset:192
    buffer_load_dwordx4 v221, s[24:27], s59 offen lds
    v_mfma_f32_16x16x32_bf16 v[52:55], v[128:131], a[212:215], v[52:55]
    ds_read_b64_tr_b16 v[122:123], v225 offset:4800
    v_mfma_f32_16x16x32_bf16 v[56:59], v[132:135], a[208:211], v[56:59]
    ds_read_b64_tr_b16 v[124:125], v225 offset:224
    s_add_u32 m0, s54, 6144
    v_mfma_f32_16x16x32_bf16 v[60:63], v[132:135], a[212:215], v[60:63]
    ds_read_b64_tr_b16 v[126:127], v225 offset:4832
    buffer_load_dwordx4 v[32:35], v1, s[20:23], s75 offen offset:1024 sc1
    v_mfma_f32_16x16x32_bf16 v[64:67], v[136:139], a[208:211], v[64:67]
    ds_read_b64_tr_b16 v[128:129], v225 offset:256
    v_mfma_f32_16x16x32_bf16 v[68:71], v[136:139], a[212:215], v[68:71]
    ds_read_b64_tr_b16 v[130:131], v225 offset:4864
    s_waitcnt lgkmcnt(6)
    v_mfma_f32_16x16x32_bf16 v[72:75], v[140:143], a[208:211], v[72:75]
    ds_read_b64_tr_b16 v[132:133], v225 offset:9216
    buffer_load_dwordx4 v222, s[24:27], s59 offen lds
    v_mfma_f32_16x16x32_bf16 v[76:79], v[140:143], a[212:215], v[76:79]
    ds_read_b64_tr_b16 v[134:135], v225 offset:13824
    v_mfma_f32_16x16x32_bf16 v[80:83], v[144:147], a[208:211], v[80:83]
    ds_read_b64_tr_b16 v[136:137], v225 offset:9248
    s_add_u32 m0, s54, 7168
    v_mfma_f32_16x16x32_bf16 v[84:87], v[144:147], a[212:215], v[84:87]
    ds_read_b64_tr_b16 v[138:139], v225 offset:13856
    v_mfma_f32_16x16x32_bf16 v[88:91], v[148:151], a[208:211], v[88:91]
    ds_read_b64_tr_b16 v[140:141], v225 offset:9280
    buffer_load_dwordx4 v[36:39], v1, s[20:23], s76 offen offset:1024 sc1
    v_mfma_f32_16x16x32_bf16 v[92:95], v[148:151], a[212:215], v[92:95]
    ds_read_b64_tr_b16 v[142:143], v225 offset:13888
    s_waitcnt lgkmcnt(6)
    v_mfma_f32_16x16x32_bf16 v[96:99], v[120:123], a[208:211], v[96:99]
    ds_read_b64_tr_b16 v[144:145], v225 offset:9312
    buffer_load_dwordx4 v223, s[24:27], s59 offen lds
    v_mfma_f32_16x16x32_bf16 v[100:103], v[120:123], a[212:215], v[100:103]
    ds_read_b64_tr_b16 v[146:147], v225 offset:13920
    v_mfma_f32_16x16x32_bf16 v[104:107], v[124:127], a[208:211], v[104:107]
    ds_read_b64_tr_b16 v[148:149], v225 offset:9344
    v_mfma_f32_16x16x32_bf16 v[108:111], v[124:127], a[212:215], v[108:111]
    ds_read_b64_tr_b16 v[150:151], v225 offset:13952
    s_add_u32 m0, s54, 8192
    v_mfma_f32_16x16x32_bf16 v[112:115], v[128:131], a[208:211], v[112:115]
    ds_read_b64_tr_b16 v[120:121], v225 offset:9376
    v_mfma_f32_16x16x32_bf16 v[116:119], v[128:131], a[212:215], v[116:119]
    ds_read_b64_tr_b16 v[122:123], v225 offset:13984
    s_waitcnt vmcnt(32)
    s_waitcnt lgkmcnt(6)
    v_mfma_f32_16x16x32_bf16 v[48:51], v[132:135], a[216:219], v[48:51]
    ds_read_b64_tr_b16 v[124:125], v225 offset:9408
    buffer_load_dwordx4 v224, s[24:27], s59 offen lds
    v_mfma_f32_16x16x32_bf16 v[52:55], v[132:135], a[220:223], v[52:55]
    ds_read_b64_tr_b16 v[126:127], v225 offset:14016
    v_mfma_f32_16x16x32_bf16 v[56:59], v[136:139], a[216:219], v[56:59]
    ds_read_b64_tr_b16 v[128:129], v225 offset:9440
    buffer_load_dwordx4 v[40:43], v1, s[20:23], s77 offen offset:1024 sc1
    v_mfma_f32_16x16x32_bf16 v[60:63], v[136:139], a[220:223], v[60:63]
    ds_read_b64_tr_b16 v[130:131], v225 offset:14048
    v_mfma_f32_16x16x32_bf16 v[64:67], v[140:143], a[216:219], v[64:67]
    ds_read_b64_tr_b16 v[132:133], v225 offset:9472
    v_mfma_f32_16x16x32_bf16 v[68:71], v[140:143], a[220:223], v[68:71]
    ds_read_b64_tr_b16 v[134:135], v225 offset:14080
    s_waitcnt vmcnt(19)
    s_barrier
    s_waitcnt lgkmcnt(6)
    v_mfma_f32_16x16x32_bf16 v[72:75], v[144:147], a[216:219], v[72:75]
    ds_read_b64_tr_b16 v[136:137], v225 offset:18432
    v_mfma_f32_16x16x32_bf16 v[76:79], v[144:147], a[220:223], v[76:79]
    ds_read_b64_tr_b16 v[138:139], v225 offset:23040
    v_mfma_f32_16x16x32_bf16 v[80:83], v[148:151], a[216:219], v[80:83]
    ds_read_b64_tr_b16 v[140:141], v225 offset:18464
    v_mfma_f32_16x16x32_bf16 v[84:87], v[148:151], a[220:223], v[84:87]
    ds_read_b64_tr_b16 v[142:143], v225 offset:23072
    v_mfma_f32_16x16x32_bf16 v[88:91], v[120:123], a[216:219], v[88:91]
    ds_read_b64_tr_b16 v[144:145], v225 offset:18496
    buffer_load_dwordx4 v[44:47], v1, s[20:23], s78 offen offset:1024 sc1
    v_mfma_f32_16x16x32_bf16 v[92:95], v[120:123], a[220:223], v[92:95]
    ds_read_b64_tr_b16 v[146:147], v225 offset:23104
    s_waitcnt lgkmcnt(6)
    v_mfma_f32_16x16x32_bf16 v[96:99], v[124:127], a[216:219], v[96:99]
    ds_read_b64_tr_b16 v[148:149], v225 offset:18528
    v_mfma_f32_16x16x32_bf16 v[100:103], v[124:127], a[220:223], v[100:103]
    ds_read_b64_tr_b16 v[150:151], v225 offset:23136
    v_mfma_f32_16x16x32_bf16 v[104:107], v[128:131], a[216:219], v[104:107]
    ds_read_b64_tr_b16 v[120:121], v225 offset:18560
    v_mfma_f32_16x16x32_bf16 v[108:111], v[128:131], a[220:223], v[108:111]
    ds_read_b64_tr_b16 v[122:123], v225 offset:23168
    v_mfma_f32_16x16x32_bf16 v[112:115], v[132:135], a[216:219], v[112:115]
    ds_read_b64_tr_b16 v[124:125], v225 offset:18592
    v_mfma_f32_16x16x32_bf16 v[116:119], v[132:135], a[220:223], v[116:119]
    ds_read_b64_tr_b16 v[126:127], v225 offset:23200
    s_waitcnt vmcnt(31)
    s_waitcnt lgkmcnt(6)
    v_mfma_f32_16x16x32_bf16 v[48:51], v[136:139], a[224:227], v[48:51]
    ds_read_b64_tr_b16 v[128:129], v225 offset:18624
    v_mfma_f32_16x16x32_bf16 v[52:55], v[136:139], a[228:231], v[52:55]
    ds_read_b64_tr_b16 v[130:131], v225 offset:23232
    v_mfma_f32_16x16x32_bf16 v[56:59], v[140:143], a[224:227], v[56:59]
    ds_read_b64_tr_b16 v[132:133], v225 offset:18656
    v_mfma_f32_16x16x32_bf16 v[60:63], v[140:143], a[228:231], v[60:63]
    ds_read_b64_tr_b16 v[134:135], v225 offset:23264
    v_mfma_f32_16x16x32_bf16 v[64:67], v[144:147], a[224:227], v[64:67]
    ds_read_b64_tr_b16 v[136:137], v225 offset:18688
    v_mfma_f32_16x16x32_bf16 v[68:71], v[144:147], a[228:231], v[68:71]
    ds_read_b64_tr_b16 v[138:139], v225 offset:23296
    s_waitcnt lgkmcnt(6)
    v_mfma_f32_16x16x32_bf16 v[72:75], v[148:151], a[224:227], v[72:75]
    ds_read_b64_tr_b16 v[140:141], v225 offset:27648
    v_mfma_f32_16x16x32_bf16 v[76:79], v[148:151], a[228:231], v[76:79]
    ds_read_b64_tr_b16 v[142:143], v225 offset:32256
    v_mfma_f32_16x16x32_bf16 v[80:83], v[120:123], a[224:227], v[80:83]
    ds_read_b64_tr_b16 v[144:145], v225 offset:27680
    v_mfma_f32_16x16x32_bf16 v[84:87], v[120:123], a[228:231], v[84:87]
    ds_read_b64_tr_b16 v[146:147], v225 offset:32288
    v_mfma_f32_16x16x32_bf16 v[88:91], v[124:127], a[224:227], v[88:91]
    ds_read_b64_tr_b16 v[148:149], v225 offset:27712
    v_mfma_f32_16x16x32_bf16 v[92:95], v[124:127], a[228:231], v[92:95]
    ds_read_b64_tr_b16 v[150:151], v225 offset:32320
    s_waitcnt lgkmcnt(6)
    v_mfma_f32_16x16x32_bf16 v[96:99], v[128:131], a[224:227], v[96:99]
    ds_read_b64_tr_b16 v[120:121], v225 offset:27744
    v_mfma_f32_16x16x32_bf16 v[100:103], v[128:131], a[228:231], v[100:103]
    ds_read_b64_tr_b16 v[122:123], v225 offset:32352
    v_mfma_f32_16x16x32_bf16 v[104:107], v[132:135], a[224:227], v[104:107]
    ds_read_b64_tr_b16 v[124:125], v225 offset:27776
    v_mfma_f32_16x16x32_bf16 v[108:111], v[132:135], a[228:231], v[108:111]
    ds_read_b64_tr_b16 v[126:127], v225 offset:32384
    v_mfma_f32_16x16x32_bf16 v[112:115], v[136:139], a[224:227], v[112:115]
    ds_read_b64_tr_b16 v[128:129], v225 offset:27808
    v_mfma_f32_16x16x32_bf16 v[116:119], v[136:139], a[228:231], v[116:119]
    ds_read_b64_tr_b16 v[130:131], v225 offset:32416
    s_waitcnt vmcnt(26)
    s_waitcnt lgkmcnt(6)
    s_waitcnt vmcnt(17)
M_py:
    v_cmp_gt_u32 vcc, 24, v14
    s_nop 4
    s_cbranch_vccz M_py_out
    s_add_u32 s100, s100, 1
    s_cmp_ge_u32 s100, 262144
    s_cbranch_scc1 M_py_out
    buffer_load_dword v14, v11, s[36:39], s68 offen sc1
    s_waitcnt vmcnt(0)
    s_branch M_py
M_py_out:
    v_mfma_f32_16x16x32_bf16 v[48:51], v[140:143], a[232:235], v[48:51]
    ds_read_b64_tr_b16 v[132:133], v225 offset:27840
    v_mfma_f32_16x16x32_bf16 v[52:55], v[140:143], a[236:239], v[52:55]
    ds_read_b64_tr_b16 v[134:135], v225 offset:32448
    v_mfma_f32_16x16x32_bf16 v[56:59], v[144:147], a[232:235], v[56:59]
    ds_read_b64_tr_b16 v[136:137], v225 offset:27872
    s_add_u32 s48, s72, 0
    buffer_load_dwordx2 v[232:233], v228, s[12:15], s48 offen
    v_mfma_f32_16x16x32_bf16 v[60:63], v[144:147], a[236:239], v[60:63]
    ds_read_b64_tr_b16 v[138:139], v225 offset:32480
    v_mfma_f32_16x16x32_bf16 v[64:67], v[148:151], a[232:235], v[64:67]
    ds_read_b64_tr_b16 v[140:141], v225 offset:27904
    v_mfma_f32_16x16x32_bf16 v[68:71], v[148:151], a[236:239], v[68:71]
    ds_read_b64_tr_b16 v[142:143], v225 offset:32512
    s_waitcnt lgkmcnt(6)
    v_mfma_f32_16x16x32_bf16 v[72:75], v[120:123], a[232:235], v[72:75]
    ds_read_b64_tr_b16 v[144:145], v225 offset:36864
    v_mfma_f32_16x16x32_bf16 v[76:79], v[120:123], a[236:239], v[76:79]
    ds_read_b64_tr_b16 v[146:147], v225 offset:41472
    s_add_u32 s48, s72, 18432
    buffer_load_dwordx2 v[234:235], v228, s[12:15], s48 offen
    v_mfma_f32_16x16x32_bf16 v[80:83], v[124:127], a[232:235], v[80:83]
    ds_read_b64_tr_b16 v[148:149], v225 offset:36896
    v_mfma_f32_16x16x32_bf16 v[84:87], v[124:127], a[236:239], v[84:87]
    ds_read_b64_tr_b16 v[150:151], v225 offset:41504
    v_mfma_f32_16x16x32_bf16 v[88:91], v[128:131], a[232:235], v[88:91]
    ds_read_b64_tr_b16 v[120:121], v225 offset:36928
    v_mfma_f32_16x16x32_bf16 v[92:95], v[128:131], a[236:239], v[92:95]
    ds_read_b64_tr_b16 v[122:123], v225 offset:41536
    s_waitcnt lgkmcnt(6)
    v_mfma_f32_16x16x32_bf16 v[96:99], v[132:135], a[232:235], v[96:99]
    ds_read_b64_tr_b16 v[124:125], v225 offset:36960
    v_mfma_f32_16x16x32_bf16 v[100:103], v[132:135], a[236:239], v[100:103]
    ds_read_b64_tr_b16 v[126:127], v225 offset:41568
    s_add_u32 s48, s73, 0
    buffer_load_dwordx4 v[244:247], v229, s[32:35], s48 offen sc1
    v_mfma_f32_16x16x32_bf16 v[104:107], v[136:139], a[232:235], v[104:107]
    ds_read_b64_tr_b16 v[128:129], v225 offset:36992
    v_mfma_f32_16x16x32_bf16 v[108:111], v[136:139], a[236:239], v[108:111]
    ds_read_b64_tr_b16 v[130:131], v225 offset:41600
    v_mfma_f32_16x16x32_bf16 v[112:115], v[140:143], a[232:235], v[112:115]
    ds_read_b64_tr_b16 v[132:133], v225 offset:37024
    v_mfma_f32_16x16x32_bf16 v[116:119], v[140:143], a[236:239], v[116:119]
    ds_read_b64_tr_b16 v[134:135], v225 offset:41632
    s_waitcnt vmcnt(25)
    s_waitcnt lgkmcnt(6)
    v_mfma_f32_16x16x32_bf16 v[48:51], v[144:147], a[240:243], v[48:51]
    ds_read_b64_tr_b16 v[136:137], v225 offset:37056
    v_mfma_f32_16x16x32_bf16 v[52:55], v[144:147], a[244:247], v[52:55]
    ds_read_b64_tr_b16 v[138:139], v225 offset:41664
    s_add_u32 s48, s72, 128
    buffer_load_dwordx2 v[236:237], v228, s[12:15], s48 offen
    v_mfma_f32_16x16x32_bf16 v[56:59], v[148:151], a[240:243], v[56:59]
    ds_read_b64_tr_b16 v[140:141], v225 offset:37088
    v_mfma_f32_16x16x32_bf16 v[60:63], v[148:151], a[244:247], v[60:63]
    ds_read_b64_tr_b16 v[142:143], v225 offset:41696
    v_mfma_f32_16x16x32_bf16 v[64:67], v[120:123], a[240:243], v[64:67]
    ds_read_b64_tr_b16 v[144:145], v225 offset:37120
    v_mfma_f32_16x16x32_bf16 v[68:71], v[120:123], a[244:247], v[68:71]
    ds_read_b64_tr_b16 v[146:147], v225 offset:41728
    s_waitcnt lgkmcnt(6)
    v_mfma_f32_16x16x32_bf16 v[72:75], v[124:127], a[240:243], v[72:75]
    ds_read_b64_tr_b16 v[148:149], v225 offset:46080
    v_mfma_f32_16x16x32_bf16 v[76:79], v[124:127], a[244:247], v[76:79]
    ds_read_b64_tr_b16 v[150:151], v225 offset:50688
    s_add_u32 s48, s72, 18560
    buffer_load_dwordx2 v[238:239], v228, s[12:15], s48 offen
    v_mfma_f32_16x16x32_bf16 v[80:83], v[128:131], a[240:243], v[80:83]
    ds_read_b64_tr_b16 v[120:121], v225 offset:46112
    v_mfma_f32_16x16x32_bf16 v[84:87], v[128:131], a[244:247], v[84:87]
    ds_read_b64_tr_b16 v[122:123], v225 offset:50720
    v_mfma_f32_16x16x32_bf16 v[88:91], v[132:135], a[240:243], v[88:91]
    ds_read_b64_tr_b16 v[124:125], v225 offset:46144
    v_mfma_f32_16x16x32_bf16 v[92:95], v[132:135], a[244:247], v[92:95]
    ds_read_b64_tr_b16 v[126:127], v225 offset:50752
    s_waitcnt lgkmcnt(6)
    v_mfma_f32_16x16x32_bf16 v[96:99], v[136:139], a[240:243], v[96:99]
    ds_read_b64_tr_b16 v[128:129], v225 offset:46176
    s_add_u32 s48, s73, 262144
    buffer_load_dwordx4 v[248:251], v229, s[32:35], s48 offen sc1
    v_mfma_f32_16x16x32_bf16 v[100:103], v[136:139], a[244:247], v[100:103]
    ds_read_b64_tr_b16 v[130:131], v225 offset:50784
    v_mfma_f32_16x16x32_bf16 v[104:107], v[140:143], a[240:243], v[104:107]
    ds_read_b64_tr_b16 v[132:133], v225 offset:46208
    v_mfma_f32_16x16x32_bf16 v[108:111], v[140:143], a[244:247], v[108:111]
    ds_read_b64_tr_b16 v[134:135], v225 offset:50816
    v_mfma_f32_16x16x32_bf16 v[112:115], v[144:147], a[240:243], v[112:115]
    ds_read_b64_tr_b16 v[136:137], v225 offset:46240
    v_mfma_f32_16x16x32_bf16 v[116:119], v[144:147], a[244:247], v[116:119]
    ds_read_b64_tr_b16 v[138:139], v225 offset:50848
    s_waitcnt vmcnt(24)
    s_waitcnt lgkmcnt(6)
    v_mfma_f32_16x16x32_bf16 v[48:51], v[148:151], a[248:251], v[48:51]
    ds_read_b64_tr_b16 v[140:141], v225 offset:46272
    s_add_u32 s48, s72, 256
    buffer_load_dwordx2 v[240:241], v228, s[12:15], s48 offen
    v_mfma_f32_16x16x32_bf16 v[52:55], v[148:151], a[252:255], v[52:55]
    ds_read_b64_tr_b16 v[142:143], v225 offset:50880
    v_mfma_f32_16x16x32_bf16 v[56:59], v[120:123], a[248:251], v[56:59]
    ds_read_b64_tr_b16 v[144:145], v225 offset:46304
    v_mfma_f32_16x16x32_bf16 v[60:63], v[120:123], a[252:255], v[60:63]
    ds_read_b64_tr_b16 v[146:147], v225 offset:50912
    v_mfma_f32_16x16x32_bf16 v[64:67], v[124:127], a[248:251], v[64:67]
    ds_read_b64_tr_b16 v[148:149], v225 offset:46336
    v_mfma_f32_16x16x32_bf16 v[68:71], v[124:127], a[252:255], v[68:71]
    ds_read_b64_tr_b16 v[150:151], v225 offset:50944
    s_waitcnt vmcnt(9)
    s_barrier
    s_waitcnt lgkmcnt(6)
    v_mfma_f32_16x16x32_bf16 v[72:75], v[128:131], a[248:251], v[72:75]
    ds_read_b64_tr_b16 v[120:121], v226 offset:4096
    s_add_u32 s48, s72, 18688
    buffer_load_dwordx2 v[242:243], v228, s[12:15], s48 offen
    v_mfma_f32_16x16x32_bf16 v[76:79], v[128:131], a[252:255], v[76:79]
    ds_read_b64_tr_b16 v[122:123], v226 offset:8704
    v_mfma_f32_16x16x32_bf16 v[80:83], v[132:135], a[248:251], v[80:83]
    ds_read_b64_tr_b16 v[124:125], v226 offset:4128
    v_mfma_f32_16x16x32_bf16 v[84:87], v[132:135], a[252:255], v[84:87]
    ds_read_b64_tr_b16 v[126:127], v226 offset:8736
    v_mfma_f32_16x16x32_bf16 v[88:91], v[136:139], a[248:251], v[88:91]
    ds_read_b64_tr_b16 v[128:129], v226 offset:13312
    v_mfma_f32_16x16x32_bf16 v[92:95], v[136:139], a[252:255], v[92:95]
    ds_read_b64_tr_b16 v[130:131], v226 offset:17920
    s_waitcnt lgkmcnt(6)
    v_mfma_f32_16x16x32_bf16 v[96:99], v[140:143], a[248:251], v[96:99]
    ds_read_b64_tr_b16 v[132:133], v226 offset:13344
    s_add_u32 s48, s73, 524288
    buffer_load_dwordx4 v[252:255], v229, s[32:35], s48 offen sc1
    v_mfma_f32_16x16x32_bf16 v[100:103], v[140:143], a[252:255], v[100:103]
    ds_read_b64_tr_b16 v[134:135], v226 offset:17952
    v_mfma_f32_16x16x32_bf16 v[104:107], v[144:147], a[248:251], v[104:107]
    ds_read_b64_tr_b16 v[136:137], v226 offset:22528
    v_mfma_f32_16x16x32_bf16 v[108:111], v[144:147], a[252:255], v[108:111]
    ds_read_b64_tr_b16 v[138:139], v226 offset:27136
    v_mfma_f32_16x16x32_bf16 v[112:115], v[148:151], a[248:251], v[112:115]
    ds_read_b64_tr_b16 v[140:141], v226 offset:22560
    v_mfma_f32_16x16x32_bf16 v[116:119], v[148:151], a[252:255], v[116:119]
    ds_read_b64_tr_b16 v[142:143], v226 offset:27168
    s_waitcnt vmcnt(22)
    s_waitcnt lgkmcnt(6)
    v_mfma_f32_16x16x32_bf16 v[48:51], v[120:123], v[16:19], v[48:51]
    ds_read_b64_tr_b16 v[144:145], v226 offset:31744
    v_mfma_f32_16x16x32_bf16 v[52:55], v[120:123], v[20:23], v[52:55]
    ds_read_b64_tr_b16 v[146:147], v226 offset:36352
    v_mfma_f32_16x16x32_bf16 v[56:59], v[124:127], v[16:19], v[56:59]
    ds_read_b64_tr_b16 v[148:149], v226 offset:31776
    v_mfma_f32_16x16x32_bf16 v[60:63], v[124:127], v[20:23], v[60:63]
    ds_read_b64_tr_b16 v[150:151], v226 offset:36384
    s_waitcnt vmcnt(17)
    v_mfma_f32_16x16x32_bf16 v[48:51], v[128:131], v[24:27], v[48:51]
    ds_read_b64_tr_b16 v[120:121], v226 offset:4160
    v_mfma_f32_16x16x32_bf16 v[52:55], v[128:131], v[28:31], v[52:55]
    ds_read_b64_tr_b16 v[122:123], v226 offset:8768
    s_waitcnt lgkmcnt(6)
    v_mfma_f32_16x16x32_bf16 v[56:59], v[132:135], v[24:27], v[56:59]
    ds_read_b64_tr_b16 v[124:125], v226 offset:4192
    v_mfma_f32_16x16x32_bf16 v[60:63], v[132:135], v[28:31], v[60:63]
    ds_read_b64_tr_b16 v[126:127], v226 offset:8800
    s_waitcnt vmcnt(13)
    v_mfma_f32_16x16x32_bf16 v[48:51], v[136:139], v[32:35], v[48:51]
    ds_read_b64_tr_b16 v[128:129], v226 offset:13376
    v_mfma_f32_16x16x32_bf16 v[52:55], v[136:139], v[36:39], v[52:55]
    ds_read_b64_tr_b16 v[130:131], v226 offset:17984
    v_mfma_f32_16x16x32_bf16 v[56:59], v[140:143], v[32:35], v[56:59]
    ds_read_b64_tr_b16 v[132:133], v226 offset:13408
    v_mfma_f32_16x16x32_bf16 v[60:63], v[140:143], v[36:39], v[60:63]
    ds_read_b64_tr_b16 v[134:135], v226 offset:18016
    s_waitcnt vmcnt(9)
    s_waitcnt lgkmcnt(6)
    v_mfma_f32_16x16x32_bf16 v[48:51], v[144:147], v[40:43], v[48:51]
    ds_read_b64_tr_b16 v[136:137], v226 offset:22592
    v_mfma_f32_16x16x32_bf16 v[52:55], v[144:147], v[44:47], v[52:55]
    ds_read_b64_tr_b16 v[138:139], v226 offset:27200
    v_mfma_f32_16x16x32_bf16 v[56:59], v[148:151], v[40:43], v[56:59]
    ds_read_b64_tr_b16 v[140:141], v226 offset:22624
    v_mfma_f32_16x16x32_bf16 v[60:63], v[148:151], v[44:47], v[60:63]
    ds_read_b64_tr_b16 v[142:143], v226 offset:27232
    v_mfma_f32_16x16x32_bf16 v[64:67], v[120:123], v[16:19], v[64:67]
    ds_read_b64_tr_b16 v[144:145], v226 offset:31808
    v_mfma_f32_16x16x32_bf16 v[68:71], v[120:123], v[20:23], v[68:71]
    ds_read_b64_tr_b16 v[146:147], v226 offset:36416
    s_waitcnt lgkmcnt(6)
    v_mfma_f32_16x16x32_bf16 v[72:75], v[124:127], v[16:19], v[72:75]
    ds_read_b64_tr_b16 v[148:149], v226 offset:31840
    v_mfma_f32_16x16x32_bf16 v[76:79], v[124:127], v[20:23], v[76:79]
    ds_read_b64_tr_b16 v[150:151], v226 offset:36448
    v_cvt_pk_bf16_f32 v208, v48, v49
    v_mfma_f32_16x16x32_bf16 v[64:67], v[128:131], v[24:27], v[64:67]
    ds_read_b64_tr_b16 v[120:121], v226 offset:4224
    v_cvt_pk_bf16_f32 v209, v50, v51
    v_mfma_f32_16x16x32_bf16 v[68:71], v[128:131], v[28:31], v[68:71]
    ds_read_b64_tr_b16 v[122:123], v226 offset:8832
    v_cvt_pk_bf16_f32 v210, v52, v53
    v_mfma_f32_16x16x32_bf16 v[72:75], v[132:135], v[24:27], v[72:75]
    ds_read_b64_tr_b16 v[124:125], v226 offset:4256
    v_cvt_pk_bf16_f32 v211, v54, v55
    v_mfma_f32_16x16x32_bf16 v[76:79], v[132:135], v[28:31], v[76:79]
    ds_read_b64_tr_b16 v[126:127], v226 offset:8864
    s_waitcnt lgkmcnt(6)
    v_mfma_f32_16x16x32_bf16 v[64:67], v[136:139], v[32:35], v[64:67]
    ds_read_b64_tr_b16 v[128:129], v226 offset:13440
    s_add_u32 s49, s61, 0
    v_mfma_f32_16x16x32_bf16 v[68:71], v[136:139], v[36:39], v[68:71]
    ds_read_b64_tr_b16 v[130:131], v226 offset:18048
    buffer_store_dwordx4 v[208:211], v1, s[28:31], s49 offen sc1
    v_mfma_f32_16x16x32_bf16 v[72:75], v[140:143], v[32:35], v[72:75]
    ds_read_b64_tr_b16 v[132:133], v226 offset:13472
    v_cvt_pk_bf16_f32 v212, v56, v57
    v_mfma_f32_16x16x32_bf16 v[76:79], v[140:143], v[36:39], v[76:79]
    ds_read_b64_tr_b16 v[134:135], v226 offset:18080
    v_cvt_pk_bf16_f32 v213, v58, v59
    v_mfma_f32_16x16x32_bf16 v[64:67], v[144:147], v[40:43], v[64:67]
    ds_read_b64_tr_b16 v[136:137], v226 offset:22656
    v_cvt_pk_bf16_f32 v214, v60, v61
    v_mfma_f32_16x16x32_bf16 v[68:71], v[144:147], v[44:47], v[68:71]
    ds_read_b64_tr_b16 v[138:139], v226 offset:27264
    s_waitcnt lgkmcnt(6)
    v_mfma_f32_16x16x32_bf16 v[72:75], v[148:151], v[40:43], v[72:75]
    ds_read_b64_tr_b16 v[140:141], v226 offset:22688
    v_cvt_pk_bf16_f32 v215, v62, v63
    v_mfma_f32_16x16x32_bf16 v[76:79], v[148:151], v[44:47], v[76:79]
    ds_read_b64_tr_b16 v[142:143], v226 offset:27296
    s_add_u32 s49, s61, 4096
    buffer_store_dwordx4 v[212:215], v1, s[28:31], s49 offen sc1
    v_mfma_f32_16x16x32_bf16 v[80:83], v[120:123], v[16:19], v[80:83]
    ds_read_b64_tr_b16 v[144:145], v226 offset:31872
    v_mfma_f32_16x16x32_bf16 v[84:87], v[120:123], v[20:23], v[84:87]
    ds_read_b64_tr_b16 v[146:147], v226 offset:36480
    v_mfma_f32_16x16x32_bf16 v[88:91], v[124:127], v[16:19], v[88:91]
    ds_read_b64_tr_b16 v[148:149], v226 offset:31904
    v_mfma_f32_16x16x32_bf16 v[92:95], v[124:127], v[20:23], v[92:95]
    ds_read_b64_tr_b16 v[150:151], v226 offset:36512
    s_waitcnt lgkmcnt(6)
    v_mfma_f32_16x16x32_bf16 v[80:83], v[128:131], v[24:27], v[80:83]
    ds_read_b64_tr_b16 v[120:121], v226 offset:4288
    v_cvt_pk_bf16_f32 v208, v64, v65
    v_mfma_f32_16x16x32_bf16 v[84:87], v[128:131], v[28:31], v[84:87]
    ds_read_b64_tr_b16 v[122:123], v226 offset:8896
    v_cvt_pk_bf16_f32 v209, v66, v67
    v_mfma_f32_16x16x32_bf16 v[88:91], v[132:135], v[24:27], v[88:91]
    ds_read_b64_tr_b16 v[124:125], v226 offset:4320
    v_cvt_pk_bf16_f32 v210, v68, v69
    v_mfma_f32_16x16x32_bf16 v[92:95], v[132:135], v[28:31], v[92:95]
    ds_read_b64_tr_b16 v[126:127], v226 offset:8928
    v_cvt_pk_bf16_f32 v211, v70, v71
    v_mfma_f32_16x16x32_bf16 v[80:83], v[136:139], v[32:35], v[80:83]
    ds_read_b64_tr_b16 v[128:129], v226 offset:13504
    s_add_u32 s49, s61, 8192
    v_mfma_f32_16x16x32_bf16 v[84:87], v[136:139], v[36:39], v[84:87]
    ds_read_b64_tr_b16 v[130:131], v226 offset:18112
    s_waitcnt lgkmcnt(6)
    v_mfma_f32_16x16x32_bf16 v[88:91], v[140:143], v[32:35], v[88:91]
    ds_read_b64_tr_b16 v[132:133], v226 offset:13536
    buffer_store_dwordx4 v[208:211], v1, s[28:31], s49 offen sc1
    v_mfma_f32_16x16x32_bf16 v[92:95], v[140:143], v[36:39], v[92:95]
    ds_read_b64_tr_b16 v[134:135], v226 offset:18144
    v_cvt_pk_bf16_f32 v212, v72, v73
    v_mfma_f32_16x16x32_bf16 v[80:83], v[144:147], v[40:43], v[80:83]
    ds_read_b64_tr_b16 v[136:137], v226 offset:22720
    v_cvt_pk_bf16_f32 v213, v74, v75
    v_mfma_f32_16x16x32_bf16 v[84:87], v[144:147], v[44:47], v[84:87]
    ds_read_b64_tr_b16 v[138:139], v226 offset:27328
    v_cvt_pk_bf16_f32 v214, v76, v77
    v_mfma_f32_16x16x32_bf16 v[88:91], v[148:151], v[40:43], v[88:91]
    ds_read_b64_tr_b16 v[140:141], v226 offset:22752
    v_cvt_pk_bf16_f32 v215, v78, v79
    s_add_u32 s49, s61, 12288
    v_mfma_f32_16x16x32_bf16 v[92:95], v[148:151], v[44:47], v[92:95]
    ds_read_b64_tr_b16 v[142:143], v226 offset:27360
    buffer_store_dwordx4 v[212:215], v1, s[28:31], s49 offen sc1
    s_waitcnt lgkmcnt(6)
    v_mfma_f32_16x16x32_bf16 v[96:99], v[120:123], v[16:19], v[96:99]
    ds_read_b64_tr_b16 v[144:145], v226 offset:31936
    v_mfma_f32_16x16x32_bf16 v[100:103], v[120:123], v[20:23], v[100:103]
    ds_read_b64_tr_b16 v[146:147], v226 offset:36544
    v_mfma_f32_16x16x32_bf16 v[104:107], v[124:127], v[16:19], v[104:107]
    ds_read_b64_tr_b16 v[148:149], v226 offset:31968
    v_mfma_f32_16x16x32_bf16 v[108:111], v[124:127], v[20:23], v[108:111]
    ds_read_b64_tr_b16 v[150:151], v226 offset:36576
    v_cvt_pk_bf16_f32 v208, v80, v81
    v_mfma_f32_16x16x32_bf16 v[96:99], v[128:131], v[24:27], v[96:99]
    ds_read_b64_tr_b16 v[120:121], v226 offset:4352
    v_cvt_pk_bf16_f32 v209, v82, v83
    v_mfma_f32_16x16x32_bf16 v[100:103], v[128:131], v[28:31], v[100:103]
    ds_read_b64_tr_b16 v[122:123], v226 offset:8960
    s_waitcnt lgkmcnt(6)
    v_mfma_f32_16x16x32_bf16 v[104:107], v[132:135], v[24:27], v[104:107]
    ds_read_b64_tr_b16 v[124:125], v226 offset:13568
    v_cvt_pk_bf16_f32 v210, v84, v85
    v_mfma_f32_16x16x32_bf16 v[108:111], v[132:135], v[28:31], v[108:111]
    ds_read_b64_tr_b16 v[126:127], v226 offset:18176
    v_cvt_pk_bf16_f32 v211, v86, v87
    v_mfma_f32_16x16x32_bf16 v[96:99], v[136:139], v[32:35], v[96:99]
    ds_read_b64_tr_b16 v[128:129], v226 offset:22784
    s_add_u32 s49, s61, 16384
    v_mfma_f32_16x16x32_bf16 v[100:103], v[136:139], v[36:39], v[100:103]
    ds_read_b64_tr_b16 v[130:131], v226 offset:27392
    buffer_store_dwordx4 v[208:211], v1, s[28:31], s49 offen sc1
    v_mfma_f32_16x16x32_bf16 v[104:107], v[140:143], v[32:35], v[104:107]
    ds_read_b64_tr_b16 v[132:133], v226 offset:32000
    v_cvt_pk_bf16_f32 v212, v88, v89
    v_mfma_f32_16x16x32_bf16 v[108:111], v[140:143], v[36:39], v[108:111]
    ds_read_b64_tr_b16 v[134:135], v226 offset:36608
    s_waitcnt lgkmcnt(6)
    v_mfma_f32_16x16x32_bf16 v[96:99], v[144:147], v[40:43], v[96:99]
    v_cvt_pk_bf16_f32 v213, v90, v91
    v_cvt_pk_bf16_f32 v214, v92, v93
    v_mfma_f32_16x16x32_bf16 v[100:103], v[144:147], v[44:47], v[100:103]
    v_cvt_pk_bf16_f32 v215, v94, v95
    s_add_u32 s49, s61, 20480
    v_mfma_f32_16x16x32_bf16 v[104:107], v[148:151], v[40:43], v[104:107]
    buffer_store_dwordx4 v[212:215], v1, s[28:31], s49 offen sc1
    v_mfma_f32_16x16x32_bf16 v[108:111], v[148:151], v[44:47], v[108:111]
    v_mfma_f32_16x16x32_bf16 v[112:115], v[120:123], v[16:19], v[112:115]
    v_mfma_f32_16x16x32_bf16 v[116:119], v[120:123], v[20:23], v[116:119]
    s_waitcnt lgkmcnt(0)
    v_mfma_f32_16x16x32_bf16 v[112:115], v[124:127], v[24:27], v[112:115]
    v_mfma_f32_16x16x32_bf16 v[116:119], v[124:127], v[28:31], v[116:119]
    v_cvt_pk_bf16_f32 v208, v96, v97
    v_cvt_pk_bf16_f32 v209, v98, v99
    v_mfma_f32_16x16x32_bf16 v[112:115], v[128:131], v[32:35], v[112:115]
    v_cvt_pk_bf16_f32 v210, v100, v101
    v_cvt_pk_bf16_f32 v211, v102, v103
    v_mfma_f32_16x16x32_bf16 v[116:119], v[128:131], v[36:39], v[116:119]
    s_add_u32 s49, s61, 24576
    buffer_store_dwordx4 v[208:211], v1, s[28:31], s49 offen sc1
    v_mfma_f32_16x16x32_bf16 v[112:115], v[132:135], v[40:43], v[112:115]
    v_cvt_pk_bf16_f32 v212, v104, v105
    v_cvt_pk_bf16_f32 v213, v106, v107
    v_mfma_f32_16x16x32_bf16 v[116:119], v[132:135], v[44:47], v[116:119]
    v_cvt_pk_bf16_f32 v214, v108, v109
    v_cvt_pk_bf16_f32 v215, v110, v111
    s_add_u32 s49, s61, 28672
    buffer_store_dwordx4 v[212:215], v1, s[28:31], s49 offen sc1
    s_nop 7
    v_cvt_pk_bf16_f32 v208, v112, v113
    v_cvt_pk_bf16_f32 v209, v114, v115
    v_cvt_pk_bf16_f32 v210, v116, v117
    v_cvt_pk_bf16_f32 v211, v118, v119
    s_add_u32 s49, s61, 32768
    buffer_store_dwordx4 v[208:211], v1, s[28:31], s49 offen sc1
    s_waitcnt vmcnt(9)
    ds_write_b128 v230, v[244:247] offset:0
    ds_write_b128 v230, v[248:251] offset:1024
    ds_write_b128 v230, v[252:255] offset:2048
    v_mov_b32 v11, 0x3f80
    v_mov_b32 v12, 0x3f800000
    s_waitcnt lgkmcnt(0)
    ds_read_b64_tr_b16 v[168:169], v231 offset:0
    ds_read_b64_tr_b16 v[170:171], v231 offset:32
    ds_read_b64_tr_b16 v[172:173], v231 offset:1024
    ds_read_b64_tr_b16 v[174:175], v231 offset:1056
    ds_read_b64_tr_b16 v[176:177], v231 offset:2048
    ds_read_b64_tr_b16 v[178:179], v231 offset:2080
    s_waitcnt lgkmcnt(0)
    v_lshlrev_b32 v184, 16, v232
    v_and_b32 v185, 0xffff0000, v232
    v_lshlrev_b32 v186, 16, v233
    v_and_b32 v187, 0xffff0000, v233
    v_lshlrev_b32 v188, 16, v234
    v_and_b32 v189, 0xffff0000, v234
    v_lshlrev_b32 v190, 16, v235
    v_and_b32 v191, 0xffff0000, v235
    v_dot2c_f32_bf16 v184, v168, v11
    v_dot2c_f32_bf16 v185, v168, v12
    v_dot2c_f32_bf16 v186, v169, v11
    v_dot2c_f32_bf16 v187, v169, v12
    v_dot2c_f32_bf16 v188, v170, v11
    v_dot2c_f32_bf16 v189, v170, v12
    v_dot2c_f32_bf16 v190, v171, v11
    v_dot2c_f32_bf16 v191, v171, v12
    v_lshlrev_b32 v192, 16, v236
    v_and_b32 v193, 0xffff0000, v236
    v_lshlrev_b32 v194, 16, v237
    v_and_b32 v195, 0xffff0000, v237
    v_lshlrev_b32 v196, 16, v238
    v_and_b32 v197, 0xffff0000, v238
    v_lshlrev_b32 v198, 16, v239
    v_and_b32 v199, 0xffff0000, v239
    v_dot2c_f32_bf16 v192, v172, v11
    v_dot2c_f32_bf16 v193, v172, v12
    v_dot2c_f32_bf16 v194, v173, v11
    v_dot2c_f32_bf16 v195, v173, v12
    v_dot2c_f32_bf16 v196, v174, v11
    v_dot2c_f32_bf16 v197, v174, v12
    v_dot2c_f32_bf16 v198, v175, v11
    v_dot2c_f32_bf16 v199, v175, v12
    v_lshlrev_b32 v200, 16, v240
    v_and_b32 v201, 0xffff0000, v240
    v_lshlrev_b32 v202, 16, v241
    v_and_b32 v203, 0xffff0000, v241
    v_lshlrev_b32 v204, 16, v242
    v_and_b32 v205, 0xffff0000, v242
    v_lshlrev_b32 v206, 16, v243
    v_and_b32 v207, 0xffff0000, v243
    v_dot2c_f32_bf16 v200, v176, v11
    v_dot2c_f32_bf16 v201, v176, v12
    v_dot2c_f32_bf16 v202, v177, v11
    v_dot2c_f32_bf16 v203, v177, v12
    v_dot2c_f32_bf16 v204, v178, v11
    v_dot2c_f32_bf16 v205, v178, v12
    v_dot2c_f32_bf16 v206, v179, v11
    v_dot2c_f32_bf16 v207, v179, v12
    s_waitcnt vmcnt(0)
    s_barrier
    s_cmp_lg_u32 s3, 0
    s_cbranch_scc1 M_nopub
    s_lshl_b32 s65, s60, 2
    s_add_u32 s65, s65, s53
    v_mov_b32 v15, 1
    s_mov_b64 exec, 1
    buffer_store_dword v15, off, s[36:39], s65 sc1
    s_mov_b64 exec, -1
M_nopub:
    v_and_b32 v13, 3, v0
    v_lshlrev_b32 v13, 2, v13
    buffer_load_dword v14, v13, s[36:39], s53 offen sc1
M_pb:
    s_sleep 2
    buffer_load_dword v15, v13, s[36:39], s53 offen sc1
    s_waitcnt vmcnt(1)
    v_cmp_ne_u32 vcc, 1, v14
    s_nop 4
    s_cbranch_vccz M_pbo
    s_sleep 2
    buffer_load_dword v14, v13, s[36:39], s53 offen sc1
    s_waitcnt vmcnt(1)
    v_cmp_ne_u32 vcc, 1, v15
    s_nop 4
    s_cbranch_vccz M_pbo
    s_add_u32 s100, s100, 1
    s_cmp_ge_u32 s100, 262144
    s_cbranch_scc0 M_pb
M_pbo:
    s_cmp_lg_u32 s3, 0
    s_cbranch_scc1 M_fin2
    s_add_u32 s48, s74, 0
    buffer_load_dwordx4 v[48:51], v1, s[28:31], s48 offen offset:0 sc1
    buffer_load_dwordx4 v[52:55], v1, s[28:31], s48 offen offset:1024 sc1
    buffer_load_dwordx4 v[56:59], v1, s[28:31], s48 offen offset:2048 sc1
    buffer_load_dwordx4 v[60:63], v1, s[28:31], s48 offen offset:3072 sc1
    s_add_u32 s48, s74, 16384
    buffer_load_dwordx4 v[64:67], v1, s[28:31], s48 offen offset:0 sc1
    buffer_load_dwordx4 v[68:71], v1, s[28:31], s48 offen offset:1024 sc1
    buffer_load_dwordx4 v[72:75], v1, s[28:31], s48 offen offset:2048 sc1
    buffer_load_dwordx4 v[76:79], v1, s[28:31], s48 offen offset:3072 sc1
    s_add_u32 s48, s74, 32768
    buffer_load_dwordx4 v[80:83], v1, s[28:31], s48 offen offset:0 sc1
    buffer_load_dwordx4 v[84:87], v1, s[28:31], s48 offen offset:1024 sc1
    buffer_load_dwordx4 v[88:91], v1, s[28:31], s48 offen offset:2048 sc1
    buffer_load_dwordx4 v[92:95], v1, s[28:31], s48 offen offset:3072 sc1
    s_waitcnt vmcnt(11)
    v_dot2c_f32_bf16 v184, v48, v11
    v_dot2c_f32_bf16 v185, v48, v12
    v_dot2c_f32_bf16 v186, v49, v11
    v_dot2c_f32_bf16 v187, v49, v12
    v_dot2c_f32_bf16 v188, v50, v11
    v_dot2c_f32_bf16 v189, v50, v12
    v_dot2c_f32_bf16 v190, v51, v11
    v_dot2c_f32_bf16 v191, v51, v12
    s_waitcnt vmcnt(10)
    v_dot2c_f32_bf16 v184, v52, v11
    v_dot2c_f32_bf16 v185, v52, v12
    v_dot2c_f32_bf16 v186, v53, v11
    v_dot2c_f32_bf16 v187, v53, v12
    v_dot2c_f32_bf16 v188, v54, v11
    v_dot2c_f32_bf16 v189, v54, v12
    v_dot2c_f32_bf16 v190, v55, v11
    v_dot2c_f32_bf16 v191, v55, v12
    s_waitcnt vmcnt(9)
    v_dot2c_f32_bf16 v184, v56, v11
    v_dot2c_f32_bf16 v185, v56, v12
    v_dot2c_f32_bf16 v186, v57, v11
    v_dot2c_f32_bf16 v187, v57, v12
    v_dot2c_f32_bf16 v188, v58, v11
    v_dot2c_f32_bf16 v189, v58, v12
    v_dot2c_f32_bf16 v190, v59, v11
    v_dot2c_f32_bf16 v191, v59, v12
    s_waitcnt vmcnt(8)
    v_dot2c_f32_bf16 v184, v60, v11
    v_dot2c_f32_bf16 v185, v60, v12
    v_dot2c_f32_bf16 v186, v61, v11
    v_dot2c_f32_bf16 v187, v61, v12
    v_dot2c_f32_bf16 v188, v62, v11
    v_dot2c_f32_bf16 v189, v62, v12
    v_dot2c_f32_bf16 v190, v63, v11
    v_dot2c_f32_bf16 v191, v63, v12
    s_nop 2
    v_cvt_pk_bf16_f32 v208, v184, v185
    v_cvt_pk_bf16_f32 v209, v186, v187
    v_cvt_pk_bf16_f32 v210, v188, v189
    v_cvt_pk_bf16_f32 v211, v190, v191
    s_add_u32 s48, s72, 0
    s_add_u32 s49, s48, 18432
    buffer_store_dwordx2 v[208:209], v228, s[16:19], s48 offen
    buffer_store_dwordx2 v[210:211], v228, s[16:19], s49 offen
    s_waitcnt vmcnt(9)
    v_dot2c_f32_bf16 v192, v64, v11
    v_dot2c_f32_bf16 v193, v64, v12
    v_dot2c_f32_bf16 v194, v65, v11
    v_dot2c_f32_bf16 v195, v65, v12
    v_dot2c_f32_bf16 v196, v66, v11
    v_dot2c_f32_bf16 v197, v66, v12
    v_dot2c_f32_bf16 v198, v67, v11
    v_dot2c_f32_bf16 v199, v67, v12
    s_waitcnt vmcnt(8)
    v_dot2c_f32_bf16 v192, v68, v11
    v_dot2c_f32_bf16 v193, v68, v12
    v_dot2c_f32_bf16 v194, v69, v11
    v_dot2c_f32_bf16 v195, v69, v12
    v_dot2c_f32_bf16 v196, v70, v11
    v_dot2c_f32_bf16 v197, v70, v12
    v_dot2c_f32_bf16 v198, v71, v11
    v_dot2c_f32_bf16 v199, v71, v12
    s_waitcnt vmcnt(7)
    v_dot2c_f32_bf16 v192, v72, v11
    v_dot2c_f32_bf16 v193, v72, v12
    v_dot2c_f32_bf16 v194, v73, v11
    v_dot2c_f32_bf16 v195, v73, v12
    v_dot2c_f32_bf16 v196, v74, v11
    v_dot2c_f32_bf16 v197, v74, v12
    v_dot2c_f32_bf16 v198, v75, v11
    v_dot2c_f32_bf16 v199, v75, v12
    s_waitcnt vmcnt(6)
    v_dot2c_f32_bf16 v192, v76, v11
    v_dot2c_f32_bf16 v193, v76, v12
    v_dot2c_f32_bf16 v194, v77, v11
    v_dot2c_f32_bf16 v195, v77, v12
    v_dot2c_f32_bf16 v196, v78, v11
    v_dot2c_f32_bf16 v197, v78, v12
    v_dot2c_f32_bf16 v198, v79, v11
    v_dot2c_f32_bf16 v199, v79, v12
    s_nop 2
    v_cvt_pk_bf16_f32 v212, v192, v193
    v_cvt_pk_bf16_f32 v213, v194, v195
    v_cvt_pk_bf16_f32 v214, v196, v197
    v_cvt_pk_bf16_f32 v215, v198, v199
    s_add_u32 s48, s72, 128
    s_add_u32 s49, s48, 18432
    buffer_store_dwordx2 v[212:213], v228, s[16:19], s48 offen
    buffer_store_dwordx2 v[214:215], v228, s[16:19], s49 offen
    s_waitcnt vmcnt(7)
    v_dot2c_f32_bf16 v200, v80, v11
    v_dot2c_f32_bf16 v201, v80, v12
    v_dot2c_f32_bf16 v202, v81, v11
    v_dot2c_f32_bf16 v203, v81, v12
    v_dot2c_f32_bf16 v204, v82, v11
    v_dot2c_f32_bf16 v205, v82, v12
    v_dot2c_f32_bf16 v206, v83, v11
    v_dot2c_f32_bf16 v207, v83, v12
    s_waitcnt vmcnt(6)
    v_dot2c_f32_bf16 v200, v84, v11
    v_dot2c_f32_bf16 v201, v84, v12
    v_dot2c_f32_bf16 v202, v85, v11
    v_dot2c_f32_bf16 v203, v85, v12
    v_dot2c_f32_bf16 v204, v86, v11
    v_dot2c_f32_bf16 v205, v86, v12
    v_dot2c_f32_bf16 v206, v87, v11
    v_dot2c_f32_bf16 v207, v87, v12
    s_waitcnt vmcnt(5)
    v_dot2c_f32_bf16 v200, v88, v11
    v_dot2c_f32_bf16 v201, v88, v12
    v_dot2c_f32_bf16 v202, v89, v11
    v_dot2c_f32_bf16 v203, v89, v12
    v_dot2c_f32_bf16 v204, v90, v11
    v_dot2c_f32_bf16 v205, v90, v12
    v_dot2c_f32_bf16 v206, v91, v11
    v_dot2c_f32_bf16 v207, v91, v12
    s_waitcnt vmcnt(4)
    v_dot2c_f32_bf16 v200, v92, v11
    v_dot2c_f32_bf16 v201, v92, v12
    v_dot2c_f32_bf16 v202, v93, v11
    v_dot2c_f32_bf16 v203, v93, v12
    v_dot2c_f32_bf16 v204, v94, v11
    v_dot2c_f32_bf16 v205, v94, v12
    v_dot2c_f32_bf16 v206, v95, v11
    v_dot2c_f32_bf16 v207, v95, v12
    s_nop 2
    v_cvt_pk_bf16_f32 v208, v200, v201
    v_cvt_pk_bf16_f32 v209, v202, v203
    v_cvt_pk_bf16_f32 v210, v204, v205
    v_cvt_pk_bf16_f32 v211, v206, v207
    s_add_u32 s48, s72, 256
    s_add_u32 s49, s48, 18432
    buffer_store_dwordx2 v[208:209], v228, s[16:19], s48 offen
    buffer_store_dwordx2 v[210:211], v228, s[16:19], s49 offen
    s_endpgm
M_fin2:
    s_add_u32 s48, s74, 0
    buffer_load_dwordx4 v[48:51], v1, s[28:31], s48 offen offset:0 sc1
    buffer_load_dwordx4 v[52:55], v1, s[28:31], s48 offen offset:1024 sc1
    buffer_load_dwordx4 v[56:59], v1, s[28:31], s48 offen offset:2048 sc1
    buffer_load_dwordx4 v[60:63], v1, s[28:31], s48 offen offset:3072 sc1
    s_add_u32 s48, s74, 16384
    buffer_load_dwordx4 v[64:67], v1, s[28:31], s48 offen offset:0 sc1
    buffer_load_dwordx4 v[68:71], v1, s[28:31], s48 offen offset:1024 sc1
    buffer_load_dwordx4 v[72:75], v1, s[28:31], s48 offen offset:2048 sc1
    buffer_load_dwordx4 v[76:79], v1, s[28:31], s48 offen offset:3072 sc1
    s_waitcnt vmcnt(7)
    v_dot2c_f32_bf16 v184, v48, v11
    v_dot2c_f32_bf16 v185, v48, v12
    v_dot2c_f32_bf16 v186, v49, v11
    v_dot2c_f32_bf16 v187, v49, v12
    v_dot2c_f32_bf16 v188, v50, v11
    v_dot2c_f32_bf16 v189, v50, v12
    v_dot2c_f32_bf16 v190, v51, v11
    v_dot2c_f32_bf16 v191, v51, v12
    s_waitcnt vmcnt(6)
    v_dot2c_f32_bf16 v184, v52, v11
    v_dot2c_f32_bf16 v185, v52, v12
    v_dot2c_f32_bf16 v186, v53, v11
    v_dot2c_f32_bf16 v187, v53, v12
    v_dot2c_f32_bf16 v188, v54, v11
    v_dot2c_f32_bf16 v189, v54, v12
    v_dot2c_f32_bf16 v190, v55, v11
    v_dot2c_f32_bf16 v191, v55, v12
    s_waitcnt vmcnt(5)
    v_dot2c_f32_bf16 v184, v56, v11
    v_dot2c_f32_bf16 v185, v56, v12
    v_dot2c_f32_bf16 v186, v57, v11
    v_dot2c_f32_bf16 v187, v57, v12
    v_dot2c_f32_bf16 v188, v58, v11
    v_dot2c_f32_bf16 v189, v58, v12
    v_dot2c_f32_bf16 v190, v59, v11
    v_dot2c_f32_bf16 v191, v59, v12
    s_waitcnt vmcnt(4)
    v_dot2c_f32_bf16 v184, v60, v11
    v_dot2c_f32_bf16 v185, v60, v12
    v_dot2c_f32_bf16 v186, v61, v11
    v_dot2c_f32_bf16 v187, v61, v12
    v_dot2c_f32_bf16 v188, v62, v11
    v_dot2c_f32_bf16 v189, v62, v12
    v_dot2c_f32_bf16 v190, v63, v11
    v_dot2c_f32_bf16 v191, v63, v12
    s_nop 2
    v_cvt_pk_bf16_f32 v208, v184, v185
    v_cvt_pk_bf16_f32 v209, v186, v187
    v_cvt_pk_bf16_f32 v210, v188, v189
    v_cvt_pk_bf16_f32 v211, v190, v191
    s_add_u32 s48, s72, 0
    s_add_u32 s49, s48, 18432
    buffer_store_dwordx2 v[208:209], v228, s[16:19], s48 offen
    buffer_store_dwordx2 v[210:211], v228, s[16:19], s49 offen
    s_waitcnt vmcnt(5)
    v_dot2c_f32_bf16 v192, v64, v11
    v_dot2c_f32_bf16 v193, v64, v12
    v_dot2c_f32_bf16 v194, v65, v11
    v_dot2c_f32_bf16 v195, v65, v12
    v_dot2c_f32_bf16 v196, v66, v11
    v_dot2c_f32_bf16 v197, v66, v12
    v_dot2c_f32_bf16 v198, v67, v11
    v_dot2c_f32_bf16 v199, v67, v12
    s_waitcnt vmcnt(4)
    v_dot2c_f32_bf16 v192, v68, v11
    v_dot2c_f32_bf16 v193, v68, v12
    v_dot2c_f32_bf16 v194, v69, v11
    v_dot2c_f32_bf16 v195, v69, v12
    v_dot2c_f32_bf16 v196, v70, v11
    v_dot2c_f32_bf16 v197, v70, v12
    v_dot2c_f32_bf16 v198, v71, v11
    v_dot2c_f32_bf16 v199, v71, v12
    s_waitcnt vmcnt(3)
    v_dot2c_f32_bf16 v192, v72, v11
    v_dot2c_f32_bf16 v193, v72, v12
    v_dot2c_f32_bf16 v194, v73, v11
    v_dot2c_f32_bf16 v195, v73, v12
    v_dot2c_f32_bf16 v196, v74, v11
    v_dot2c_f32_bf16 v197, v74, v12
    v_dot2c_f32_bf16 v198, v75, v11
    v_dot2c_f32_bf16 v199, v75, v12
    s_waitcnt vmcnt(2)
    v_dot2c_f32_bf16 v192, v76, v11
    v_dot2c_f32_bf16 v193, v76, v12
    v_dot2c_f32_bf16 v194, v77, v11
    v_dot2c_f32_bf16 v195, v77, v12
    v_dot2c_f32_bf16 v196, v78, v11
    v_dot2c_f32_bf16 v197, v78, v12
    v_dot2c_f32_bf16 v198, v79, v11
    v_dot2c_f32_bf16 v199, v79, v12
    s_nop 2
    v_cvt_pk_bf16_f32 v212, v192, v193
    v_cvt_pk_bf16_f32 v213, v194, v195
    v_cvt_pk_bf16_f32 v214, v196, v197
    v_cvt_pk_bf16_f32 v215, v198, v199
    s_add_u32 s48, s72, 128
    s_add_u32 s49, s48, 18432
    buffer_store_dwordx2 v[212:213], v228, s[16:19], s48 offen
    buffer_store_dwordx2 v[214:215], v228, s[16:19], s49 offen
M_end:
    s_endpgm
M_codeend:
.section .rodata,"a"
.p2align 6
.amdhsa_kernel parallel_sum__ssm_conv_s4d__swiglu_ffn__prompt_kernel
  .amdhsa_next_free_vgpr 512
  .amdhsa_next_free_sgpr 102
  .amdhsa_accum_offset 256
  .amdhsa_group_segment_fixed_size 0
  .amdhsa_kernarg_size 112
  .amdhsa_user_sgpr_count 2
  .amdhsa_user_sgpr_kernarg_segment_ptr 1
  .amdhsa_system_sgpr_workgroup_id_x 1
  .amdhsa_float_denorm_mode_32 3
.end_amdhsa_kernel
```
